```python
import torch

def _softmax(x, axis=-1):
    return torch.softmax(x, dim=axis)
def _gelu(x):
    return torch.nn.functional.gelu(x, approximate="tanh")
def _silu(x):
    return torch.nn.functional.silu(x)
def _sigmoid(x):
    return torch.sigmoid(x)
def _layernorm(x, axis=-1, eps=1e-5):
    m = x.mean(dim=axis, keepdim=True)
    v = x.var(dim=axis, keepdim=True, unbiased=False)
    return (x - m) / torch.sqrt(v + eps)
def _scatter_add(tgt, idx, src, axis=0):
    return tgt.clone().index_add_(axis, idx, src)
def _segment_sum(src, seg, n):
    out = torch.zeros((n,) + src.shape[1:], dtype=src.dtype)
    return out.index_add_(0, seg, src)
def _pad(x, pw):
    flat = tuple(v for pair in reversed(pw) for v in pair)
    return torch.nn.functional.pad(x, flat)

kernel_name = 'concat_heads__mha_block__mha_block__prompt'

def setup_inputs():

    _w = (lambda a: (lambda t: t.to(torch.bfloat16) if t.is_floating_point() else t)(torch.as_tensor(a)))
    def _A_setup():
        B, S, D, H = 1, 2048, 576, 32
        return {
            "x": _w((lambda *s: torch.randn(*s, dtype=torch.bfloat16) * 0.2)(B, S, D)),
            "wqkv": _w((lambda *s: torch.randn(*s, dtype=torch.bfloat16) * 0.2)(D, 3 * D)),
            "wo": _w((lambda *s: torch.randn(*s, dtype=torch.bfloat16) * 0.05)(D, D)),
        }
    _A_in = _A_setup()

    def _B_setup():
        B, S, D, H = 1, 2048, 576, 32
        return {
            "x": _w((lambda *s: torch.randn(*s, dtype=torch.bfloat16) * 0.2)(B, S, D)),
            "wqkv": _w((lambda *s: torch.randn(*s, dtype=torch.bfloat16) * 0.2)(D, 3 * D)),
            "wo": _w((lambda *s: torch.randn(*s, dtype=torch.bfloat16) * 0.05)(D, D)),
        }
    _B_in = _B_setup()

    return {
        "A_x": _A_in["x"],
        "A_wqkv": _A_in["wqkv"],
        "A_wo": _A_in["wo"],
        "B_x": _B_in["x"],
        "B_wqkv": _B_in["wqkv"],
        "B_wo": _B_in["wo"],
    }

def reference(A_x, A_wqkv, A_wo, B_x, B_wqkv, B_wo):
    def _A_ref(x, wqkv, wo):
        B, S, D = x.shape
        H = 32
        Dh = D // H
        qkv = (lambda x, *d: x.permute(*d))((x @ wqkv).reshape(B, S, 3, H, Dh), 2, 0, 3, 1, 4)
        q, k, v = qkv[0], qkv[1], qkv[2]
        scores = torch.einsum("bhqd,bhkd->bhqk", q, k) * (Dh ** -0.5)
        p = _softmax(scores, axis=-1)
        o = torch.einsum("bhqk,bhkd->bhqd", p, v)
        return (lambda x, *d: x.permute(*d))(o, 0, 2, 1, 3).reshape(B, S, D) @ wo

    def _B_ref(x, wqkv, wo):
        B, S, D = x.shape
        H = 32
        Dh = D // H
        qkv = (lambda x, *d: x.permute(*d))((x @ wqkv).reshape(B, S, 3, H, Dh), 2, 0, 3, 1, 4)
        q, k, v = qkv[0], qkv[1], qkv[2]
        scores = torch.einsum("bhqd,bhkd->bhqk", q, k) * (Dh ** -0.5)
        p = _softmax(scores, axis=-1)
        o = torch.einsum("bhqk,bhkd->bhqd", p, v)
        return (lambda x, *d: x.permute(*d))(o, 0, 2, 1, 3).reshape(B, S, D) @ wo

    a = _A_ref(A_x, A_wqkv, A_wo)
    b = _B_ref(B_x, B_wqkv, B_wo)
    return torch.concatenate([a, b], axis=-1)
```

```asm
; @launch grid=(256,1,1) block=(512,1,1) lds=155648
.amdgcn_target "amdgcn-amd-amdhsa--gfx950"
.text
.globl concat_heads__mha_block__mha_block__prompt_kernel
.p2align 8
.type concat_heads__mha_block__mha_block__prompt_kernel,@function
concat_heads__mha_block__mha_block__prompt_kernel:
    s_cmp_ge_u32 s2, 256
    s_cbranch_scc1 L_exit
    s_load_dwordx16 s[64:79], s[0:1], 0
    s_load_dwordx2 s[80:81], s[0:1], 64
    v_lshrrev_b32 v1, 6, v0
    v_and_b32 v0, 63, v0
    s_nop 0
    v_readfirstlane_b32 s3, v1
    s_nop 3
    s_cmp_lg_u32 s2, 0
    s_cbranch_scc1 L_nonce_done
    s_cmp_lg_u32 s3, 0
    s_cbranch_scc1 L_nonce_done
    s_memrealtime s[40:41]
    s_waitcnt lgkmcnt(0)
    s_or_b32 s40, s40, 1
    v_mov_b32 v2, 0
    v_mov_b32 v3, s40
    s_mov_b64 exec, 1
    global_store_dword v2, v3, s[78:79] sc1
    s_mov_b64 exec, -1
L_nonce_done:
    s_and_b32 s30, s2, 7
    s_lshr_b32 s31, s2, 3
    s_and_b32 s32, s3, 3
    s_lshr_b32 s33, s30, 2
    s_and_b32 s34, s30, 1
    s_lshl_b32 s34, s34, 2
    s_and_b32 s35, s31, 3
    s_add_u32 s34, s34, s35
    s_lshr_b32 s35, s30, 1
    s_and_b32 s35, s35, 1
    s_lshl_b32 s35, s35, 3
    s_lshr_b32 s36, s31, 2
    s_add_u32 s35, s35, s36
    s_lshl_b32 s20, s34, 8
    s_lshl_b32 s21, s32, 6
    s_add_u32 s38, s20, s21
    s_lshl_b32 s37, s32, 13
    v_lshrrev_b32 v4, 4, v0
    v_and_b32 v3, 15, v0
    v_and_b32 v2, 1, v4
    v_lshrrev_b32 v5, 1, v4
    v_lshlrev_b32 v2, 2, v2
    v_lshl_add_u32 v2, v5, 4, v2
    v_mul_u32_u24 v2, 3456, v2
    v_lshl_add_u32 v2, v3, 4, v2
    v_mov_b32 v5, 0x40000000
    v_cmp_gt_u32 vcc, 14, v3
    s_mul_i32 s20, s38, 1152
    s_lshr_b32 s21, s32, 1
    v_cndmask_b32 v2, v5, v2, vcc
    v_add_u32 v24, 0, v2
    v_add_u32 v25, 3456, v2
    v_add_u32 v26, 6912, v2
    v_add_u32 v27, 10368, v2
    s_lshl_b32 s21, s21, 5
    s_and_b32 s22, s32, 1
    s_lshl_b32 s23, s22, 3
    s_add_u32 s21, s21, s23
    s_mul_i32 s21, s21, 3456
    s_mul_i32 s23, s35, 216
    s_add_u32 s21, s21, s23
    s_lshr_b32 s23, s32, 1
    s_mul_i32 s23, s23, 8448
    s_mul_i32 s22, s22, 4224
    s_add_u32 s23, s23, s22
    s_add_u32 s23, s23, 32768
    s_mov_b32 s22, s37
    s_add_u32 s24, s35, s34
    s_mul_i32 s25, s24, 43
    s_lshr_b32 s25, s25, 7
    s_mul_i32 s25, s25, 3
    s_sub_u32 s24, s24, s25
    s_mul_i32 s24, s24, 3
    s_lshl_b32 s25, s24, 7
    s_add_u32 s20, s20, s25
    s_mul_i32 s25, s24, 221184
    s_add_u32 s21, s21, s25
    v_lshrrev_b32 v2, 3, v0
    v_and_b32 v5, 7, v0
    v_xor_b32 v5, v5, v4
    v_mul_u32_u24 v6, 1152, v2
    v_lshl_add_u32 v7, v5, 4, v6
    v_xor_b32 v8, 64, v7
    v_add_u32 v16, 0, v7
    v_add_u32 v17, 9216, v8
    v_add_u32 v18, 18432, v7
    v_add_u32 v19, 27648, v8
    v_add_u32 v20, 36864, v7
    v_add_u32 v21, 46080, v8
    v_add_u32 v22, 55296, v7
    v_add_u32 v23, 64512, v8
    s_mov_b32 s10, 2359296
    s_mov_b32 s11, 0x00020000
    s_mov_b32 s14, 1990656
    s_mov_b32 s15, 0x00020000
    s_waitcnt lgkmcnt(0)
    s_cmp_eq_u32 s33, 0
    s_cselect_b32 s8, s64, s70
    s_cselect_b32 s9, s65, s71
    s_cselect_b32 s12, s66, s72
    s_cselect_b32 s13, s67, s73
    s_cmp_ge_u32 s3, 4
    s_cbranch_scc0 L_p1_compute
    s_add_u32 m0, s22, 0
    s_nop 0
    buffer_load_dwordx4 v16, s[8:11], s20 offen lds
    s_add_u32 m0, m0, 1024
    s_nop 0
    buffer_load_dwordx4 v17, s[8:11], s20 offen lds
    s_add_u32 m0, m0, 1024
    s_nop 0
    buffer_load_dwordx4 v18, s[8:11], s20 offen lds
    s_add_u32 m0, m0, 1024
    s_nop 0
    buffer_load_dwordx4 v19, s[8:11], s20 offen lds
    s_add_u32 m0, m0, 1024
    s_nop 0
    buffer_load_dwordx4 v20, s[8:11], s20 offen lds
    s_add_u32 m0, m0, 1024
    s_nop 0
    buffer_load_dwordx4 v21, s[8:11], s20 offen lds
    s_add_u32 m0, m0, 1024
    s_nop 0
    buffer_load_dwordx4 v22, s[8:11], s20 offen lds
    s_add_u32 m0, m0, 1024
    s_nop 0
    buffer_load_dwordx4 v23, s[8:11], s20 offen lds
    s_add_u32 m0, s23, 0
    s_nop 0
    buffer_load_dwordx4 v24, s[12:15], s21 offen lds
    s_add_u32 m0, m0, 1056
    s_nop 0
    buffer_load_dwordx4 v25, s[12:15], s21 offen lds
    s_add_u32 m0, m0, 1056
    s_nop 0
    buffer_load_dwordx4 v26, s[12:15], s21 offen lds
    s_add_u32 m0, m0, 1056
    s_nop 0
    buffer_load_dwordx4 v27, s[12:15], s21 offen lds
    s_add_u32 s21, s21, 221184
    s_add_u32 s20, s20, 128
    s_add_u32 s24, s24, 1
    s_cmp_eq_u32 s24, 9
    s_cselect_b32 s25, 1152, 0
    s_cselect_b32 s26, 1990656, 0
    s_cselect_b32 s24, 0, s24
    s_sub_u32 s20, s20, s25
    s_sub_u32 s21, s21, s26
    s_add_u32 m0, s22, 49664
    s_nop 0
    buffer_load_dwordx4 v16, s[8:11], s20 offen lds
    s_add_u32 m0, m0, 1024
    s_nop 0
    buffer_load_dwordx4 v17, s[8:11], s20 offen lds
    s_add_u32 m0, m0, 1024
    s_nop 0
    buffer_load_dwordx4 v18, s[8:11], s20 offen lds
    s_add_u32 m0, m0, 1024
    s_nop 0
    buffer_load_dwordx4 v19, s[8:11], s20 offen lds
    s_add_u32 m0, m0, 1024
    s_nop 0
    buffer_load_dwordx4 v20, s[8:11], s20 offen lds
    s_add_u32 m0, m0, 1024
    s_nop 0
    buffer_load_dwordx4 v21, s[8:11], s20 offen lds
    s_add_u32 m0, m0, 1024
    s_nop 0
    buffer_load_dwordx4 v22, s[8:11], s20 offen lds
    s_add_u32 m0, m0, 1024
    s_nop 0
    buffer_load_dwordx4 v23, s[8:11], s20 offen lds
    s_add_u32 m0, s23, 49664
    s_nop 0
    buffer_load_dwordx4 v24, s[12:15], s21 offen lds
    s_add_u32 m0, m0, 1056
    s_nop 0
    buffer_load_dwordx4 v25, s[12:15], s21 offen lds
    s_add_u32 m0, m0, 1056
    s_nop 0
    buffer_load_dwordx4 v26, s[12:15], s21 offen lds
    s_add_u32 m0, m0, 1056
    s_nop 0
    buffer_load_dwordx4 v27, s[12:15], s21 offen lds
    s_add_u32 s21, s21, 221184
    s_add_u32 s20, s20, 128
    s_add_u32 s24, s24, 1
    s_cmp_eq_u32 s24, 9
    s_cselect_b32 s25, 1152, 0
    s_cselect_b32 s26, 1990656, 0
    s_cselect_b32 s24, 0, s24
    s_sub_u32 s20, s20, s25
    s_sub_u32 s21, s21, s26
    s_waitcnt vmcnt(12)
    s_barrier
    s_add_u32 m0, s22, 99328
    s_nop 0
    buffer_load_dwordx4 v16, s[8:11], s20 offen lds
    s_add_u32 m0, m0, 1024
    s_nop 0
    buffer_load_dwordx4 v17, s[8:11], s20 offen lds
    s_add_u32 m0, m0, 1024
    s_nop 0
    buffer_load_dwordx4 v18, s[8:11], s20 offen lds
    s_add_u32 m0, m0, 1024
    s_nop 0
    buffer_load_dwordx4 v19, s[8:11], s20 offen lds
    s_add_u32 m0, m0, 1024
    s_nop 0
    buffer_load_dwordx4 v20, s[8:11], s20 offen lds
    s_add_u32 m0, m0, 1024
    s_nop 0
    buffer_load_dwordx4 v21, s[8:11], s20 offen lds
    s_add_u32 m0, m0, 1024
    s_nop 0
    buffer_load_dwordx4 v22, s[8:11], s20 offen lds
    s_add_u32 m0, m0, 1024
    s_nop 0
    buffer_load_dwordx4 v23, s[8:11], s20 offen lds
    s_add_u32 m0, s23, 99328
    s_nop 0
    buffer_load_dwordx4 v24, s[12:15], s21 offen lds
    s_add_u32 m0, m0, 1056
    s_nop 0
    buffer_load_dwordx4 v25, s[12:15], s21 offen lds
    s_add_u32 m0, m0, 1056
    s_nop 0
    buffer_load_dwordx4 v26, s[12:15], s21 offen lds
    s_add_u32 m0, m0, 1056
    s_nop 0
    buffer_load_dwordx4 v27, s[12:15], s21 offen lds
    s_add_u32 s21, s21, 221184
    s_add_u32 s20, s20, 128
    s_add_u32 s24, s24, 1
    s_cmp_eq_u32 s24, 9
    s_cselect_b32 s25, 1152, 0
    s_cselect_b32 s26, 1990656, 0
    s_cselect_b32 s24, 0, s24
    s_sub_u32 s20, s20, s25
    s_sub_u32 s21, s21, s26
    s_waitcnt vmcnt(12)
    s_barrier
    s_add_u32 m0, s22, 0
    s_nop 0
    buffer_load_dwordx4 v16, s[8:11], s20 offen lds
    s_add_u32 m0, m0, 1024
    s_nop 0
    buffer_load_dwordx4 v17, s[8:11], s20 offen lds
    s_add_u32 m0, m0, 1024
    s_nop 0
    buffer_load_dwordx4 v18, s[8:11], s20 offen lds
    s_add_u32 m0, m0, 1024
    s_nop 0
    buffer_load_dwordx4 v19, s[8:11], s20 offen lds
    s_add_u32 m0, m0, 1024
    s_nop 0
    buffer_load_dwordx4 v20, s[8:11], s20 offen lds
    s_add_u32 m0, m0, 1024
    s_nop 0
    buffer_load_dwordx4 v21, s[8:11], s20 offen lds
    s_add_u32 m0, m0, 1024
    s_nop 0
    buffer_load_dwordx4 v22, s[8:11], s20 offen lds
    s_add_u32 m0, m0, 1024
    s_nop 0
    buffer_load_dwordx4 v23, s[8:11], s20 offen lds
    s_add_u32 m0, s23, 0
    s_nop 0
    buffer_load_dwordx4 v24, s[12:15], s21 offen lds
    s_add_u32 m0, m0, 1056
    s_nop 0
    buffer_load_dwordx4 v25, s[12:15], s21 offen lds
    s_add_u32 m0, m0, 1056
    s_nop 0
    buffer_load_dwordx4 v26, s[12:15], s21 offen lds
    s_add_u32 m0, m0, 1056
    s_nop 0
    buffer_load_dwordx4 v27, s[12:15], s21 offen lds
    s_add_u32 s21, s21, 221184
    s_add_u32 s20, s20, 128
    s_add_u32 s24, s24, 1
    s_cmp_eq_u32 s24, 9
    s_cselect_b32 s25, 1152, 0
    s_cselect_b32 s26, 1990656, 0
    s_cselect_b32 s24, 0, s24
    s_sub_u32 s20, s20, s25
    s_sub_u32 s21, s21, s26
    s_waitcnt vmcnt(12)
    s_barrier
    s_add_u32 m0, s22, 49664
    s_nop 0
    buffer_load_dwordx4 v16, s[8:11], s20 offen lds
    s_add_u32 m0, m0, 1024
    s_nop 0
    buffer_load_dwordx4 v17, s[8:11], s20 offen lds
    s_add_u32 m0, m0, 1024
    s_nop 0
    buffer_load_dwordx4 v18, s[8:11], s20 offen lds
    s_add_u32 m0, m0, 1024
    s_nop 0
    buffer_load_dwordx4 v19, s[8:11], s20 offen lds
    s_add_u32 m0, m0, 1024
    s_nop 0
    buffer_load_dwordx4 v20, s[8:11], s20 offen lds
    s_add_u32 m0, m0, 1024
    s_nop 0
    buffer_load_dwordx4 v21, s[8:11], s20 offen lds
    s_add_u32 m0, m0, 1024
    s_nop 0
    buffer_load_dwordx4 v22, s[8:11], s20 offen lds
    s_add_u32 m0, m0, 1024
    s_nop 0
    buffer_load_dwordx4 v23, s[8:11], s20 offen lds
    s_add_u32 m0, s23, 49664
    s_nop 0
    buffer_load_dwordx4 v24, s[12:15], s21 offen lds
    s_add_u32 m0, m0, 1056
    s_nop 0
    buffer_load_dwordx4 v25, s[12:15], s21 offen lds
    s_add_u32 m0, m0, 1056
    s_nop 0
    buffer_load_dwordx4 v26, s[12:15], s21 offen lds
    s_add_u32 m0, m0, 1056
    s_nop 0
    buffer_load_dwordx4 v27, s[12:15], s21 offen lds
    s_add_u32 s21, s21, 221184
    s_add_u32 s20, s20, 128
    s_add_u32 s24, s24, 1
    s_cmp_eq_u32 s24, 9
    s_cselect_b32 s25, 1152, 0
    s_cselect_b32 s26, 1990656, 0
    s_cselect_b32 s24, 0, s24
    s_sub_u32 s20, s20, s25
    s_sub_u32 s21, s21, s26
    s_waitcnt vmcnt(12)
    s_barrier
    s_add_u32 m0, s22, 99328
    s_nop 0
    buffer_load_dwordx4 v16, s[8:11], s20 offen lds
    s_add_u32 m0, m0, 1024
    s_nop 0
    buffer_load_dwordx4 v17, s[8:11], s20 offen lds
    s_add_u32 m0, m0, 1024
    s_nop 0
    buffer_load_dwordx4 v18, s[8:11], s20 offen lds
    s_add_u32 m0, m0, 1024
    s_nop 0
    buffer_load_dwordx4 v19, s[8:11], s20 offen lds
    s_add_u32 m0, m0, 1024
    s_nop 0
    buffer_load_dwordx4 v20, s[8:11], s20 offen lds
    s_add_u32 m0, m0, 1024
    s_nop 0
    buffer_load_dwordx4 v21, s[8:11], s20 offen lds
    s_add_u32 m0, m0, 1024
    s_nop 0
    buffer_load_dwordx4 v22, s[8:11], s20 offen lds
    s_add_u32 m0, m0, 1024
    s_nop 0
    buffer_load_dwordx4 v23, s[8:11], s20 offen lds
    s_add_u32 m0, s23, 99328
    s_nop 0
    buffer_load_dwordx4 v24, s[12:15], s21 offen lds
    s_add_u32 m0, m0, 1056
    s_nop 0
    buffer_load_dwordx4 v25, s[12:15], s21 offen lds
    s_add_u32 m0, m0, 1056
    s_nop 0
    buffer_load_dwordx4 v26, s[12:15], s21 offen lds
    s_add_u32 m0, m0, 1056
    s_nop 0
    buffer_load_dwordx4 v27, s[12:15], s21 offen lds
    s_add_u32 s21, s21, 221184
    s_add_u32 s20, s20, 128
    s_add_u32 s24, s24, 1
    s_cmp_eq_u32 s24, 9
    s_cselect_b32 s25, 1152, 0
    s_cselect_b32 s26, 1990656, 0
    s_cselect_b32 s24, 0, s24
    s_sub_u32 s20, s20, s25
    s_sub_u32 s21, s21, s26
    s_waitcnt vmcnt(12)
    s_barrier
    s_add_u32 m0, s22, 0
    s_nop 0
    buffer_load_dwordx4 v16, s[8:11], s20 offen lds
    s_add_u32 m0, m0, 1024
    s_nop 0
    buffer_load_dwordx4 v17, s[8:11], s20 offen lds
    s_add_u32 m0, m0, 1024
    s_nop 0
    buffer_load_dwordx4 v18, s[8:11], s20 offen lds
    s_add_u32 m0, m0, 1024
    s_nop 0
    buffer_load_dwordx4 v19, s[8:11], s20 offen lds
    s_add_u32 m0, m0, 1024
    s_nop 0
    buffer_load_dwordx4 v20, s[8:11], s20 offen lds
    s_add_u32 m0, m0, 1024
    s_nop 0
    buffer_load_dwordx4 v21, s[8:11], s20 offen lds
    s_add_u32 m0, m0, 1024
    s_nop 0
    buffer_load_dwordx4 v22, s[8:11], s20 offen lds
    s_add_u32 m0, m0, 1024
    s_nop 0
    buffer_load_dwordx4 v23, s[8:11], s20 offen lds
    s_add_u32 m0, s23, 0
    s_nop 0
    buffer_load_dwordx4 v24, s[12:15], s21 offen lds
    s_add_u32 m0, m0, 1056
    s_nop 0
    buffer_load_dwordx4 v25, s[12:15], s21 offen lds
    s_add_u32 m0, m0, 1056
    s_nop 0
    buffer_load_dwordx4 v26, s[12:15], s21 offen lds
    s_add_u32 m0, m0, 1056
    s_nop 0
    buffer_load_dwordx4 v27, s[12:15], s21 offen lds
    s_add_u32 s21, s21, 221184
    s_add_u32 s20, s20, 128
    s_add_u32 s24, s24, 1
    s_cmp_eq_u32 s24, 9
    s_cselect_b32 s25, 1152, 0
    s_cselect_b32 s26, 1990656, 0
    s_cselect_b32 s24, 0, s24
    s_sub_u32 s20, s20, s25
    s_sub_u32 s21, s21, s26
    s_waitcnt vmcnt(12)
    s_barrier
    s_add_u32 m0, s22, 49664
    s_nop 0
    buffer_load_dwordx4 v16, s[8:11], s20 offen lds
    s_add_u32 m0, m0, 1024
    s_nop 0
    buffer_load_dwordx4 v17, s[8:11], s20 offen lds
    s_add_u32 m0, m0, 1024
    s_nop 0
    buffer_load_dwordx4 v18, s[8:11], s20 offen lds
    s_add_u32 m0, m0, 1024
    s_nop 0
    buffer_load_dwordx4 v19, s[8:11], s20 offen lds
    s_add_u32 m0, m0, 1024
    s_nop 0
    buffer_load_dwordx4 v20, s[8:11], s20 offen lds
    s_add_u32 m0, m0, 1024
    s_nop 0
    buffer_load_dwordx4 v21, s[8:11], s20 offen lds
    s_add_u32 m0, m0, 1024
    s_nop 0
    buffer_load_dwordx4 v22, s[8:11], s20 offen lds
    s_add_u32 m0, m0, 1024
    s_nop 0
    buffer_load_dwordx4 v23, s[8:11], s20 offen lds
    s_add_u32 m0, s23, 49664
    s_nop 0
    buffer_load_dwordx4 v24, s[12:15], s21 offen lds
    s_add_u32 m0, m0, 1056
    s_nop 0
    buffer_load_dwordx4 v25, s[12:15], s21 offen lds
    s_add_u32 m0, m0, 1056
    s_nop 0
    buffer_load_dwordx4 v26, s[12:15], s21 offen lds
    s_add_u32 m0, m0, 1056
    s_nop 0
    buffer_load_dwordx4 v27, s[12:15], s21 offen lds
    s_add_u32 s21, s21, 221184
    s_add_u32 s20, s20, 128
    s_add_u32 s24, s24, 1
    s_cmp_eq_u32 s24, 9
    s_cselect_b32 s25, 1152, 0
    s_cselect_b32 s26, 1990656, 0
    s_cselect_b32 s24, 0, s24
    s_sub_u32 s20, s20, s25
    s_sub_u32 s21, s21, s26
    s_waitcnt vmcnt(12)
    s_barrier
    s_add_u32 m0, s22, 99328
    s_nop 0
    buffer_load_dwordx4 v16, s[8:11], s20 offen lds
    s_add_u32 m0, m0, 1024
    s_nop 0
    buffer_load_dwordx4 v17, s[8:11], s20 offen lds
    s_add_u32 m0, m0, 1024
    s_nop 0
    buffer_load_dwordx4 v18, s[8:11], s20 offen lds
    s_add_u32 m0, m0, 1024
    s_nop 0
    buffer_load_dwordx4 v19, s[8:11], s20 offen lds
    s_add_u32 m0, m0, 1024
    s_nop 0
    buffer_load_dwordx4 v20, s[8:11], s20 offen lds
    s_add_u32 m0, m0, 1024
    s_nop 0
    buffer_load_dwordx4 v21, s[8:11], s20 offen lds
    s_add_u32 m0, m0, 1024
    s_nop 0
    buffer_load_dwordx4 v22, s[8:11], s20 offen lds
    s_add_u32 m0, m0, 1024
    s_nop 0
    buffer_load_dwordx4 v23, s[8:11], s20 offen lds
    s_add_u32 m0, s23, 99328
    s_nop 0
    buffer_load_dwordx4 v24, s[12:15], s21 offen lds
    s_add_u32 m0, m0, 1056
    s_nop 0
    buffer_load_dwordx4 v25, s[12:15], s21 offen lds
    s_add_u32 m0, m0, 1056
    s_nop 0
    buffer_load_dwordx4 v26, s[12:15], s21 offen lds
    s_add_u32 m0, m0, 1056
    s_nop 0
    buffer_load_dwordx4 v27, s[12:15], s21 offen lds
    s_add_u32 s21, s21, 221184
    s_add_u32 s20, s20, 128
    s_add_u32 s24, s24, 1
    s_cmp_eq_u32 s24, 9
    s_cselect_b32 s25, 1152, 0
    s_cselect_b32 s26, 1990656, 0
    s_cselect_b32 s24, 0, s24
    s_sub_u32 s20, s20, s25
    s_sub_u32 s21, s21, s26
    s_waitcnt vmcnt(12)
    s_barrier
    s_waitcnt vmcnt(0)
    s_barrier
    s_branch L_p1_done
L_p1_compute:
    v_lshrrev_b32 v5, 1, v3
    v_xor_b32 v5, v5, v4
    v_lshlrev_b32 v5, 4, v5
    v_lshl_add_u32 v5, v3, 7, v5
    v_add_u32 v5, s37, v5
    v_xor_b32 v6, 64, v5
    v_add_u32 v28, 0, v5
    v_add_u32 v29, 0, v6
    v_add_u32 v30, 49664, v5
    v_add_u32 v31, 49664, v6
    v_add_u32 v32, 99328, v5
    v_add_u32 v33, 99328, v6
    v_lshrrev_b32 v5, 2, v3
    v_and_b32 v6, 1, v4
    v_lshl_add_u32 v5, v6, 2, v5
    v_mul_u32_u24 v5, 1056, v5
    v_lshrrev_b32 v6, 1, v4
    v_lshl_add_u32 v5, v6, 9, v5
    v_and_b32 v6, 3, v3
    v_lshl_add_u32 v5, v6, 3, v5
    v_add_u32 v34, 32768, v5
    v_add_u32 v35, 82432, v5
    v_add_u32 v36, 132096, v5
    s_mov_b32 s16, s80
    s_mov_b32 s17, s81
    s_mov_b32 s18, 20971520
    s_mov_b32 s19, 0x00020000
    s_mul_i32 s39, s32, 14848
    s_mul_i32 s40, s35, 6
    v_mul_u32_u24 v5, 232, v3
    v_lshl_add_u32 v5, v4, 3, v5
    v_add_u32 v2, s39, v5
    v_and_b32 v6, 31, v0
    v_lshrrev_b32 v7, 5, v0
    v_mul_u32_u24 v8, 232, v6
    v_lshl_add_u32 v8, v7, 4, v8
    v_add_u32 v8, s39, v8
    v_add_u32 v240, 7424, v8
    v_lshlrev_b32 v9, 4, v0
    v_mul_u32_u24 v10, 232, v0
    v_add_u32 v10, s39, v10
    v_lshlrev_b32 v11, 3, v0
    v_lshrrev_b32 v12, 1, v4
    v_lshrrev_b32 v13, 2, v3
    v_lshl_add_u32 v13, v12, 3, v13
    v_mul_u32_u24 v13, 232, v13
    v_add_u32 v13, s39, v13
    v_and_b32 v14, 1, v4
    v_and_b32 v15, 3, v3
    v_lshlrev_b32 v15, 3, v15
    v_mul_u32_u24 v12, 288, v12
    s_lshr_b32 s42, s38, 5
    s_lshl_b32 s42, s42, 10
    s_lshl_b32 s43, s38, 3
    s_lshr_b32 s27, s38, 4
    s_mul_i32 s27, s27, 576
    s_sub_u32 s41, 32, s40
    s_cmp_lt_u32 s40, 32
    s_cselect_b32 s41, s41, 0
    s_lshr_b32 s41, s41, 1
    s_mul_i32 s41, s41, 9
    s_mov_b32 s28, 1051597459
    v_cmp_eq_u32 vcc, 0, v14
    v_add_u32 v242, 0, v15
    v_mov_b32 v17, 32
    v_cndmask_b32 v242, v17, v242, vcc
    v_add_u32 v242, v242, v13
    v_add_u32 v243, 40, v15
    v_mov_b32 v17, 32
    v_cndmask_b32 v243, v17, v243, vcc
    v_add_u32 v243, v243, v13
    v_add_u32 v244, 72, v15
    v_mov_b32 v17, 104
    v_cndmask_b32 v244, v17, v244, vcc
    v_add_u32 v244, v244, v13
    v_add_u32 v245, 112, v15
    v_mov_b32 v17, 104
    v_cndmask_b32 v245, v17, v245, vcc
    v_add_u32 v245, v245, v13
    v_add_u32 v246, 144, v15
    v_mov_b32 v17, 176
    v_cndmask_b32 v246, v17, v246, vcc
    v_add_u32 v246, v246, v13
    v_add_u32 v247, 184, v15
    v_mov_b32 v17, 176
    v_cndmask_b32 v247, v17, v247, vcc
    v_add_u32 v247, v247, v13
    v_add_u32 v17, 16, v3
    v_cndmask_b32 v17, v17, v3, vcc
    v_lshl_add_u32 v250, v17, 4, v12
    v_add_u32 v17, 14, v3
    v_cndmask_b32 v17, v17, v3, vcc
    v_lshl_add_u32 v251, v17, 4, v12
    s_add_u32 s46, s40, 0
    s_lshr_b32 s20, s46, 5
    s_and_b32 s46, s46, 31
    s_lshl_b32 s47, s33, 5
    s_add_u32 s47, s47, s46
    s_lshl_b32 s52, s47, 16
    s_lshl_b32 s46, s20, 22
    s_add_u32 s52, s52, s46
    s_add_u32 s52, s52, s42
    s_mul_i32 s46, s47, 73728
    s_add_u32 s46, s46, s27
    s_add_u32 s46, s46, 8388608
    s_cmp_eq_u32 s20, 2
    s_cselect_b32 s52, s46, s52
    s_lshr_b32 s48, s47, 1
    s_lshl_b32 s48, s48, 14
    s_add_u32 s48, s48, s43
    s_lshl_b32 s46, s20, 19
    s_add_u32 s48, s48, s46
    s_add_u32 s48, s48, 13631488
    s_add_u32 s46, s40, 1
    s_lshr_b32 s21, s46, 5
    s_and_b32 s46, s46, 31
    s_lshl_b32 s47, s33, 5
    s_add_u32 s47, s47, s46
    s_lshl_b32 s53, s47, 16
    s_lshl_b32 s46, s21, 22
    s_add_u32 s53, s53, s46
    s_add_u32 s53, s53, s42
    s_mul_i32 s46, s47, 73728
    s_add_u32 s46, s46, s27
    s_add_u32 s46, s46, 8388608
    s_cmp_eq_u32 s21, 2
    s_cselect_b32 s53, s46, s53
    s_add_u32 s46, s40, 2
    s_lshr_b32 s22, s46, 5
    s_and_b32 s46, s46, 31
    s_lshl_b32 s47, s33, 5
    s_add_u32 s47, s47, s46
    s_lshl_b32 s54, s47, 16
    s_lshl_b32 s46, s22, 22
    s_add_u32 s54, s54, s46
    s_add_u32 s54, s54, s42
    s_mul_i32 s46, s47, 73728
    s_add_u32 s46, s46, s27
    s_add_u32 s46, s46, 8388608
    s_cmp_eq_u32 s22, 2
    s_cselect_b32 s54, s46, s54
    s_lshr_b32 s49, s47, 1
    s_lshl_b32 s49, s49, 14
    s_add_u32 s49, s49, s43
    s_lshl_b32 s46, s22, 19
    s_add_u32 s49, s49, s46
    s_add_u32 s49, s49, 13631488
    s_add_u32 s46, s40, 3
    s_lshr_b32 s23, s46, 5
    s_and_b32 s46, s46, 31
    s_lshl_b32 s47, s33, 5
    s_add_u32 s47, s47, s46
    s_lshl_b32 s55, s47, 16
    s_lshl_b32 s46, s23, 22
    s_add_u32 s55, s55, s46
    s_add_u32 s55, s55, s42
    s_mul_i32 s46, s47, 73728
    s_add_u32 s46, s46, s27
    s_add_u32 s46, s46, 8388608
    s_cmp_eq_u32 s23, 2
    s_cselect_b32 s55, s46, s55
    s_add_u32 s46, s40, 4
    s_lshr_b32 s24, s46, 5
    s_and_b32 s46, s46, 31
    s_lshl_b32 s47, s33, 5
    s_add_u32 s47, s47, s46
    s_lshl_b32 s56, s47, 16
    s_lshl_b32 s46, s24, 22
    s_add_u32 s56, s56, s46
    s_add_u32 s56, s56, s42
    s_mul_i32 s46, s47, 73728
    s_add_u32 s46, s46, s27
    s_add_u32 s46, s46, 8388608
    s_cmp_eq_u32 s24, 2
    s_cselect_b32 s56, s46, s56
    s_lshr_b32 s50, s47, 1
    s_lshl_b32 s50, s50, 14
    s_add_u32 s50, s50, s43
    s_lshl_b32 s46, s24, 19
    s_add_u32 s50, s50, s46
    s_add_u32 s50, s50, 13631488
    s_add_u32 s46, s40, 5
    s_lshr_b32 s25, s46, 5
    s_and_b32 s46, s46, 31
    s_lshl_b32 s47, s33, 5
    s_add_u32 s47, s47, s46
    s_lshl_b32 s57, s47, 16
    s_lshl_b32 s46, s25, 22
    s_add_u32 s57, s57, s46
    s_add_u32 s57, s57, s42
    s_mul_i32 s46, s47, 73728
    s_add_u32 s46, s46, s27
    s_add_u32 s46, s46, 8388608
    s_cmp_eq_u32 s25, 2
    s_cselect_b32 s57, s46, s57
    s_barrier
    ds_read_b128 v[40:43], v28 offset:0
    ds_read_b64_tr_b16 v[72:73], v34 offset:0
    ds_read_b64_tr_b16 v[74:75], v34 offset:256
    ds_read_b128 v[44:47], v28 offset:2048
    ds_read_b64_tr_b16 v[76:77], v34 offset:32
    ds_read_b64_tr_b16 v[78:79], v34 offset:288
    ds_read_b128 v[48:51], v28 offset:4096
    ds_read_b64_tr_b16 v[80:81], v34 offset:64
    ds_read_b64_tr_b16 v[82:83], v34 offset:320
    ds_read_b128 v[52:55], v28 offset:6144
    ds_read_b64_tr_b16 v[84:85], v34 offset:96
    ds_read_b64_tr_b16 v[86:87], v34 offset:352
    ds_read_b64_tr_b16 v[88:89], v34 offset:128
    ds_read_b64_tr_b16 v[90:91], v34 offset:384
    ds_read_b64_tr_b16 v[92:93], v34 offset:160
    ds_read_b64_tr_b16 v[94:95], v34 offset:416
    ds_read_b64_tr_b16 v[96:97], v34 offset:192
    ds_read_b64_tr_b16 v[98:99], v34 offset:448
    s_waitcnt lgkmcnt(0)
    v_mfma_f32_16x16x32_bf16 v[128:131], v[72:75], v[40:43], 0
    ds_read_b128 v[56:59], v29 offset:0
    v_mfma_f32_16x16x32_bf16 v[132:135], v[72:75], v[44:47], 0
    ds_read_b64_tr_b16 v[100:101], v34 offset:8448
    v_mfma_f32_16x16x32_bf16 v[136:139], v[72:75], v[48:51], 0
    ds_read_b64_tr_b16 v[102:103], v34 offset:8704
    v_mfma_f32_16x16x32_bf16 v[140:143], v[72:75], v[52:55], 0
    ds_read_b128 v[60:63], v29 offset:2048
    v_mfma_f32_16x16x32_bf16 v[144:147], v[76:79], v[40:43], 0
    ds_read_b64_tr_b16 v[104:105], v34 offset:8480
    v_mfma_f32_16x16x32_bf16 v[148:151], v[76:79], v[44:47], 0
    ds_read_b64_tr_b16 v[106:107], v34 offset:8736
    v_mfma_f32_16x16x32_bf16 v[152:155], v[76:79], v[48:51], 0
    ds_read_b128 v[64:67], v29 offset:4096
    v_mfma_f32_16x16x32_bf16 v[156:159], v[76:79], v[52:55], 0
    ds_read_b64_tr_b16 v[108:109], v34 offset:8512
    v_mfma_f32_16x16x32_bf16 v[160:163], v[80:83], v[40:43], 0
    ds_read_b64_tr_b16 v[110:111], v34 offset:8768
    v_mfma_f32_16x16x32_bf16 v[164:167], v[80:83], v[44:47], 0
    ds_read_b128 v[68:71], v29 offset:6144
    v_mfma_f32_16x16x32_bf16 v[168:171], v[80:83], v[48:51], 0
    ds_read_b64_tr_b16 v[112:113], v34 offset:8544
    v_mfma_f32_16x16x32_bf16 v[172:175], v[80:83], v[52:55], 0
    ds_read_b64_tr_b16 v[114:115], v34 offset:8800
    v_mfma_f32_16x16x32_bf16 v[176:179], v[84:87], v[40:43], 0
    ds_read_b64_tr_b16 v[116:117], v34 offset:8576
    v_mfma_f32_16x16x32_bf16 v[180:183], v[84:87], v[44:47], 0
    ds_read_b64_tr_b16 v[118:119], v34 offset:8832
    v_mfma_f32_16x16x32_bf16 v[184:187], v[84:87], v[48:51], 0
    ds_read_b64_tr_b16 v[120:121], v34 offset:8608
    v_mfma_f32_16x16x32_bf16 v[188:191], v[84:87], v[52:55], 0
    ds_read_b64_tr_b16 v[122:123], v34 offset:8864
    v_mfma_f32_16x16x32_bf16 v[192:195], v[88:91], v[40:43], 0
    ds_read_b64_tr_b16 v[124:125], v34 offset:8640
    v_mfma_f32_16x16x32_bf16 v[196:199], v[88:91], v[44:47], 0
    ds_read_b64_tr_b16 v[126:127], v34 offset:8896
    v_mfma_f32_16x16x32_bf16 v[200:203], v[88:91], v[48:51], 0
    v_mfma_f32_16x16x32_bf16 v[204:207], v[88:91], v[52:55], 0
    v_mfma_f32_16x16x32_bf16 v[208:211], v[92:95], v[40:43], 0
    v_mfma_f32_16x16x32_bf16 v[212:215], v[92:95], v[44:47], 0
    v_mfma_f32_16x16x32_bf16 v[216:219], v[92:95], v[48:51], 0
    v_mfma_f32_16x16x32_bf16 v[220:223], v[92:95], v[52:55], 0
    v_mfma_f32_16x16x32_bf16 v[224:227], v[96:99], v[40:43], 0
    v_mfma_f32_16x16x32_bf16 v[228:231], v[96:99], v[44:47], 0
    v_mfma_f32_16x16x32_bf16 v[232:235], v[96:99], v[48:51], 0
    v_mfma_f32_16x16x32_bf16 v[236:239], v[96:99], v[52:55], 0
    s_waitcnt lgkmcnt(0)
    s_barrier
    v_mfma_f32_16x16x32_bf16 v[128:131], v[100:103], v[56:59], v[128:131]
    ds_read_b128 v[40:43], v30 offset:0
    v_mfma_f32_16x16x32_bf16 v[132:135], v[100:103], v[60:63], v[132:135]
    ds_read_b64_tr_b16 v[72:73], v35 offset:0
    v_mfma_f32_16x16x32_bf16 v[136:139], v[100:103], v[64:67], v[136:139]
    ds_read_b64_tr_b16 v[74:75], v35 offset:256
    v_mfma_f32_16x16x32_bf16 v[140:143], v[100:103], v[68:71], v[140:143]
    ds_read_b128 v[44:47], v30 offset:2048
    v_mfma_f32_16x16x32_bf16 v[144:147], v[104:107], v[56:59], v[144:147]
    ds_read_b64_tr_b16 v[76:77], v35 offset:32
    v_mfma_f32_16x16x32_bf16 v[148:151], v[104:107], v[60:63], v[148:151]
    ds_read_b64_tr_b16 v[78:79], v35 offset:288
    v_mfma_f32_16x16x32_bf16 v[152:155], v[104:107], v[64:67], v[152:155]
    ds_read_b128 v[48:51], v30 offset:4096
    v_mfma_f32_16x16x32_bf16 v[156:159], v[104:107], v[68:71], v[156:159]
    ds_read_b64_tr_b16 v[80:81], v35 offset:64
    v_mfma_f32_16x16x32_bf16 v[160:163], v[108:111], v[56:59], v[160:163]
    ds_read_b64_tr_b16 v[82:83], v35 offset:320
    v_mfma_f32_16x16x32_bf16 v[164:167], v[108:111], v[60:63], v[164:167]
    ds_read_b128 v[52:55], v30 offset:6144
    v_mfma_f32_16x16x32_bf16 v[168:171], v[108:111], v[64:67], v[168:171]
    ds_read_b64_tr_b16 v[84:85], v35 offset:96
    v_mfma_f32_16x16x32_bf16 v[172:175], v[108:111], v[68:71], v[172:175]
    ds_read_b64_tr_b16 v[86:87], v35 offset:352
    v_mfma_f32_16x16x32_bf16 v[176:179], v[112:115], v[56:59], v[176:179]
    ds_read_b64_tr_b16 v[88:89], v35 offset:128
    v_mfma_f32_16x16x32_bf16 v[180:183], v[112:115], v[60:63], v[180:183]
    ds_read_b64_tr_b16 v[90:91], v35 offset:384
    v_mfma_f32_16x16x32_bf16 v[184:187], v[112:115], v[64:67], v[184:187]
    ds_read_b64_tr_b16 v[92:93], v35 offset:160
    v_mfma_f32_16x16x32_bf16 v[188:191], v[112:115], v[68:71], v[188:191]
    ds_read_b64_tr_b16 v[94:95], v35 offset:416
    v_mfma_f32_16x16x32_bf16 v[192:195], v[116:119], v[56:59], v[192:195]
    ds_read_b64_tr_b16 v[96:97], v35 offset:192
    v_mfma_f32_16x16x32_bf16 v[196:199], v[116:119], v[60:63], v[196:199]
    ds_read_b64_tr_b16 v[98:99], v35 offset:448
    v_mfma_f32_16x16x32_bf16 v[200:203], v[116:119], v[64:67], v[200:203]
    v_mfma_f32_16x16x32_bf16 v[204:207], v[116:119], v[68:71], v[204:207]
    v_mfma_f32_16x16x32_bf16 v[208:211], v[120:123], v[56:59], v[208:211]
    v_mfma_f32_16x16x32_bf16 v[212:215], v[120:123], v[60:63], v[212:215]
    v_mfma_f32_16x16x32_bf16 v[216:219], v[120:123], v[64:67], v[216:219]
    v_mfma_f32_16x16x32_bf16 v[220:223], v[120:123], v[68:71], v[220:223]
    v_mfma_f32_16x16x32_bf16 v[224:227], v[124:127], v[56:59], v[224:227]
    v_mfma_f32_16x16x32_bf16 v[228:231], v[124:127], v[60:63], v[228:231]
    v_mfma_f32_16x16x32_bf16 v[232:235], v[124:127], v[64:67], v[232:235]
    v_mfma_f32_16x16x32_bf16 v[236:239], v[124:127], v[68:71], v[236:239]
    s_waitcnt lgkmcnt(0)
    v_mfma_f32_16x16x32_bf16 v[128:131], v[72:75], v[40:43], v[128:131]
    ds_read_b128 v[56:59], v31 offset:0
    v_mfma_f32_16x16x32_bf16 v[132:135], v[72:75], v[44:47], v[132:135]
    ds_read_b64_tr_b16 v[100:101], v35 offset:8448
    v_mfma_f32_16x16x32_bf16 v[136:139], v[72:75], v[48:51], v[136:139]
    ds_read_b64_tr_b16 v[102:103], v35 offset:8704
    v_mfma_f32_16x16x32_bf16 v[140:143], v[72:75], v[52:55], v[140:143]
    ds_read_b128 v[60:63], v31 offset:2048
    v_mfma_f32_16x16x32_bf16 v[144:147], v[76:79], v[40:43], v[144:147]
    ds_read_b64_tr_b16 v[104:105], v35 offset:8480
    v_mfma_f32_16x16x32_bf16 v[148:151], v[76:79], v[44:47], v[148:151]
    ds_read_b64_tr_b16 v[106:107], v35 offset:8736
    v_mfma_f32_16x16x32_bf16 v[152:155], v[76:79], v[48:51], v[152:155]
    ds_read_b128 v[64:67], v31 offset:4096
    v_mfma_f32_16x16x32_bf16 v[156:159], v[76:79], v[52:55], v[156:159]
    ds_read_b64_tr_b16 v[108:109], v35 offset:8512
    v_mfma_f32_16x16x32_bf16 v[160:163], v[80:83], v[40:43], v[160:163]
    ds_read_b64_tr_b16 v[110:111], v35 offset:8768
    v_mfma_f32_16x16x32_bf16 v[164:167], v[80:83], v[44:47], v[164:167]
    ds_read_b128 v[68:71], v31 offset:6144
    v_mfma_f32_16x16x32_bf16 v[168:171], v[80:83], v[48:51], v[168:171]
    ds_read_b64_tr_b16 v[112:113], v35 offset:8544
    v_mfma_f32_16x16x32_bf16 v[172:175], v[80:83], v[52:55], v[172:175]
    ds_read_b64_tr_b16 v[114:115], v35 offset:8800
    v_mfma_f32_16x16x32_bf16 v[176:179], v[84:87], v[40:43], v[176:179]
    ds_read_b64_tr_b16 v[116:117], v35 offset:8576
    v_mfma_f32_16x16x32_bf16 v[180:183], v[84:87], v[44:47], v[180:183]
    ds_read_b64_tr_b16 v[118:119], v35 offset:8832
    v_mfma_f32_16x16x32_bf16 v[184:187], v[84:87], v[48:51], v[184:187]
    ds_read_b64_tr_b16 v[120:121], v35 offset:8608
    v_mfma_f32_16x16x32_bf16 v[188:191], v[84:87], v[52:55], v[188:191]
    ds_read_b64_tr_b16 v[122:123], v35 offset:8864
    v_mfma_f32_16x16x32_bf16 v[192:195], v[88:91], v[40:43], v[192:195]
    ds_read_b64_tr_b16 v[124:125], v35 offset:8640
    v_mfma_f32_16x16x32_bf16 v[196:199], v[88:91], v[44:47], v[196:199]
    ds_read_b64_tr_b16 v[126:127], v35 offset:8896
    v_mfma_f32_16x16x32_bf16 v[200:203], v[88:91], v[48:51], v[200:203]
    v_mfma_f32_16x16x32_bf16 v[204:207], v[88:91], v[52:55], v[204:207]
    v_mfma_f32_16x16x32_bf16 v[208:211], v[92:95], v[40:43], v[208:211]
    v_mfma_f32_16x16x32_bf16 v[212:215], v[92:95], v[44:47], v[212:215]
    v_mfma_f32_16x16x32_bf16 v[216:219], v[92:95], v[48:51], v[216:219]
    v_mfma_f32_16x16x32_bf16 v[220:223], v[92:95], v[52:55], v[220:223]
    v_mfma_f32_16x16x32_bf16 v[224:227], v[96:99], v[40:43], v[224:227]
    v_mfma_f32_16x16x32_bf16 v[228:231], v[96:99], v[44:47], v[228:231]
    v_mfma_f32_16x16x32_bf16 v[232:235], v[96:99], v[48:51], v[232:235]
    v_mfma_f32_16x16x32_bf16 v[236:239], v[96:99], v[52:55], v[236:239]
    s_waitcnt lgkmcnt(0)
    s_barrier
    v_mfma_f32_16x16x32_bf16 v[128:131], v[100:103], v[56:59], v[128:131]
    ds_read_b128 v[40:43], v32 offset:0
    v_mfma_f32_16x16x32_bf16 v[132:135], v[100:103], v[60:63], v[132:135]
    ds_read_b64_tr_b16 v[72:73], v36 offset:0
    v_mfma_f32_16x16x32_bf16 v[136:139], v[100:103], v[64:67], v[136:139]
    ds_read_b64_tr_b16 v[74:75], v36 offset:256
    v_mfma_f32_16x16x32_bf16 v[140:143], v[100:103], v[68:71], v[140:143]
    ds_read_b128 v[44:47], v32 offset:2048
    v_mfma_f32_16x16x32_bf16 v[144:147], v[104:107], v[56:59], v[144:147]
    ds_read_b64_tr_b16 v[76:77], v36 offset:32
    v_mfma_f32_16x16x32_bf16 v[148:151], v[104:107], v[60:63], v[148:151]
    ds_read_b64_tr_b16 v[78:79], v36 offset:288
    v_mfma_f32_16x16x32_bf16 v[152:155], v[104:107], v[64:67], v[152:155]
    ds_read_b128 v[48:51], v32 offset:4096
    v_mfma_f32_16x16x32_bf16 v[156:159], v[104:107], v[68:71], v[156:159]
    ds_read_b64_tr_b16 v[80:81], v36 offset:64
    v_mfma_f32_16x16x32_bf16 v[160:163], v[108:111], v[56:59], v[160:163]
    ds_read_b64_tr_b16 v[82:83], v36 offset:320
    v_mfma_f32_16x16x32_bf16 v[164:167], v[108:111], v[60:63], v[164:167]
    ds_read_b128 v[52:55], v32 offset:6144
    v_mfma_f32_16x16x32_bf16 v[168:171], v[108:111], v[64:67], v[168:171]
    ds_read_b64_tr_b16 v[84:85], v36 offset:96
    v_mfma_f32_16x16x32_bf16 v[172:175], v[108:111], v[68:71], v[172:175]
    ds_read_b64_tr_b16 v[86:87], v36 offset:352
    v_mfma_f32_16x16x32_bf16 v[176:179], v[112:115], v[56:59], v[176:179]
    ds_read_b64_tr_b16 v[88:89], v36 offset:128
    v_mfma_f32_16x16x32_bf16 v[180:183], v[112:115], v[60:63], v[180:183]
    ds_read_b64_tr_b16 v[90:91], v36 offset:384
    v_mfma_f32_16x16x32_bf16 v[184:187], v[112:115], v[64:67], v[184:187]
    ds_read_b64_tr_b16 v[92:93], v36 offset:160
    v_mfma_f32_16x16x32_bf16 v[188:191], v[112:115], v[68:71], v[188:191]
    ds_read_b64_tr_b16 v[94:95], v36 offset:416
    v_mfma_f32_16x16x32_bf16 v[192:195], v[116:119], v[56:59], v[192:195]
    ds_read_b64_tr_b16 v[96:97], v36 offset:192
    v_mfma_f32_16x16x32_bf16 v[196:199], v[116:119], v[60:63], v[196:199]
    ds_read_b64_tr_b16 v[98:99], v36 offset:448
    v_mfma_f32_16x16x32_bf16 v[200:203], v[116:119], v[64:67], v[200:203]
    v_mfma_f32_16x16x32_bf16 v[204:207], v[116:119], v[68:71], v[204:207]
    v_mfma_f32_16x16x32_bf16 v[208:211], v[120:123], v[56:59], v[208:211]
    v_mfma_f32_16x16x32_bf16 v[212:215], v[120:123], v[60:63], v[212:215]
    v_mfma_f32_16x16x32_bf16 v[216:219], v[120:123], v[64:67], v[216:219]
    v_mfma_f32_16x16x32_bf16 v[220:223], v[120:123], v[68:71], v[220:223]
    v_mfma_f32_16x16x32_bf16 v[224:227], v[124:127], v[56:59], v[224:227]
    v_mfma_f32_16x16x32_bf16 v[228:231], v[124:127], v[60:63], v[228:231]
    v_mfma_f32_16x16x32_bf16 v[232:235], v[124:127], v[64:67], v[232:235]
    v_mfma_f32_16x16x32_bf16 v[236:239], v[124:127], v[68:71], v[236:239]
    s_waitcnt lgkmcnt(0)
    v_mfma_f32_16x16x32_bf16 v[128:131], v[72:75], v[40:43], v[128:131]
    ds_read_b128 v[56:59], v33 offset:0
    v_mfma_f32_16x16x32_bf16 v[132:135], v[72:75], v[44:47], v[132:135]
    ds_read_b64_tr_b16 v[100:101], v36 offset:8448
    v_mfma_f32_16x16x32_bf16 v[136:139], v[72:75], v[48:51], v[136:139]
    ds_read_b64_tr_b16 v[102:103], v36 offset:8704
    v_mfma_f32_16x16x32_bf16 v[140:143], v[72:75], v[52:55], v[140:143]
    ds_read_b128 v[60:63], v33 offset:2048
    v_mfma_f32_16x16x32_bf16 v[144:147], v[76:79], v[40:43], v[144:147]
    ds_read_b64_tr_b16 v[104:105], v36 offset:8480
    v_mfma_f32_16x16x32_bf16 v[148:151], v[76:79], v[44:47], v[148:151]
    ds_read_b64_tr_b16 v[106:107], v36 offset:8736
    v_mfma_f32_16x16x32_bf16 v[152:155], v[76:79], v[48:51], v[152:155]
    ds_read_b128 v[64:67], v33 offset:4096
    v_mfma_f32_16x16x32_bf16 v[156:159], v[76:79], v[52:55], v[156:159]
    ds_read_b64_tr_b16 v[108:109], v36 offset:8512
    v_mfma_f32_16x16x32_bf16 v[160:163], v[80:83], v[40:43], v[160:163]
    ds_read_b64_tr_b16 v[110:111], v36 offset:8768
    v_mfma_f32_16x16x32_bf16 v[164:167], v[80:83], v[44:47], v[164:167]
    ds_read_b128 v[68:71], v33 offset:6144
    v_mfma_f32_16x16x32_bf16 v[168:171], v[80:83], v[48:51], v[168:171]
    ds_read_b64_tr_b16 v[112:113], v36 offset:8544
    v_mfma_f32_16x16x32_bf16 v[172:175], v[80:83], v[52:55], v[172:175]
    ds_read_b64_tr_b16 v[114:115], v36 offset:8800
    v_mfma_f32_16x16x32_bf16 v[176:179], v[84:87], v[40:43], v[176:179]
    ds_read_b64_tr_b16 v[116:117], v36 offset:8576
    v_mfma_f32_16x16x32_bf16 v[180:183], v[84:87], v[44:47], v[180:183]
    ds_read_b64_tr_b16 v[118:119], v36 offset:8832
    v_mfma_f32_16x16x32_bf16 v[184:187], v[84:87], v[48:51], v[184:187]
    ds_read_b64_tr_b16 v[120:121], v36 offset:8608
    v_mfma_f32_16x16x32_bf16 v[188:191], v[84:87], v[52:55], v[188:191]
    ds_read_b64_tr_b16 v[122:123], v36 offset:8864
    v_mfma_f32_16x16x32_bf16 v[192:195], v[88:91], v[40:43], v[192:195]
    ds_read_b64_tr_b16 v[124:125], v36 offset:8640
    v_mfma_f32_16x16x32_bf16 v[196:199], v[88:91], v[44:47], v[196:199]
    ds_read_b64_tr_b16 v[126:127], v36 offset:8896
    v_mfma_f32_16x16x32_bf16 v[200:203], v[88:91], v[48:51], v[200:203]
    v_mfma_f32_16x16x32_bf16 v[204:207], v[88:91], v[52:55], v[204:207]
    v_mfma_f32_16x16x32_bf16 v[208:211], v[92:95], v[40:43], v[208:211]
    v_mfma_f32_16x16x32_bf16 v[212:215], v[92:95], v[44:47], v[212:215]
    v_mfma_f32_16x16x32_bf16 v[216:219], v[92:95], v[48:51], v[216:219]
    v_mfma_f32_16x16x32_bf16 v[220:223], v[92:95], v[52:55], v[220:223]
    v_mfma_f32_16x16x32_bf16 v[224:227], v[96:99], v[40:43], v[224:227]
    v_mfma_f32_16x16x32_bf16 v[228:231], v[96:99], v[44:47], v[228:231]
    v_mfma_f32_16x16x32_bf16 v[232:235], v[96:99], v[48:51], v[232:235]
    v_mfma_f32_16x16x32_bf16 v[236:239], v[96:99], v[52:55], v[236:239]
    s_waitcnt lgkmcnt(0)
    s_barrier
    v_mfma_f32_16x16x32_bf16 v[128:131], v[100:103], v[56:59], v[128:131]
    ds_read_b128 v[40:43], v28 offset:0
    v_mfma_f32_16x16x32_bf16 v[132:135], v[100:103], v[60:63], v[132:135]
    ds_read_b64_tr_b16 v[72:73], v34 offset:0
    v_mfma_f32_16x16x32_bf16 v[136:139], v[100:103], v[64:67], v[136:139]
    ds_read_b64_tr_b16 v[74:75], v34 offset:256
    v_mfma_f32_16x16x32_bf16 v[140:143], v[100:103], v[68:71], v[140:143]
    ds_read_b128 v[44:47], v28 offset:2048
    v_mfma_f32_16x16x32_bf16 v[144:147], v[104:107], v[56:59], v[144:147]
    ds_read_b64_tr_b16 v[76:77], v34 offset:32
    v_mfma_f32_16x16x32_bf16 v[148:151], v[104:107], v[60:63], v[148:151]
    ds_read_b64_tr_b16 v[78:79], v34 offset:288
    v_mfma_f32_16x16x32_bf16 v[152:155], v[104:107], v[64:67], v[152:155]
    ds_read_b128 v[48:51], v28 offset:4096
    v_mfma_f32_16x16x32_bf16 v[156:159], v[104:107], v[68:71], v[156:159]
    ds_read_b64_tr_b16 v[80:81], v34 offset:64
    v_mfma_f32_16x16x32_bf16 v[160:163], v[108:111], v[56:59], v[160:163]
    ds_read_b64_tr_b16 v[82:83], v34 offset:320
    v_mfma_f32_16x16x32_bf16 v[164:167], v[108:111], v[60:63], v[164:167]
    ds_read_b128 v[52:55], v28 offset:6144
    v_mfma_f32_16x16x32_bf16 v[168:171], v[108:111], v[64:67], v[168:171]
    ds_read_b64_tr_b16 v[84:85], v34 offset:96
    v_mfma_f32_16x16x32_bf16 v[172:175], v[108:111], v[68:71], v[172:175]
    ds_read_b64_tr_b16 v[86:87], v34 offset:352
    v_mfma_f32_16x16x32_bf16 v[176:179], v[112:115], v[56:59], v[176:179]
    ds_read_b64_tr_b16 v[88:89], v34 offset:128
    v_mfma_f32_16x16x32_bf16 v[180:183], v[112:115], v[60:63], v[180:183]
    ds_read_b64_tr_b16 v[90:91], v34 offset:384
    v_mfma_f32_16x16x32_bf16 v[184:187], v[112:115], v[64:67], v[184:187]
    ds_read_b64_tr_b16 v[92:93], v34 offset:160
    v_mfma_f32_16x16x32_bf16 v[188:191], v[112:115], v[68:71], v[188:191]
    ds_read_b64_tr_b16 v[94:95], v34 offset:416
    v_mfma_f32_16x16x32_bf16 v[192:195], v[116:119], v[56:59], v[192:195]
    ds_read_b64_tr_b16 v[96:97], v34 offset:192
    v_mfma_f32_16x16x32_bf16 v[196:199], v[116:119], v[60:63], v[196:199]
    ds_read_b64_tr_b16 v[98:99], v34 offset:448
    v_mfma_f32_16x16x32_bf16 v[200:203], v[116:119], v[64:67], v[200:203]
    v_mfma_f32_16x16x32_bf16 v[204:207], v[116:119], v[68:71], v[204:207]
    v_mfma_f32_16x16x32_bf16 v[208:211], v[120:123], v[56:59], v[208:211]
    v_mfma_f32_16x16x32_bf16 v[212:215], v[120:123], v[60:63], v[212:215]
    v_mfma_f32_16x16x32_bf16 v[216:219], v[120:123], v[64:67], v[216:219]
    v_mfma_f32_16x16x32_bf16 v[220:223], v[120:123], v[68:71], v[220:223]
    v_mfma_f32_16x16x32_bf16 v[224:227], v[124:127], v[56:59], v[224:227]
    v_mfma_f32_16x16x32_bf16 v[228:231], v[124:127], v[60:63], v[228:231]
    v_mfma_f32_16x16x32_bf16 v[232:235], v[124:127], v[64:67], v[232:235]
    v_mfma_f32_16x16x32_bf16 v[236:239], v[124:127], v[68:71], v[236:239]
    s_waitcnt lgkmcnt(0)
    v_mov_b32 v254, 0
    global_load_dword v255, v254, s[78:79] sc1
    v_mfma_f32_16x16x32_bf16 v[128:131], v[72:75], v[40:43], v[128:131]
    ds_read_b128 v[56:59], v29 offset:0
    v_mfma_f32_16x16x32_bf16 v[132:135], v[72:75], v[44:47], v[132:135]
    ds_read_b64_tr_b16 v[100:101], v34 offset:8448
    v_mfma_f32_16x16x32_bf16 v[136:139], v[72:75], v[48:51], v[136:139]
    ds_read_b64_tr_b16 v[102:103], v34 offset:8704
    v_mfma_f32_16x16x32_bf16 v[140:143], v[72:75], v[52:55], v[140:143]
    ds_read_b128 v[60:63], v29 offset:2048
    v_mfma_f32_16x16x32_bf16 v[144:147], v[76:79], v[40:43], v[144:147]
    ds_read_b64_tr_b16 v[104:105], v34 offset:8480
    v_mfma_f32_16x16x32_bf16 v[148:151], v[76:79], v[44:47], v[148:151]
    ds_read_b64_tr_b16 v[106:107], v34 offset:8736
    v_mfma_f32_16x16x32_bf16 v[152:155], v[76:79], v[48:51], v[152:155]
    ds_read_b128 v[64:67], v29 offset:4096
    v_mfma_f32_16x16x32_bf16 v[156:159], v[76:79], v[52:55], v[156:159]
    ds_read_b64_tr_b16 v[108:109], v34 offset:8512
    v_mfma_f32_16x16x32_bf16 v[160:163], v[80:83], v[40:43], v[160:163]
    ds_read_b64_tr_b16 v[110:111], v34 offset:8768
    v_mfma_f32_16x16x32_bf16 v[164:167], v[80:83], v[44:47], v[164:167]
    ds_read_b128 v[68:71], v29 offset:6144
    v_mfma_f32_16x16x32_bf16 v[168:171], v[80:83], v[48:51], v[168:171]
    ds_read_b64_tr_b16 v[112:113], v34 offset:8544
    v_mfma_f32_16x16x32_bf16 v[172:175], v[80:83], v[52:55], v[172:175]
    ds_read_b64_tr_b16 v[114:115], v34 offset:8800
    v_mfma_f32_16x16x32_bf16 v[176:179], v[84:87], v[40:43], v[176:179]
    ds_read_b64_tr_b16 v[116:117], v34 offset:8576
    v_mfma_f32_16x16x32_bf16 v[180:183], v[84:87], v[44:47], v[180:183]
    ds_read_b64_tr_b16 v[118:119], v34 offset:8832
    v_mfma_f32_16x16x32_bf16 v[184:187], v[84:87], v[48:51], v[184:187]
    ds_read_b64_tr_b16 v[120:121], v34 offset:8608
    v_mfma_f32_16x16x32_bf16 v[188:191], v[84:87], v[52:55], v[188:191]
    ds_read_b64_tr_b16 v[122:123], v34 offset:8864
    v_mfma_f32_16x16x32_bf16 v[192:195], v[88:91], v[40:43], v[192:195]
    ds_read_b64_tr_b16 v[124:125], v34 offset:8640
    v_mfma_f32_16x16x32_bf16 v[196:199], v[88:91], v[44:47], v[196:199]
    ds_read_b64_tr_b16 v[126:127], v34 offset:8896
    v_mfma_f32_16x16x32_bf16 v[200:203], v[88:91], v[48:51], v[200:203]
    v_mfma_f32_16x16x32_bf16 v[204:207], v[88:91], v[52:55], v[204:207]
    v_mfma_f32_16x16x32_bf16 v[208:211], v[92:95], v[40:43], v[208:211]
    v_mfma_f32_16x16x32_bf16 v[212:215], v[92:95], v[44:47], v[212:215]
    v_mfma_f32_16x16x32_bf16 v[216:219], v[92:95], v[48:51], v[216:219]
    v_mfma_f32_16x16x32_bf16 v[220:223], v[92:95], v[52:55], v[220:223]
    v_mfma_f32_16x16x32_bf16 v[224:227], v[96:99], v[40:43], v[224:227]
    v_mfma_f32_16x16x32_bf16 v[228:231], v[96:99], v[44:47], v[228:231]
    v_mfma_f32_16x16x32_bf16 v[232:235], v[96:99], v[48:51], v[232:235]
    v_mfma_f32_16x16x32_bf16 v[236:239], v[96:99], v[52:55], v[236:239]
    s_waitcnt lgkmcnt(0)
    s_barrier
    v_mfma_f32_16x16x32_bf16 v[128:131], v[100:103], v[56:59], v[128:131]
    ds_read_b128 v[40:43], v30 offset:0
    v_mfma_f32_16x16x32_bf16 v[132:135], v[100:103], v[60:63], v[132:135]
    ds_read_b64_tr_b16 v[72:73], v35 offset:0
    v_mfma_f32_16x16x32_bf16 v[136:139], v[100:103], v[64:67], v[136:139]
    ds_read_b64_tr_b16 v[74:75], v35 offset:256
    v_mfma_f32_16x16x32_bf16 v[140:143], v[100:103], v[68:71], v[140:143]
    ds_read_b128 v[44:47], v30 offset:2048
    v_mfma_f32_16x16x32_bf16 v[144:147], v[104:107], v[56:59], v[144:147]
    ds_read_b64_tr_b16 v[76:77], v35 offset:32
    v_mfma_f32_16x16x32_bf16 v[148:151], v[104:107], v[60:63], v[148:151]
    ds_read_b64_tr_b16 v[78:79], v35 offset:288
    v_mfma_f32_16x16x32_bf16 v[152:155], v[104:107], v[64:67], v[152:155]
    ds_read_b128 v[48:51], v30 offset:4096
    v_mfma_f32_16x16x32_bf16 v[156:159], v[104:107], v[68:71], v[156:159]
    ds_read_b64_tr_b16 v[80:81], v35 offset:64
    v_mfma_f32_16x16x32_bf16 v[160:163], v[108:111], v[56:59], v[160:163]
    ds_read_b64_tr_b16 v[82:83], v35 offset:320
    v_mfma_f32_16x16x32_bf16 v[164:167], v[108:111], v[60:63], v[164:167]
    ds_read_b128 v[52:55], v30 offset:6144
    v_mfma_f32_16x16x32_bf16 v[168:171], v[108:111], v[64:67], v[168:171]
    ds_read_b64_tr_b16 v[84:85], v35 offset:96
    v_mfma_f32_16x16x32_bf16 v[172:175], v[108:111], v[68:71], v[172:175]
    ds_read_b64_tr_b16 v[86:87], v35 offset:352
    v_mfma_f32_16x16x32_bf16 v[176:179], v[112:115], v[56:59], v[176:179]
    ds_read_b64_tr_b16 v[88:89], v35 offset:128
    v_mfma_f32_16x16x32_bf16 v[180:183], v[112:115], v[60:63], v[180:183]
    ds_read_b64_tr_b16 v[90:91], v35 offset:384
    v_mfma_f32_16x16x32_bf16 v[184:187], v[112:115], v[64:67], v[184:187]
    ds_read_b64_tr_b16 v[92:93], v35 offset:160
    v_mfma_f32_16x16x32_bf16 v[188:191], v[112:115], v[68:71], v[188:191]
    ds_read_b64_tr_b16 v[94:95], v35 offset:416
    v_mfma_f32_16x16x32_bf16 v[192:195], v[116:119], v[56:59], v[192:195]
    ds_read_b64_tr_b16 v[96:97], v35 offset:192
    v_mfma_f32_16x16x32_bf16 v[196:199], v[116:119], v[60:63], v[196:199]
    ds_read_b64_tr_b16 v[98:99], v35 offset:448
    v_mfma_f32_16x16x32_bf16 v[200:203], v[116:119], v[64:67], v[200:203]
    v_mfma_f32_16x16x32_bf16 v[204:207], v[116:119], v[68:71], v[204:207]
    v_mfma_f32_16x16x32_bf16 v[208:211], v[120:123], v[56:59], v[208:211]
    v_mfma_f32_16x16x32_bf16 v[212:215], v[120:123], v[60:63], v[212:215]
    v_mfma_f32_16x16x32_bf16 v[216:219], v[120:123], v[64:67], v[216:219]
    v_mfma_f32_16x16x32_bf16 v[220:223], v[120:123], v[68:71], v[220:223]
    v_mfma_f32_16x16x32_bf16 v[224:227], v[124:127], v[56:59], v[224:227]
    v_mfma_f32_16x16x32_bf16 v[228:231], v[124:127], v[60:63], v[228:231]
    v_mfma_f32_16x16x32_bf16 v[232:235], v[124:127], v[64:67], v[232:235]
    v_mfma_f32_16x16x32_bf16 v[236:239], v[124:127], v[68:71], v[236:239]
    s_waitcnt lgkmcnt(0)
    v_mfma_f32_16x16x32_bf16 v[128:131], v[72:75], v[40:43], v[128:131]
    ds_read_b128 v[56:59], v31 offset:0
    v_mfma_f32_16x16x32_bf16 v[132:135], v[72:75], v[44:47], v[132:135]
    ds_read_b64_tr_b16 v[100:101], v35 offset:8448
    v_mfma_f32_16x16x32_bf16 v[136:139], v[72:75], v[48:51], v[136:139]
    ds_read_b64_tr_b16 v[102:103], v35 offset:8704
    v_mfma_f32_16x16x32_bf16 v[140:143], v[72:75], v[52:55], v[140:143]
    ds_read_b128 v[60:63], v31 offset:2048
    v_mfma_f32_16x16x32_bf16 v[144:147], v[76:79], v[40:43], v[144:147]
    ds_read_b64_tr_b16 v[104:105], v35 offset:8480
    v_mfma_f32_16x16x32_bf16 v[148:151], v[76:79], v[44:47], v[148:151]
    ds_read_b64_tr_b16 v[106:107], v35 offset:8736
    v_mfma_f32_16x16x32_bf16 v[152:155], v[76:79], v[48:51], v[152:155]
    ds_read_b128 v[64:67], v31 offset:4096
    v_mfma_f32_16x16x32_bf16 v[156:159], v[76:79], v[52:55], v[156:159]
    ds_read_b64_tr_b16 v[108:109], v35 offset:8512
    v_mfma_f32_16x16x32_bf16 v[160:163], v[80:83], v[40:43], v[160:163]
    ds_read_b64_tr_b16 v[110:111], v35 offset:8768
    v_mfma_f32_16x16x32_bf16 v[164:167], v[80:83], v[44:47], v[164:167]
    ds_read_b128 v[68:71], v31 offset:6144
    v_mfma_f32_16x16x32_bf16 v[168:171], v[80:83], v[48:51], v[168:171]
    ds_read_b64_tr_b16 v[112:113], v35 offset:8544
    v_mfma_f32_16x16x32_bf16 v[172:175], v[80:83], v[52:55], v[172:175]
    ds_read_b64_tr_b16 v[114:115], v35 offset:8800
    v_mfma_f32_16x16x32_bf16 v[176:179], v[84:87], v[40:43], v[176:179]
    ds_read_b64_tr_b16 v[116:117], v35 offset:8576
    v_mfma_f32_16x16x32_bf16 v[180:183], v[84:87], v[44:47], v[180:183]
    ds_read_b64_tr_b16 v[118:119], v35 offset:8832
    v_mfma_f32_16x16x32_bf16 v[184:187], v[84:87], v[48:51], v[184:187]
    ds_read_b64_tr_b16 v[120:121], v35 offset:8608
    v_mfma_f32_16x16x32_bf16 v[188:191], v[84:87], v[52:55], v[188:191]
    ds_read_b64_tr_b16 v[122:123], v35 offset:8864
    v_mfma_f32_16x16x32_bf16 v[192:195], v[88:91], v[40:43], v[192:195]
    ds_read_b64_tr_b16 v[124:125], v35 offset:8640
    v_mfma_f32_16x16x32_bf16 v[196:199], v[88:91], v[44:47], v[196:199]
    ds_read_b64_tr_b16 v[126:127], v35 offset:8896
    v_mfma_f32_16x16x32_bf16 v[200:203], v[88:91], v[48:51], v[200:203]
    v_mfma_f32_16x16x32_bf16 v[204:207], v[88:91], v[52:55], v[204:207]
    v_mfma_f32_16x16x32_bf16 v[208:211], v[92:95], v[40:43], v[208:211]
    v_mfma_f32_16x16x32_bf16 v[212:215], v[92:95], v[44:47], v[212:215]
    v_mfma_f32_16x16x32_bf16 v[216:219], v[92:95], v[48:51], v[216:219]
    v_mfma_f32_16x16x32_bf16 v[220:223], v[92:95], v[52:55], v[220:223]
    v_mfma_f32_16x16x32_bf16 v[224:227], v[96:99], v[40:43], v[224:227]
    v_mfma_f32_16x16x32_bf16 v[228:231], v[96:99], v[44:47], v[228:231]
    v_mfma_f32_16x16x32_bf16 v[232:235], v[96:99], v[48:51], v[232:235]
    v_mfma_f32_16x16x32_bf16 v[236:239], v[96:99], v[52:55], v[236:239]
    s_waitcnt lgkmcnt(0)
    s_barrier
    v_mfma_f32_16x16x32_bf16 v[128:131], v[100:103], v[56:59], v[128:131]
    ds_read_b128 v[40:43], v32 offset:0
    v_mfma_f32_16x16x32_bf16 v[132:135], v[100:103], v[60:63], v[132:135]
    ds_read_b64_tr_b16 v[72:73], v36 offset:0
    v_mfma_f32_16x16x32_bf16 v[136:139], v[100:103], v[64:67], v[136:139]
    ds_read_b64_tr_b16 v[74:75], v36 offset:256
    v_mfma_f32_16x16x32_bf16 v[140:143], v[100:103], v[68:71], v[140:143]
    ds_read_b128 v[44:47], v32 offset:2048
    v_mfma_f32_16x16x32_bf16 v[144:147], v[104:107], v[56:59], v[144:147]
    ds_read_b64_tr_b16 v[76:77], v36 offset:32
    v_mfma_f32_16x16x32_bf16 v[148:151], v[104:107], v[60:63], v[148:151]
    ds_read_b64_tr_b16 v[78:79], v36 offset:288
    v_mfma_f32_16x16x32_bf16 v[152:155], v[104:107], v[64:67], v[152:155]
    ds_read_b128 v[48:51], v32 offset:4096
    v_mfma_f32_16x16x32_bf16 v[156:159], v[104:107], v[68:71], v[156:159]
    ds_read_b64_tr_b16 v[80:81], v36 offset:64
    v_mfma_f32_16x16x32_bf16 v[160:163], v[108:111], v[56:59], v[160:163]
    ds_read_b64_tr_b16 v[82:83], v36 offset:320
    v_mfma_f32_16x16x32_bf16 v[164:167], v[108:111], v[60:63], v[164:167]
    ds_read_b128 v[52:55], v32 offset:6144
    v_mfma_f32_16x16x32_bf16 v[168:171], v[108:111], v[64:67], v[168:171]
    ds_read_b64_tr_b16 v[84:85], v36 offset:96
    v_mfma_f32_16x16x32_bf16 v[172:175], v[108:111], v[68:71], v[172:175]
    ds_read_b64_tr_b16 v[86:87], v36 offset:352
    v_mfma_f32_16x16x32_bf16 v[176:179], v[112:115], v[56:59], v[176:179]
    ds_read_b64_tr_b16 v[88:89], v36 offset:128
    v_mfma_f32_16x16x32_bf16 v[180:183], v[112:115], v[60:63], v[180:183]
    ds_read_b64_tr_b16 v[90:91], v36 offset:384
    v_mfma_f32_16x16x32_bf16 v[184:187], v[112:115], v[64:67], v[184:187]
    ds_read_b64_tr_b16 v[92:93], v36 offset:160
    v_mfma_f32_16x16x32_bf16 v[188:191], v[112:115], v[68:71], v[188:191]
    ds_read_b64_tr_b16 v[94:95], v36 offset:416
    v_mfma_f32_16x16x32_bf16 v[192:195], v[116:119], v[56:59], v[192:195]
    ds_read_b64_tr_b16 v[96:97], v36 offset:192
    v_mfma_f32_16x16x32_bf16 v[196:199], v[116:119], v[60:63], v[196:199]
    ds_read_b64_tr_b16 v[98:99], v36 offset:448
    v_mfma_f32_16x16x32_bf16 v[200:203], v[116:119], v[64:67], v[200:203]
    v_mfma_f32_16x16x32_bf16 v[204:207], v[116:119], v[68:71], v[204:207]
    v_mfma_f32_16x16x32_bf16 v[208:211], v[120:123], v[56:59], v[208:211]
    v_mfma_f32_16x16x32_bf16 v[212:215], v[120:123], v[60:63], v[212:215]
    v_mfma_f32_16x16x32_bf16 v[216:219], v[120:123], v[64:67], v[216:219]
    v_mfma_f32_16x16x32_bf16 v[220:223], v[120:123], v[68:71], v[220:223]
    v_mfma_f32_16x16x32_bf16 v[224:227], v[124:127], v[56:59], v[224:227]
    v_mfma_f32_16x16x32_bf16 v[228:231], v[124:127], v[60:63], v[228:231]
    v_mfma_f32_16x16x32_bf16 v[232:235], v[124:127], v[64:67], v[232:235]
    v_mfma_f32_16x16x32_bf16 v[236:239], v[124:127], v[68:71], v[236:239]
    s_waitcnt lgkmcnt(0)
    v_mfma_f32_16x16x32_bf16 v[128:131], v[72:75], v[40:43], v[128:131]
    ds_read_b128 v[56:59], v33 offset:0
    v_mfma_f32_16x16x32_bf16 v[132:135], v[72:75], v[44:47], v[132:135]
    ds_read_b64_tr_b16 v[100:101], v36 offset:8448
    v_mfma_f32_16x16x32_bf16 v[136:139], v[72:75], v[48:51], v[136:139]
    ds_read_b64_tr_b16 v[102:103], v36 offset:8704
    v_mfma_f32_16x16x32_bf16 v[140:143], v[72:75], v[52:55], v[140:143]
    ds_read_b128 v[60:63], v33 offset:2048
    v_mfma_f32_16x16x32_bf16 v[144:147], v[76:79], v[40:43], v[144:147]
    ds_read_b64_tr_b16 v[104:105], v36 offset:8480
    v_mfma_f32_16x16x32_bf16 v[148:151], v[76:79], v[44:47], v[148:151]
    ds_read_b64_tr_b16 v[106:107], v36 offset:8736
    v_mfma_f32_16x16x32_bf16 v[152:155], v[76:79], v[48:51], v[152:155]
    ds_read_b128 v[64:67], v33 offset:4096
    v_mfma_f32_16x16x32_bf16 v[156:159], v[76:79], v[52:55], v[156:159]
    ds_read_b64_tr_b16 v[108:109], v36 offset:8512
    v_mfma_f32_16x16x32_bf16 v[160:163], v[80:83], v[40:43], v[160:163]
    ds_read_b64_tr_b16 v[110:111], v36 offset:8768
    v_mfma_f32_16x16x32_bf16 v[164:167], v[80:83], v[44:47], v[164:167]
    ds_read_b128 v[68:71], v33 offset:6144
    v_mfma_f32_16x16x32_bf16 v[168:171], v[80:83], v[48:51], v[168:171]
    ds_read_b64_tr_b16 v[112:113], v36 offset:8544
    v_mfma_f32_16x16x32_bf16 v[172:175], v[80:83], v[52:55], v[172:175]
    ds_read_b64_tr_b16 v[114:115], v36 offset:8800
    v_mfma_f32_16x16x32_bf16 v[176:179], v[84:87], v[40:43], v[176:179]
    ds_read_b64_tr_b16 v[116:117], v36 offset:8576
    v_mfma_f32_16x16x32_bf16 v[180:183], v[84:87], v[44:47], v[180:183]
    ds_read_b64_tr_b16 v[118:119], v36 offset:8832
    v_mfma_f32_16x16x32_bf16 v[184:187], v[84:87], v[48:51], v[184:187]
    ds_read_b64_tr_b16 v[120:121], v36 offset:8608
    v_mfma_f32_16x16x32_bf16 v[188:191], v[84:87], v[52:55], v[188:191]
    ds_read_b64_tr_b16 v[122:123], v36 offset:8864
    v_mfma_f32_16x16x32_bf16 v[192:195], v[88:91], v[40:43], v[192:195]
    ds_read_b64_tr_b16 v[124:125], v36 offset:8640
    v_mfma_f32_16x16x32_bf16 v[196:199], v[88:91], v[44:47], v[196:199]
    ds_read_b64_tr_b16 v[126:127], v36 offset:8896
    v_mfma_f32_16x16x32_bf16 v[200:203], v[88:91], v[48:51], v[200:203]
    v_mfma_f32_16x16x32_bf16 v[204:207], v[88:91], v[52:55], v[204:207]
    v_mfma_f32_16x16x32_bf16 v[208:211], v[92:95], v[40:43], v[208:211]
    v_mfma_f32_16x16x32_bf16 v[212:215], v[92:95], v[44:47], v[212:215]
    v_mfma_f32_16x16x32_bf16 v[216:219], v[92:95], v[48:51], v[216:219]
    v_mfma_f32_16x16x32_bf16 v[220:223], v[92:95], v[52:55], v[220:223]
    v_mfma_f32_16x16x32_bf16 v[224:227], v[96:99], v[40:43], v[224:227]
    v_mfma_f32_16x16x32_bf16 v[228:231], v[96:99], v[44:47], v[228:231]
    v_mfma_f32_16x16x32_bf16 v[232:235], v[96:99], v[48:51], v[232:235]
    v_mfma_f32_16x16x32_bf16 v[236:239], v[96:99], v[52:55], v[236:239]
    s_waitcnt lgkmcnt(0)
    s_barrier
    v_mfma_f32_16x16x32_bf16 v[128:131], v[100:103], v[56:59], v[128:131]
    ds_read_b128 v[40:43], v28 offset:0
    v_mfma_f32_16x16x32_bf16 v[132:135], v[100:103], v[60:63], v[132:135]
    ds_read_b64_tr_b16 v[72:73], v34 offset:0
    v_mfma_f32_16x16x32_bf16 v[136:139], v[100:103], v[64:67], v[136:139]
    ds_read_b64_tr_b16 v[74:75], v34 offset:256
    v_mfma_f32_16x16x32_bf16 v[140:143], v[100:103], v[68:71], v[140:143]
    ds_read_b128 v[44:47], v28 offset:2048
    v_mfma_f32_16x16x32_bf16 v[144:147], v[104:107], v[56:59], v[144:147]
    ds_read_b64_tr_b16 v[76:77], v34 offset:32
    v_mfma_f32_16x16x32_bf16 v[148:151], v[104:107], v[60:63], v[148:151]
    ds_read_b64_tr_b16 v[78:79], v34 offset:288
    v_mfma_f32_16x16x32_bf16 v[152:155], v[104:107], v[64:67], v[152:155]
    ds_read_b128 v[48:51], v28 offset:4096
    v_mfma_f32_16x16x32_bf16 v[156:159], v[104:107], v[68:71], v[156:159]
    ds_read_b64_tr_b16 v[80:81], v34 offset:64
    v_mfma_f32_16x16x32_bf16 v[160:163], v[108:111], v[56:59], v[160:163]
    ds_read_b64_tr_b16 v[82:83], v34 offset:320
    v_mfma_f32_16x16x32_bf16 v[164:167], v[108:111], v[60:63], v[164:167]
    ds_read_b128 v[52:55], v28 offset:6144
    v_mfma_f32_16x16x32_bf16 v[168:171], v[108:111], v[64:67], v[168:171]
    ds_read_b64_tr_b16 v[84:85], v34 offset:96
    v_mfma_f32_16x16x32_bf16 v[172:175], v[108:111], v[68:71], v[172:175]
    ds_read_b64_tr_b16 v[86:87], v34 offset:352
    v_mfma_f32_16x16x32_bf16 v[176:179], v[112:115], v[56:59], v[176:179]
    ds_read_b64_tr_b16 v[88:89], v34 offset:128
    v_mfma_f32_16x16x32_bf16 v[180:183], v[112:115], v[60:63], v[180:183]
    ds_read_b64_tr_b16 v[90:91], v34 offset:384
    v_mfma_f32_16x16x32_bf16 v[184:187], v[112:115], v[64:67], v[184:187]
    ds_read_b64_tr_b16 v[92:93], v34 offset:160
    v_mfma_f32_16x16x32_bf16 v[188:191], v[112:115], v[68:71], v[188:191]
    ds_read_b64_tr_b16 v[94:95], v34 offset:416
    v_mfma_f32_16x16x32_bf16 v[192:195], v[116:119], v[56:59], v[192:195]
    ds_read_b64_tr_b16 v[96:97], v34 offset:192
    v_mfma_f32_16x16x32_bf16 v[196:199], v[116:119], v[60:63], v[196:199]
    ds_read_b64_tr_b16 v[98:99], v34 offset:448
    v_mfma_f32_16x16x32_bf16 v[200:203], v[116:119], v[64:67], v[200:203]
    v_mfma_f32_16x16x32_bf16 v[204:207], v[116:119], v[68:71], v[204:207]
    v_mfma_f32_16x16x32_bf16 v[208:211], v[120:123], v[56:59], v[208:211]
    v_mfma_f32_16x16x32_bf16 v[212:215], v[120:123], v[60:63], v[212:215]
    v_mfma_f32_16x16x32_bf16 v[216:219], v[120:123], v[64:67], v[216:219]
    v_mfma_f32_16x16x32_bf16 v[220:223], v[120:123], v[68:71], v[220:223]
    v_mfma_f32_16x16x32_bf16 v[224:227], v[124:127], v[56:59], v[224:227]
    v_mfma_f32_16x16x32_bf16 v[228:231], v[124:127], v[60:63], v[228:231]
    v_mfma_f32_16x16x32_bf16 v[232:235], v[124:127], v[64:67], v[232:235]
    v_mfma_f32_16x16x32_bf16 v[236:239], v[124:127], v[68:71], v[236:239]
    s_waitcnt lgkmcnt(0)
    v_mfma_f32_16x16x32_bf16 v[128:131], v[72:75], v[40:43], v[128:131]
    ds_read_b128 v[56:59], v29 offset:0
    v_mfma_f32_16x16x32_bf16 v[132:135], v[72:75], v[44:47], v[132:135]
    ds_read_b64_tr_b16 v[100:101], v34 offset:8448
    v_mfma_f32_16x16x32_bf16 v[136:139], v[72:75], v[48:51], v[136:139]
    ds_read_b64_tr_b16 v[102:103], v34 offset:8704
    v_mfma_f32_16x16x32_bf16 v[140:143], v[72:75], v[52:55], v[140:143]
    ds_read_b128 v[60:63], v29 offset:2048
    v_mfma_f32_16x16x32_bf16 v[144:147], v[76:79], v[40:43], v[144:147]
    ds_read_b64_tr_b16 v[104:105], v34 offset:8480
    v_mfma_f32_16x16x32_bf16 v[148:151], v[76:79], v[44:47], v[148:151]
    ds_read_b64_tr_b16 v[106:107], v34 offset:8736
    v_mfma_f32_16x16x32_bf16 v[152:155], v[76:79], v[48:51], v[152:155]
    ds_read_b128 v[64:67], v29 offset:4096
    v_mfma_f32_16x16x32_bf16 v[156:159], v[76:79], v[52:55], v[156:159]
    ds_read_b64_tr_b16 v[108:109], v34 offset:8512
    v_mfma_f32_16x16x32_bf16 v[160:163], v[80:83], v[40:43], v[160:163]
    ds_read_b64_tr_b16 v[110:111], v34 offset:8768
    v_mfma_f32_16x16x32_bf16 v[164:167], v[80:83], v[44:47], v[164:167]
    ds_read_b128 v[68:71], v29 offset:6144
    v_mfma_f32_16x16x32_bf16 v[168:171], v[80:83], v[48:51], v[168:171]
    ds_read_b64_tr_b16 v[112:113], v34 offset:8544
    v_mfma_f32_16x16x32_bf16 v[172:175], v[80:83], v[52:55], v[172:175]
    ds_read_b64_tr_b16 v[114:115], v34 offset:8800
    v_mfma_f32_16x16x32_bf16 v[176:179], v[84:87], v[40:43], v[176:179]
    ds_read_b64_tr_b16 v[116:117], v34 offset:8576
    v_mfma_f32_16x16x32_bf16 v[180:183], v[84:87], v[44:47], v[180:183]
    ds_read_b64_tr_b16 v[118:119], v34 offset:8832
    v_mfma_f32_16x16x32_bf16 v[184:187], v[84:87], v[48:51], v[184:187]
    ds_read_b64_tr_b16 v[120:121], v34 offset:8608
    v_mfma_f32_16x16x32_bf16 v[188:191], v[84:87], v[52:55], v[188:191]
    ds_read_b64_tr_b16 v[122:123], v34 offset:8864
    v_mfma_f32_16x16x32_bf16 v[192:195], v[88:91], v[40:43], v[192:195]
    ds_read_b64_tr_b16 v[124:125], v34 offset:8640
    v_mfma_f32_16x16x32_bf16 v[196:199], v[88:91], v[44:47], v[196:199]
    ds_read_b64_tr_b16 v[126:127], v34 offset:8896
    v_mfma_f32_16x16x32_bf16 v[200:203], v[88:91], v[48:51], v[200:203]
    v_mfma_f32_16x16x32_bf16 v[204:207], v[88:91], v[52:55], v[204:207]
    v_mfma_f32_16x16x32_bf16 v[208:211], v[92:95], v[40:43], v[208:211]
    v_mfma_f32_16x16x32_bf16 v[212:215], v[92:95], v[44:47], v[212:215]
    v_mfma_f32_16x16x32_bf16 v[216:219], v[92:95], v[48:51], v[216:219]
    v_mfma_f32_16x16x32_bf16 v[220:223], v[92:95], v[52:55], v[220:223]
    v_mfma_f32_16x16x32_bf16 v[224:227], v[96:99], v[40:43], v[224:227]
    v_mfma_f32_16x16x32_bf16 v[228:231], v[96:99], v[44:47], v[228:231]
    v_mfma_f32_16x16x32_bf16 v[232:235], v[96:99], v[48:51], v[232:235]
    v_mfma_f32_16x16x32_bf16 v[236:239], v[96:99], v[52:55], v[236:239]
    s_waitcnt lgkmcnt(0)
    s_barrier
    v_mfma_f32_16x16x32_bf16 v[128:131], v[100:103], v[56:59], v[128:131]
    ds_read_b128 v[40:43], v30 offset:0
    v_mfma_f32_16x16x32_bf16 v[132:135], v[100:103], v[60:63], v[132:135]
    ds_read_b64_tr_b16 v[72:73], v35 offset:0
    v_mfma_f32_16x16x32_bf16 v[136:139], v[100:103], v[64:67], v[136:139]
    ds_read_b64_tr_b16 v[74:75], v35 offset:256
    v_mfma_f32_16x16x32_bf16 v[140:143], v[100:103], v[68:71], v[140:143]
    ds_read_b128 v[44:47], v30 offset:2048
    v_mfma_f32_16x16x32_bf16 v[144:147], v[104:107], v[56:59], v[144:147]
    ds_read_b64_tr_b16 v[76:77], v35 offset:32
    v_mfma_f32_16x16x32_bf16 v[148:151], v[104:107], v[60:63], v[148:151]
    ds_read_b64_tr_b16 v[78:79], v35 offset:288
    v_mfma_f32_16x16x32_bf16 v[152:155], v[104:107], v[64:67], v[152:155]
    ds_read_b128 v[48:51], v30 offset:4096
    v_mfma_f32_16x16x32_bf16 v[156:159], v[104:107], v[68:71], v[156:159]
    ds_read_b64_tr_b16 v[80:81], v35 offset:64
    v_mfma_f32_16x16x32_bf16 v[160:163], v[108:111], v[56:59], v[160:163]
    ds_read_b64_tr_b16 v[82:83], v35 offset:320
    v_mfma_f32_16x16x32_bf16 v[164:167], v[108:111], v[60:63], v[164:167]
    ds_read_b128 v[52:55], v30 offset:6144
    v_mfma_f32_16x16x32_bf16 v[168:171], v[108:111], v[64:67], v[168:171]
    ds_read_b64_tr_b16 v[84:85], v35 offset:96
    v_mfma_f32_16x16x32_bf16 v[172:175], v[108:111], v[68:71], v[172:175]
    ds_read_b64_tr_b16 v[86:87], v35 offset:352
    v_mfma_f32_16x16x32_bf16 v[176:179], v[112:115], v[56:59], v[176:179]
    ds_read_b64_tr_b16 v[88:89], v35 offset:128
    v_mfma_f32_16x16x32_bf16 v[180:183], v[112:115], v[60:63], v[180:183]
    ds_read_b64_tr_b16 v[90:91], v35 offset:384
    v_mfma_f32_16x16x32_bf16 v[184:187], v[112:115], v[64:67], v[184:187]
    ds_read_b64_tr_b16 v[92:93], v35 offset:160
    v_mfma_f32_16x16x32_bf16 v[188:191], v[112:115], v[68:71], v[188:191]
    ds_read_b64_tr_b16 v[94:95], v35 offset:416
    v_mfma_f32_16x16x32_bf16 v[192:195], v[116:119], v[56:59], v[192:195]
    ds_read_b64_tr_b16 v[96:97], v35 offset:192
    v_mfma_f32_16x16x32_bf16 v[196:199], v[116:119], v[60:63], v[196:199]
    ds_read_b64_tr_b16 v[98:99], v35 offset:448
    v_mfma_f32_16x16x32_bf16 v[200:203], v[116:119], v[64:67], v[200:203]
    v_mfma_f32_16x16x32_bf16 v[204:207], v[116:119], v[68:71], v[204:207]
    v_mfma_f32_16x16x32_bf16 v[208:211], v[120:123], v[56:59], v[208:211]
    v_mfma_f32_16x16x32_bf16 v[212:215], v[120:123], v[60:63], v[212:215]
    v_mfma_f32_16x16x32_bf16 v[216:219], v[120:123], v[64:67], v[216:219]
    v_mfma_f32_16x16x32_bf16 v[220:223], v[120:123], v[68:71], v[220:223]
    v_mfma_f32_16x16x32_bf16 v[224:227], v[124:127], v[56:59], v[224:227]
    v_mfma_f32_16x16x32_bf16 v[228:231], v[124:127], v[60:63], v[228:231]
    v_mfma_f32_16x16x32_bf16 v[232:235], v[124:127], v[64:67], v[232:235]
    v_mfma_f32_16x16x32_bf16 v[236:239], v[124:127], v[68:71], v[236:239]
    s_waitcnt lgkmcnt(0)
    v_mfma_f32_16x16x32_bf16 v[128:131], v[72:75], v[40:43], v[128:131]
    ds_read_b128 v[56:59], v31 offset:0
    v_mfma_f32_16x16x32_bf16 v[132:135], v[72:75], v[44:47], v[132:135]
    ds_read_b64_tr_b16 v[100:101], v35 offset:8448
    v_mfma_f32_16x16x32_bf16 v[136:139], v[72:75], v[48:51], v[136:139]
    ds_read_b64_tr_b16 v[102:103], v35 offset:8704
    v_mfma_f32_16x16x32_bf16 v[140:143], v[72:75], v[52:55], v[140:143]
    ds_read_b128 v[60:63], v31 offset:2048
    v_mfma_f32_16x16x32_bf16 v[144:147], v[76:79], v[40:43], v[144:147]
    ds_read_b64_tr_b16 v[104:105], v35 offset:8480
    v_mfma_f32_16x16x32_bf16 v[148:151], v[76:79], v[44:47], v[148:151]
    ds_read_b64_tr_b16 v[106:107], v35 offset:8736
    v_mfma_f32_16x16x32_bf16 v[152:155], v[76:79], v[48:51], v[152:155]
    ds_read_b128 v[64:67], v31 offset:4096
    v_mfma_f32_16x16x32_bf16 v[156:159], v[76:79], v[52:55], v[156:159]
    ds_read_b64_tr_b16 v[108:109], v35 offset:8512
    v_mfma_f32_16x16x32_bf16 v[160:163], v[80:83], v[40:43], v[160:163]
    ds_read_b64_tr_b16 v[110:111], v35 offset:8768
    v_mfma_f32_16x16x32_bf16 v[164:167], v[80:83], v[44:47], v[164:167]
    ds_read_b128 v[68:71], v31 offset:6144
    v_mfma_f32_16x16x32_bf16 v[168:171], v[80:83], v[48:51], v[168:171]
    ds_read_b64_tr_b16 v[112:113], v35 offset:8544
    v_mfma_f32_16x16x32_bf16 v[172:175], v[80:83], v[52:55], v[172:175]
    ds_read_b64_tr_b16 v[114:115], v35 offset:8800
    v_mfma_f32_16x16x32_bf16 v[176:179], v[84:87], v[40:43], v[176:179]
    ds_read_b64_tr_b16 v[116:117], v35 offset:8576
    v_mfma_f32_16x16x32_bf16 v[180:183], v[84:87], v[44:47], v[180:183]
    ds_read_b64_tr_b16 v[118:119], v35 offset:8832
    v_mfma_f32_16x16x32_bf16 v[184:187], v[84:87], v[48:51], v[184:187]
    ds_read_b64_tr_b16 v[120:121], v35 offset:8608
    v_mfma_f32_16x16x32_bf16 v[188:191], v[84:87], v[52:55], v[188:191]
    ds_read_b64_tr_b16 v[122:123], v35 offset:8864
    v_mfma_f32_16x16x32_bf16 v[192:195], v[88:91], v[40:43], v[192:195]
    ds_read_b64_tr_b16 v[124:125], v35 offset:8640
    v_mfma_f32_16x16x32_bf16 v[196:199], v[88:91], v[44:47], v[196:199]
    ds_read_b64_tr_b16 v[126:127], v35 offset:8896
    v_mfma_f32_16x16x32_bf16 v[200:203], v[88:91], v[48:51], v[200:203]
    v_mfma_f32_16x16x32_bf16 v[204:207], v[88:91], v[52:55], v[204:207]
    v_mfma_f32_16x16x32_bf16 v[208:211], v[92:95], v[40:43], v[208:211]
    v_mfma_f32_16x16x32_bf16 v[212:215], v[92:95], v[44:47], v[212:215]
    v_mfma_f32_16x16x32_bf16 v[216:219], v[92:95], v[48:51], v[216:219]
    v_mfma_f32_16x16x32_bf16 v[220:223], v[92:95], v[52:55], v[220:223]
    v_mfma_f32_16x16x32_bf16 v[224:227], v[96:99], v[40:43], v[224:227]
    v_mfma_f32_16x16x32_bf16 v[228:231], v[96:99], v[44:47], v[228:231]
    v_mfma_f32_16x16x32_bf16 v[232:235], v[96:99], v[48:51], v[232:235]
    v_mfma_f32_16x16x32_bf16 v[236:239], v[96:99], v[52:55], v[236:239]
    s_waitcnt lgkmcnt(0)
    s_barrier
    v_mfma_f32_16x16x32_bf16 v[128:131], v[100:103], v[56:59], v[128:131]
    ds_read_b128 v[40:43], v32 offset:0
    v_mfma_f32_16x16x32_bf16 v[132:135], v[100:103], v[60:63], v[132:135]
    ds_read_b64_tr_b16 v[72:73], v36 offset:0
    v_mfma_f32_16x16x32_bf16 v[136:139], v[100:103], v[64:67], v[136:139]
    ds_read_b64_tr_b16 v[74:75], v36 offset:256
    v_mfma_f32_16x16x32_bf16 v[140:143], v[100:103], v[68:71], v[140:143]
    ds_read_b128 v[44:47], v32 offset:2048
    v_mfma_f32_16x16x32_bf16 v[144:147], v[104:107], v[56:59], v[144:147]
    ds_read_b64_tr_b16 v[76:77], v36 offset:32
    v_mfma_f32_16x16x32_bf16 v[148:151], v[104:107], v[60:63], v[148:151]
    ds_read_b64_tr_b16 v[78:79], v36 offset:288
    v_mfma_f32_16x16x32_bf16 v[152:155], v[104:107], v[64:67], v[152:155]
    ds_read_b128 v[48:51], v32 offset:4096
    v_mfma_f32_16x16x32_bf16 v[156:159], v[104:107], v[68:71], v[156:159]
    ds_read_b64_tr_b16 v[80:81], v36 offset:64
    v_mfma_f32_16x16x32_bf16 v[160:163], v[108:111], v[56:59], v[160:163]
    ds_read_b64_tr_b16 v[82:83], v36 offset:320
    v_mfma_f32_16x16x32_bf16 v[164:167], v[108:111], v[60:63], v[164:167]
    ds_read_b128 v[52:55], v32 offset:6144
    v_mfma_f32_16x16x32_bf16 v[168:171], v[108:111], v[64:67], v[168:171]
    ds_read_b64_tr_b16 v[84:85], v36 offset:96
    v_mfma_f32_16x16x32_bf16 v[172:175], v[108:111], v[68:71], v[172:175]
    ds_read_b64_tr_b16 v[86:87], v36 offset:352
    v_mfma_f32_16x16x32_bf16 v[176:179], v[112:115], v[56:59], v[176:179]
    ds_read_b64_tr_b16 v[88:89], v36 offset:128
    v_mfma_f32_16x16x32_bf16 v[180:183], v[112:115], v[60:63], v[180:183]
    ds_read_b64_tr_b16 v[90:91], v36 offset:384
    v_mfma_f32_16x16x32_bf16 v[184:187], v[112:115], v[64:67], v[184:187]
    ds_read_b64_tr_b16 v[92:93], v36 offset:160
    v_mfma_f32_16x16x32_bf16 v[188:191], v[112:115], v[68:71], v[188:191]
    ds_read_b64_tr_b16 v[94:95], v36 offset:416
    v_mfma_f32_16x16x32_bf16 v[192:195], v[116:119], v[56:59], v[192:195]
    ds_read_b64_tr_b16 v[96:97], v36 offset:192
    v_mfma_f32_16x16x32_bf16 v[196:199], v[116:119], v[60:63], v[196:199]
    ds_read_b64_tr_b16 v[98:99], v36 offset:448
    v_mfma_f32_16x16x32_bf16 v[200:203], v[116:119], v[64:67], v[200:203]
    v_mfma_f32_16x16x32_bf16 v[204:207], v[116:119], v[68:71], v[204:207]
    v_mfma_f32_16x16x32_bf16 v[208:211], v[120:123], v[56:59], v[208:211]
    v_mfma_f32_16x16x32_bf16 v[212:215], v[120:123], v[60:63], v[212:215]
    v_mfma_f32_16x16x32_bf16 v[216:219], v[120:123], v[64:67], v[216:219]
    v_mfma_f32_16x16x32_bf16 v[220:223], v[120:123], v[68:71], v[220:223]
    v_mfma_f32_16x16x32_bf16 v[224:227], v[124:127], v[56:59], v[224:227]
    v_mfma_f32_16x16x32_bf16 v[228:231], v[124:127], v[60:63], v[228:231]
    v_mfma_f32_16x16x32_bf16 v[232:235], v[124:127], v[64:67], v[232:235]
    v_mfma_f32_16x16x32_bf16 v[236:239], v[124:127], v[68:71], v[236:239]
    s_waitcnt lgkmcnt(0)
    v_mfma_f32_16x16x32_bf16 v[128:131], v[72:75], v[40:43], v[128:131]
    ds_read_b128 v[56:59], v33 offset:0
    v_mfma_f32_16x16x32_bf16 v[132:135], v[72:75], v[44:47], v[132:135]
    ds_read_b64_tr_b16 v[100:101], v36 offset:8448
    v_mfma_f32_16x16x32_bf16 v[136:139], v[72:75], v[48:51], v[136:139]
    ds_read_b64_tr_b16 v[102:103], v36 offset:8704
    v_mfma_f32_16x16x32_bf16 v[140:143], v[72:75], v[52:55], v[140:143]
    ds_read_b128 v[60:63], v33 offset:2048
    v_mfma_f32_16x16x32_bf16 v[144:147], v[76:79], v[40:43], v[144:147]
    ds_read_b64_tr_b16 v[104:105], v36 offset:8480
    v_mfma_f32_16x16x32_bf16 v[148:151], v[76:79], v[44:47], v[148:151]
    ds_read_b64_tr_b16 v[106:107], v36 offset:8736
    v_mfma_f32_16x16x32_bf16 v[152:155], v[76:79], v[48:51], v[152:155]
    ds_read_b128 v[64:67], v33 offset:4096
    v_mfma_f32_16x16x32_bf16 v[156:159], v[76:79], v[52:55], v[156:159]
    ds_read_b64_tr_b16 v[108:109], v36 offset:8512
    v_mfma_f32_16x16x32_bf16 v[160:163], v[80:83], v[40:43], v[160:163]
    ds_read_b64_tr_b16 v[110:111], v36 offset:8768
    v_mfma_f32_16x16x32_bf16 v[164:167], v[80:83], v[44:47], v[164:167]
    ds_read_b128 v[68:71], v33 offset:6144
    v_mfma_f32_16x16x32_bf16 v[168:171], v[80:83], v[48:51], v[168:171]
    ds_read_b64_tr_b16 v[112:113], v36 offset:8544
    v_mfma_f32_16x16x32_bf16 v[172:175], v[80:83], v[52:55], v[172:175]
    ds_read_b64_tr_b16 v[114:115], v36 offset:8800
    v_mfma_f32_16x16x32_bf16 v[176:179], v[84:87], v[40:43], v[176:179]
    ds_read_b64_tr_b16 v[116:117], v36 offset:8576
    v_mfma_f32_16x16x32_bf16 v[180:183], v[84:87], v[44:47], v[180:183]
    ds_read_b64_tr_b16 v[118:119], v36 offset:8832
    v_mfma_f32_16x16x32_bf16 v[184:187], v[84:87], v[48:51], v[184:187]
    ds_read_b64_tr_b16 v[120:121], v36 offset:8608
    v_mfma_f32_16x16x32_bf16 v[188:191], v[84:87], v[52:55], v[188:191]
    ds_read_b64_tr_b16 v[122:123], v36 offset:8864
    v_mfma_f32_16x16x32_bf16 v[192:195], v[88:91], v[40:43], v[192:195]
    ds_read_b64_tr_b16 v[124:125], v36 offset:8640
    v_mfma_f32_16x16x32_bf16 v[196:199], v[88:91], v[44:47], v[196:199]
    ds_read_b64_tr_b16 v[126:127], v36 offset:8896
    v_mfma_f32_16x16x32_bf16 v[200:203], v[88:91], v[48:51], v[200:203]
    v_mfma_f32_16x16x32_bf16 v[204:207], v[88:91], v[52:55], v[204:207]
    v_mfma_f32_16x16x32_bf16 v[208:211], v[92:95], v[40:43], v[208:211]
    v_mfma_f32_16x16x32_bf16 v[212:215], v[92:95], v[44:47], v[212:215]
    v_mfma_f32_16x16x32_bf16 v[216:219], v[92:95], v[48:51], v[216:219]
    v_mfma_f32_16x16x32_bf16 v[220:223], v[92:95], v[52:55], v[220:223]
    v_mfma_f32_16x16x32_bf16 v[224:227], v[96:99], v[40:43], v[224:227]
    v_mfma_f32_16x16x32_bf16 v[228:231], v[96:99], v[44:47], v[228:231]
    v_mfma_f32_16x16x32_bf16 v[232:235], v[96:99], v[48:51], v[232:235]
    v_mfma_f32_16x16x32_bf16 v[236:239], v[96:99], v[52:55], v[236:239]
    s_waitcnt lgkmcnt(0)
    v_mfma_f32_16x16x32_bf16 v[128:131], v[100:103], v[56:59], v[128:131]
    v_mfma_f32_16x16x32_bf16 v[132:135], v[100:103], v[60:63], v[132:135]
    v_mfma_f32_16x16x32_bf16 v[136:139], v[100:103], v[64:67], v[136:139]
    v_mfma_f32_16x16x32_bf16 v[140:143], v[100:103], v[68:71], v[140:143]
    v_mfma_f32_16x16x32_bf16 v[144:147], v[104:107], v[56:59], v[144:147]
    v_mfma_f32_16x16x32_bf16 v[148:151], v[104:107], v[60:63], v[148:151]
    v_mfma_f32_16x16x32_bf16 v[152:155], v[104:107], v[64:67], v[152:155]
    v_mfma_f32_16x16x32_bf16 v[156:159], v[104:107], v[68:71], v[156:159]
    v_mfma_f32_16x16x32_bf16 v[160:163], v[108:111], v[56:59], v[160:163]
    v_mfma_f32_16x16x32_bf16 v[164:167], v[108:111], v[60:63], v[164:167]
    v_mfma_f32_16x16x32_bf16 v[168:171], v[108:111], v[64:67], v[168:171]
    v_mfma_f32_16x16x32_bf16 v[172:175], v[108:111], v[68:71], v[172:175]
    v_mfma_f32_16x16x32_bf16 v[176:179], v[112:115], v[56:59], v[176:179]
    v_mfma_f32_16x16x32_bf16 v[180:183], v[112:115], v[60:63], v[180:183]
    v_mfma_f32_16x16x32_bf16 v[184:187], v[112:115], v[64:67], v[184:187]
    v_mfma_f32_16x16x32_bf16 v[188:191], v[112:115], v[68:71], v[188:191]
    v_mfma_f32_16x16x32_bf16 v[192:195], v[116:119], v[56:59], v[192:195]
    v_mfma_f32_16x16x32_bf16 v[196:199], v[116:119], v[60:63], v[196:199]
    v_mfma_f32_16x16x32_bf16 v[200:203], v[116:119], v[64:67], v[200:203]
    v_mfma_f32_16x16x32_bf16 v[204:207], v[116:119], v[68:71], v[204:207]
    v_mfma_f32_16x16x32_bf16 v[208:211], v[120:123], v[56:59], v[208:211]
    v_mfma_f32_16x16x32_bf16 v[212:215], v[120:123], v[60:63], v[212:215]
    v_mfma_f32_16x16x32_bf16 v[216:219], v[120:123], v[64:67], v[216:219]
    v_mfma_f32_16x16x32_bf16 v[220:223], v[120:123], v[68:71], v[220:223]
    v_mfma_f32_16x16x32_bf16 v[224:227], v[124:127], v[56:59], v[224:227]
    v_mfma_f32_16x16x32_bf16 v[228:231], v[124:127], v[60:63], v[228:231]
    v_mfma_f32_16x16x32_bf16 v[232:235], v[124:127], v[64:67], v[232:235]
    v_mfma_f32_16x16x32_bf16 v[236:239], v[124:127], v[68:71], v[236:239]
    s_cmp_lg_u32 s3, 0
    s_cbranch_scc1 L_nf_done
    s_mov_b32 s58, 0
L_nf_loop:
    s_waitcnt vmcnt(0)
    v_readfirstlane_b32 s63, v255
    s_add_u32 s58, s58, 1
    s_cmp_lg_u32 s63, 0
    s_cbranch_scc1 L_nf_done
    s_sleep 4
    global_load_dword v255, v254, s[78:79] sc1
    s_cmp_lt_u32 s58, 400000
    s_cbranch_scc1 L_nf_loop
L_nf_done:
    s_cmp_le_u32 s41, 0
    s_cbranch_scc1 L_p1_ns0
    s_cmp_lt_u32 s41, 4
    s_cbranch_scc1 L_p1_mx0
    v_pk_mul_f32 v[128:129], v[128:129], s[28:29] op_sel_hi:[1,0]
    v_pk_mul_f32 v[130:131], v[130:131], s[28:29] op_sel_hi:[1,0]
    v_pk_mul_f32 v[132:133], v[132:133], s[28:29] op_sel_hi:[1,0]
    v_pk_mul_f32 v[134:135], v[134:135], s[28:29] op_sel_hi:[1,0]
    v_pk_mul_f32 v[136:137], v[136:137], s[28:29] op_sel_hi:[1,0]
    v_pk_mul_f32 v[138:139], v[138:139], s[28:29] op_sel_hi:[1,0]
    v_pk_mul_f32 v[140:141], v[140:141], s[28:29] op_sel_hi:[1,0]
    v_pk_mul_f32 v[142:143], v[142:143], s[28:29] op_sel_hi:[1,0]
    s_branch L_p1_ns0
L_p1_mx0:
    v_add_u32 v6, 0, v4
    v_cmp_gt_u32 vcc, s41, v6
    v_mov_b32 v7, 1.0
    v_mov_b32 v241, s28
    v_cndmask_b32 v6, v7, v241, vcc
    v_pk_mul_f32 v[128:129], v[128:129], v[6:7] op_sel_hi:[1,0]
    v_pk_mul_f32 v[130:131], v[130:131], v[6:7] op_sel_hi:[1,0]
    v_pk_mul_f32 v[132:133], v[132:133], v[6:7] op_sel_hi:[1,0]
    v_pk_mul_f32 v[134:135], v[134:135], v[6:7] op_sel_hi:[1,0]
    v_pk_mul_f32 v[136:137], v[136:137], v[6:7] op_sel_hi:[1,0]
    v_pk_mul_f32 v[138:139], v[138:139], v[6:7] op_sel_hi:[1,0]
    v_pk_mul_f32 v[140:141], v[140:141], v[6:7] op_sel_hi:[1,0]
    v_pk_mul_f32 v[142:143], v[142:143], v[6:7] op_sel_hi:[1,0]
L_p1_ns0:
    v_cvt_pk_bf16_f32 v40, v128, v129
    v_cvt_pk_bf16_f32 v41, v130, v131
    ds_write_b64 v2, v[40:41] offset:0
    v_cvt_pk_bf16_f32 v42, v132, v133
    v_cvt_pk_bf16_f32 v43, v134, v135
    ds_write_b64 v2, v[42:43] offset:3712
    v_cvt_pk_bf16_f32 v44, v136, v137
    v_cvt_pk_bf16_f32 v45, v138, v139
    ds_write_b64 v2, v[44:45] offset:7424
    v_cvt_pk_bf16_f32 v46, v140, v141
    v_cvt_pk_bf16_f32 v47, v142, v143
    ds_write_b64 v2, v[46:47] offset:11136
    s_cmp_le_u32 s41, 4
    s_cbranch_scc1 L_p1_ns1
    s_cmp_lt_u32 s41, 8
    s_cbranch_scc1 L_p1_mx1
    v_pk_mul_f32 v[144:145], v[144:145], s[28:29] op_sel_hi:[1,0]
    v_pk_mul_f32 v[146:147], v[146:147], s[28:29] op_sel_hi:[1,0]
    v_pk_mul_f32 v[148:149], v[148:149], s[28:29] op_sel_hi:[1,0]
    v_pk_mul_f32 v[150:151], v[150:151], s[28:29] op_sel_hi:[1,0]
    v_pk_mul_f32 v[152:153], v[152:153], s[28:29] op_sel_hi:[1,0]
    v_pk_mul_f32 v[154:155], v[154:155], s[28:29] op_sel_hi:[1,0]
    v_pk_mul_f32 v[156:157], v[156:157], s[28:29] op_sel_hi:[1,0]
    v_pk_mul_f32 v[158:159], v[158:159], s[28:29] op_sel_hi:[1,0]
    s_branch L_p1_ns1
L_p1_mx1:
    v_add_u32 v6, 4, v4
    v_cmp_gt_u32 vcc, s41, v6
    v_mov_b32 v7, 1.0
    v_mov_b32 v241, s28
    v_cndmask_b32 v6, v7, v241, vcc
    v_pk_mul_f32 v[144:145], v[144:145], v[6:7] op_sel_hi:[1,0]
    v_pk_mul_f32 v[146:147], v[146:147], v[6:7] op_sel_hi:[1,0]
    v_pk_mul_f32 v[148:149], v[148:149], v[6:7] op_sel_hi:[1,0]
    v_pk_mul_f32 v[150:151], v[150:151], v[6:7] op_sel_hi:[1,0]
    v_pk_mul_f32 v[152:153], v[152:153], v[6:7] op_sel_hi:[1,0]
    v_pk_mul_f32 v[154:155], v[154:155], v[6:7] op_sel_hi:[1,0]
    v_pk_mul_f32 v[156:157], v[156:157], v[6:7] op_sel_hi:[1,0]
    v_pk_mul_f32 v[158:159], v[158:159], v[6:7] op_sel_hi:[1,0]
L_p1_ns1:
    v_cvt_pk_bf16_f32 v48, v144, v145
    v_cvt_pk_bf16_f32 v49, v146, v147
    ds_write_b64 v2, v[48:49] offset:32
    v_cvt_pk_bf16_f32 v50, v148, v149
    v_cvt_pk_bf16_f32 v51, v150, v151
    ds_write_b64 v2, v[50:51] offset:3744
    v_cvt_pk_bf16_f32 v52, v152, v153
    v_cvt_pk_bf16_f32 v53, v154, v155
    ds_write_b64 v2, v[52:53] offset:7456
    v_cvt_pk_bf16_f32 v54, v156, v157
    v_cvt_pk_bf16_f32 v55, v158, v159
    ds_write_b64 v2, v[54:55] offset:11168
    s_cmp_le_u32 s41, 8
    s_cbranch_scc1 L_p1_ns2
    s_cmp_lt_u32 s41, 12
    s_cbranch_scc1 L_p1_mx2
    v_pk_mul_f32 v[160:161], v[160:161], s[28:29] op_sel_hi:[1,0]
    v_pk_mul_f32 v[162:163], v[162:163], s[28:29] op_sel_hi:[1,0]
    v_pk_mul_f32 v[164:165], v[164:165], s[28:29] op_sel_hi:[1,0]
    v_pk_mul_f32 v[166:167], v[166:167], s[28:29] op_sel_hi:[1,0]
    v_pk_mul_f32 v[168:169], v[168:169], s[28:29] op_sel_hi:[1,0]
    v_pk_mul_f32 v[170:171], v[170:171], s[28:29] op_sel_hi:[1,0]
    v_pk_mul_f32 v[172:173], v[172:173], s[28:29] op_sel_hi:[1,0]
    v_pk_mul_f32 v[174:175], v[174:175], s[28:29] op_sel_hi:[1,0]
    s_branch L_p1_ns2
L_p1_mx2:
    v_add_u32 v6, 8, v4
    v_cmp_gt_u32 vcc, s41, v6
    v_mov_b32 v7, 1.0
    v_mov_b32 v241, s28
    v_cndmask_b32 v6, v7, v241, vcc
    v_pk_mul_f32 v[160:161], v[160:161], v[6:7] op_sel_hi:[1,0]
    v_pk_mul_f32 v[162:163], v[162:163], v[6:7] op_sel_hi:[1,0]
    v_pk_mul_f32 v[164:165], v[164:165], v[6:7] op_sel_hi:[1,0]
    v_pk_mul_f32 v[166:167], v[166:167], v[6:7] op_sel_hi:[1,0]
    v_pk_mul_f32 v[168:169], v[168:169], v[6:7] op_sel_hi:[1,0]
    v_pk_mul_f32 v[170:171], v[170:171], v[6:7] op_sel_hi:[1,0]
    v_pk_mul_f32 v[172:173], v[172:173], v[6:7] op_sel_hi:[1,0]
    v_pk_mul_f32 v[174:175], v[174:175], v[6:7] op_sel_hi:[1,0]
L_p1_ns2:
    v_cvt_pk_bf16_f32 v56, v160, v161
    v_cvt_pk_bf16_f32 v57, v162, v163
    ds_write_b64 v2, v[56:57] offset:64
    v_cvt_pk_bf16_f32 v58, v164, v165
    v_cvt_pk_bf16_f32 v59, v166, v167
    ds_write_b64 v2, v[58:59] offset:3776
    v_cvt_pk_bf16_f32 v60, v168, v169
    v_cvt_pk_bf16_f32 v61, v170, v171
    ds_write_b64 v2, v[60:61] offset:7488
    v_cvt_pk_bf16_f32 v62, v172, v173
    v_cvt_pk_bf16_f32 v63, v174, v175
    ds_write_b64 v2, v[62:63] offset:11200
    s_cmp_eq_u32 s20, 2
    s_cbranch_scc1 L_p1_h0_v
    ds_read2_b64 v[128:131], v8 offset0:0 offset1:1
    ds_read2_b64 v[132:135], v240 offset0:0 offset1:1
    ds_read_b64 v[136:137], v10 offset:32
    s_branch L_p1_h0_e
L_p1_h0_v:
    ds_read_b64_tr_b16 v[128:129], v242 offset:0
    ds_read_b64_tr_b16 v[130:131], v242 offset:928
    ds_read_b64_tr_b16 v[132:133], v242 offset:3712
    ds_read_b64_tr_b16 v[134:135], v242 offset:4640
    ds_read_b64_tr_b16 v[136:137], v242 offset:7424
    ds_read_b64_tr_b16 v[138:139], v242 offset:8352
    ds_read_b64_tr_b16 v[140:141], v242 offset:11136
    ds_read_b64_tr_b16 v[142:143], v242 offset:12064
L_p1_h0_e:
    s_cmp_eq_u32 s21, 2
    s_cbranch_scc1 L_p1_h1_v
    ds_read2_b64 v[144:147], v8 offset0:5 offset1:6
    ds_read2_b64 v[148:151], v240 offset0:5 offset1:6
    s_branch L_p1_h1_e
L_p1_h1_v:
    ds_read_b64_tr_b16 v[144:145], v243 offset:0
    ds_read_b64_tr_b16 v[146:147], v243 offset:928
    ds_read_b64_tr_b16 v[148:149], v243 offset:3712
    ds_read_b64_tr_b16 v[150:151], v243 offset:4640
    ds_read_b64_tr_b16 v[152:153], v243 offset:7424
    ds_read_b64_tr_b16 v[154:155], v243 offset:8352
    ds_read_b64_tr_b16 v[156:157], v243 offset:11136
    ds_read_b64_tr_b16 v[158:159], v243 offset:12064
L_p1_h1_e:
    s_cmp_le_u32 s41, 12
    s_cbranch_scc1 L_p1_ns3
    s_cmp_lt_u32 s41, 16
    s_cbranch_scc1 L_p1_mx3
    v_pk_mul_f32 v[176:177], v[176:177], s[28:29] op_sel_hi:[1,0]
    v_pk_mul_f32 v[178:179], v[178:179], s[28:29] op_sel_hi:[1,0]
    v_pk_mul_f32 v[180:181], v[180:181], s[28:29] op_sel_hi:[1,0]
    v_pk_mul_f32 v[182:183], v[182:183], s[28:29] op_sel_hi:[1,0]
    v_pk_mul_f32 v[184:185], v[184:185], s[28:29] op_sel_hi:[1,0]
    v_pk_mul_f32 v[186:187], v[186:187], s[28:29] op_sel_hi:[1,0]
    v_pk_mul_f32 v[188:189], v[188:189], s[28:29] op_sel_hi:[1,0]
    v_pk_mul_f32 v[190:191], v[190:191], s[28:29] op_sel_hi:[1,0]
    s_branch L_p1_ns3
L_p1_mx3:
    v_add_u32 v6, 12, v4
    v_cmp_gt_u32 vcc, s41, v6
    v_mov_b32 v7, 1.0
    v_mov_b32 v241, s28
    v_cndmask_b32 v6, v7, v241, vcc
    v_pk_mul_f32 v[176:177], v[176:177], v[6:7] op_sel_hi:[1,0]
    v_pk_mul_f32 v[178:179], v[178:179], v[6:7] op_sel_hi:[1,0]
    v_pk_mul_f32 v[180:181], v[180:181], v[6:7] op_sel_hi:[1,0]
    v_pk_mul_f32 v[182:183], v[182:183], v[6:7] op_sel_hi:[1,0]
    v_pk_mul_f32 v[184:185], v[184:185], v[6:7] op_sel_hi:[1,0]
    v_pk_mul_f32 v[186:187], v[186:187], v[6:7] op_sel_hi:[1,0]
    v_pk_mul_f32 v[188:189], v[188:189], v[6:7] op_sel_hi:[1,0]
    v_pk_mul_f32 v[190:191], v[190:191], v[6:7] op_sel_hi:[1,0]
L_p1_ns3:
    v_cvt_pk_bf16_f32 v64, v176, v177
    v_cvt_pk_bf16_f32 v65, v178, v179
    ds_write_b64 v2, v[64:65] offset:96
    v_cvt_pk_bf16_f32 v66, v180, v181
    v_cvt_pk_bf16_f32 v67, v182, v183
    ds_write_b64 v2, v[66:67] offset:3808
    v_cvt_pk_bf16_f32 v68, v184, v185
    v_cvt_pk_bf16_f32 v69, v186, v187
    ds_write_b64 v2, v[68:69] offset:7520
    v_cvt_pk_bf16_f32 v70, v188, v189
    v_cvt_pk_bf16_f32 v71, v190, v191
    ds_write_b64 v2, v[70:71] offset:11232
    s_cmp_le_u32 s41, 16
    s_cbranch_scc1 L_p1_ns4
    s_cmp_lt_u32 s41, 20
    s_cbranch_scc1 L_p1_mx4
    v_pk_mul_f32 v[192:193], v[192:193], s[28:29] op_sel_hi:[1,0]
    v_pk_mul_f32 v[194:195], v[194:195], s[28:29] op_sel_hi:[1,0]
    v_pk_mul_f32 v[196:197], v[196:197], s[28:29] op_sel_hi:[1,0]
    v_pk_mul_f32 v[198:199], v[198:199], s[28:29] op_sel_hi:[1,0]
    v_pk_mul_f32 v[200:201], v[200:201], s[28:29] op_sel_hi:[1,0]
    v_pk_mul_f32 v[202:203], v[202:203], s[28:29] op_sel_hi:[1,0]
    v_pk_mul_f32 v[204:205], v[204:205], s[28:29] op_sel_hi:[1,0]
    v_pk_mul_f32 v[206:207], v[206:207], s[28:29] op_sel_hi:[1,0]
    s_branch L_p1_ns4
L_p1_mx4:
    v_add_u32 v6, 16, v4
    v_cmp_gt_u32 vcc, s41, v6
    v_mov_b32 v7, 1.0
    v_mov_b32 v241, s28
    v_cndmask_b32 v6, v7, v241, vcc
    v_pk_mul_f32 v[192:193], v[192:193], v[6:7] op_sel_hi:[1,0]
    v_pk_mul_f32 v[194:195], v[194:195], v[6:7] op_sel_hi:[1,0]
    v_pk_mul_f32 v[196:197], v[196:197], v[6:7] op_sel_hi:[1,0]
    v_pk_mul_f32 v[198:199], v[198:199], v[6:7] op_sel_hi:[1,0]
    v_pk_mul_f32 v[200:201], v[200:201], v[6:7] op_sel_hi:[1,0]
    v_pk_mul_f32 v[202:203], v[202:203], v[6:7] op_sel_hi:[1,0]
    v_pk_mul_f32 v[204:205], v[204:205], v[6:7] op_sel_hi:[1,0]
    v_pk_mul_f32 v[206:207], v[206:207], v[6:7] op_sel_hi:[1,0]
L_p1_ns4:
    v_cvt_pk_bf16_f32 v40, v192, v193
    v_cvt_pk_bf16_f32 v41, v194, v195
    ds_write_b64 v2, v[40:41] offset:128
    v_cvt_pk_bf16_f32 v42, v196, v197
    v_cvt_pk_bf16_f32 v43, v198, v199
    ds_write_b64 v2, v[42:43] offset:3840
    v_cvt_pk_bf16_f32 v44, v200, v201
    v_cvt_pk_bf16_f32 v45, v202, v203
    ds_write_b64 v2, v[44:45] offset:7552
    v_cvt_pk_bf16_f32 v46, v204, v205
    v_cvt_pk_bf16_f32 v47, v206, v207
    ds_write_b64 v2, v[46:47] offset:11264
    s_waitcnt lgkmcnt(8)
    s_cmp_eq_u32 s20, 2
    s_cbranch_scc1 L_p1_s0_v
    buffer_store_dwordx4 v[128:131], v9, s[16:19], s52 offen sc1
    buffer_store_dwordx4 v[132:135], v9, s[16:19], s52 offen offset:1024 sc1
    buffer_store_dwordx2 v[136:137], v11, s[16:19], s48 offen sc1
    s_branch L_p1_s0_e
L_p1_s0_v:
    s_mov_b32 exec_lo, 262143
    s_mov_b32 exec_hi, 262143
    buffer_store_dwordx4 v[128:131], v250, s[16:19], s52 offen offset:0 sc1
    buffer_store_dwordx4 v[132:135], v250, s[16:19], s52 offen offset:576 sc1
    buffer_store_dwordx4 v[136:139], v250, s[16:19], s52 offen offset:1152 sc1
    buffer_store_dwordx4 v[140:143], v250, s[16:19], s52 offen offset:1728 sc1
    s_mov_b64 exec, -1
L_p1_s0_e:
    s_cmp_eq_u32 s21, 2
    s_cbranch_scc1 L_p1_s1_v
    buffer_store_dwordx4 v[144:147], v9, s[16:19], s53 offen sc1
    buffer_store_dwordx4 v[148:151], v9, s[16:19], s53 offen offset:1024 sc1
    s_branch L_p1_s1_e
L_p1_s1_v:
    s_mov_b32 exec_lo, 851967
    s_mov_b32 exec_hi, 851967
    buffer_store_dwordx4 v[144:147], v251, s[16:19], s53 offen offset:0 sc1
    buffer_store_dwordx4 v[148:151], v251, s[16:19], s53 offen offset:576 sc1
    buffer_store_dwordx4 v[152:155], v251, s[16:19], s53 offen offset:1152 sc1
    buffer_store_dwordx4 v[156:159], v251, s[16:19], s53 offen offset:1728 sc1
    s_mov_b64 exec, -1
L_p1_s1_e:
    s_cmp_eq_u32 s22, 2
    s_cbranch_scc1 L_p1_h2_v
    ds_read2_b64 v[160:163], v8 offset0:9 offset1:10
    ds_read2_b64 v[164:167], v240 offset0:9 offset1:10
    ds_read_b64 v[168:169], v10 offset:104
    s_branch L_p1_h2_e
L_p1_h2_v:
    ds_read_b64_tr_b16 v[160:161], v244 offset:0
    ds_read_b64_tr_b16 v[162:163], v244 offset:928
    ds_read_b64_tr_b16 v[164:165], v244 offset:3712
    ds_read_b64_tr_b16 v[166:167], v244 offset:4640
    ds_read_b64_tr_b16 v[168:169], v244 offset:7424
    ds_read_b64_tr_b16 v[170:171], v244 offset:8352
    ds_read_b64_tr_b16 v[172:173], v244 offset:11136
    ds_read_b64_tr_b16 v[174:175], v244 offset:12064
L_p1_h2_e:
    s_cmp_eq_u32 s23, 2
    s_cbranch_scc1 L_p1_h3_v
    ds_read2_b64 v[176:179], v8 offset0:14 offset1:15
    ds_read2_b64 v[180:183], v240 offset0:14 offset1:15
    s_branch L_p1_h3_e
L_p1_h3_v:
    ds_read_b64_tr_b16 v[176:177], v245 offset:0
    ds_read_b64_tr_b16 v[178:179], v245 offset:928
    ds_read_b64_tr_b16 v[180:181], v245 offset:3712
    ds_read_b64_tr_b16 v[182:183], v245 offset:4640
    ds_read_b64_tr_b16 v[184:185], v245 offset:7424
    ds_read_b64_tr_b16 v[186:187], v245 offset:8352
    ds_read_b64_tr_b16 v[188:189], v245 offset:11136
    ds_read_b64_tr_b16 v[190:191], v245 offset:12064
L_p1_h3_e:
    s_cmp_le_u32 s41, 20
    s_cbranch_scc1 L_p1_ns5
    s_cmp_lt_u32 s41, 24
    s_cbranch_scc1 L_p1_mx5
    v_pk_mul_f32 v[208:209], v[208:209], s[28:29] op_sel_hi:[1,0]
    v_pk_mul_f32 v[210:211], v[210:211], s[28:29] op_sel_hi:[1,0]
    v_pk_mul_f32 v[212:213], v[212:213], s[28:29] op_sel_hi:[1,0]
    v_pk_mul_f32 v[214:215], v[214:215], s[28:29] op_sel_hi:[1,0]
    v_pk_mul_f32 v[216:217], v[216:217], s[28:29] op_sel_hi:[1,0]
    v_pk_mul_f32 v[218:219], v[218:219], s[28:29] op_sel_hi:[1,0]
    v_pk_mul_f32 v[220:221], v[220:221], s[28:29] op_sel_hi:[1,0]
    v_pk_mul_f32 v[222:223], v[222:223], s[28:29] op_sel_hi:[1,0]
    s_branch L_p1_ns5
L_p1_mx5:
    v_add_u32 v6, 20, v4
    v_cmp_gt_u32 vcc, s41, v6
    v_mov_b32 v7, 1.0
    v_mov_b32 v241, s28
    v_cndmask_b32 v6, v7, v241, vcc
    v_pk_mul_f32 v[208:209], v[208:209], v[6:7] op_sel_hi:[1,0]
    v_pk_mul_f32 v[210:211], v[210:211], v[6:7] op_sel_hi:[1,0]
    v_pk_mul_f32 v[212:213], v[212:213], v[6:7] op_sel_hi:[1,0]
    v_pk_mul_f32 v[214:215], v[214:215], v[6:7] op_sel_hi:[1,0]
    v_pk_mul_f32 v[216:217], v[216:217], v[6:7] op_sel_hi:[1,0]
    v_pk_mul_f32 v[218:219], v[218:219], v[6:7] op_sel_hi:[1,0]
    v_pk_mul_f32 v[220:221], v[220:221], v[6:7] op_sel_hi:[1,0]
    v_pk_mul_f32 v[222:223], v[222:223], v[6:7] op_sel_hi:[1,0]
L_p1_ns5:
    v_cvt_pk_bf16_f32 v48, v208, v209
    v_cvt_pk_bf16_f32 v49, v210, v211
    ds_write_b64 v2, v[48:49] offset:160
    v_cvt_pk_bf16_f32 v50, v212, v213
    v_cvt_pk_bf16_f32 v51, v214, v215
    ds_write_b64 v2, v[50:51] offset:3872
    v_cvt_pk_bf16_f32 v52, v216, v217
    v_cvt_pk_bf16_f32 v53, v218, v219
    ds_write_b64 v2, v[52:53] offset:7584
    v_cvt_pk_bf16_f32 v54, v220, v221
    v_cvt_pk_bf16_f32 v55, v222, v223
    ds_write_b64 v2, v[54:55] offset:11296
    s_cmp_le_u32 s41, 24
    s_cbranch_scc1 L_p1_ns6
    s_cmp_lt_u32 s41, 28
    s_cbranch_scc1 L_p1_mx6
    v_pk_mul_f32 v[224:225], v[224:225], s[28:29] op_sel_hi:[1,0]
    v_pk_mul_f32 v[226:227], v[226:227], s[28:29] op_sel_hi:[1,0]
    v_pk_mul_f32 v[228:229], v[228:229], s[28:29] op_sel_hi:[1,0]
    v_pk_mul_f32 v[230:231], v[230:231], s[28:29] op_sel_hi:[1,0]
    v_pk_mul_f32 v[232:233], v[232:233], s[28:29] op_sel_hi:[1,0]
    v_pk_mul_f32 v[234:235], v[234:235], s[28:29] op_sel_hi:[1,0]
    v_pk_mul_f32 v[236:237], v[236:237], s[28:29] op_sel_hi:[1,0]
    v_pk_mul_f32 v[238:239], v[238:239], s[28:29] op_sel_hi:[1,0]
    s_branch L_p1_ns6
L_p1_mx6:
    v_add_u32 v6, 24, v4
    v_cmp_gt_u32 vcc, s41, v6
    v_mov_b32 v7, 1.0
    v_mov_b32 v241, s28
    v_cndmask_b32 v6, v7, v241, vcc
    v_pk_mul_f32 v[224:225], v[224:225], v[6:7] op_sel_hi:[1,0]
    v_pk_mul_f32 v[226:227], v[226:227], v[6:7] op_sel_hi:[1,0]
    v_pk_mul_f32 v[228:229], v[228:229], v[6:7] op_sel_hi:[1,0]
    v_pk_mul_f32 v[230:231], v[230:231], v[6:7] op_sel_hi:[1,0]
    v_pk_mul_f32 v[232:233], v[232:233], v[6:7] op_sel_hi:[1,0]
    v_pk_mul_f32 v[234:235], v[234:235], v[6:7] op_sel_hi:[1,0]
    v_pk_mul_f32 v[236:237], v[236:237], v[6:7] op_sel_hi:[1,0]
    v_pk_mul_f32 v[238:239], v[238:239], v[6:7] op_sel_hi:[1,0]
L_p1_ns6:
    v_cvt_pk_bf16_f32 v56, v224, v225
    v_cvt_pk_bf16_f32 v57, v226, v227
    ds_write_b64 v2, v[56:57] offset:192
    v_cvt_pk_bf16_f32 v58, v228, v229
    v_cvt_pk_bf16_f32 v59, v230, v231
    ds_write_b64 v2, v[58:59] offset:3904
    v_cvt_pk_bf16_f32 v60, v232, v233
    v_cvt_pk_bf16_f32 v61, v234, v235
    ds_write_b64 v2, v[60:61] offset:7616
    v_cvt_pk_bf16_f32 v62, v236, v237
    v_cvt_pk_bf16_f32 v63, v238, v239
    ds_write_b64 v2, v[62:63] offset:11328
    s_waitcnt lgkmcnt(8)
    s_cmp_eq_u32 s22, 2
    s_cbranch_scc1 L_p1_s2_v
    buffer_store_dwordx4 v[160:163], v9, s[16:19], s54 offen sc1
    buffer_store_dwordx4 v[164:167], v9, s[16:19], s54 offen offset:1024 sc1
    buffer_store_dwordx2 v[168:169], v11, s[16:19], s49 offen sc1
    s_branch L_p1_s2_e
L_p1_s2_v:
    s_mov_b32 exec_lo, 262143
    s_mov_b32 exec_hi, 262143
    buffer_store_dwordx4 v[160:163], v250, s[16:19], s54 offen offset:0 sc1
    buffer_store_dwordx4 v[164:167], v250, s[16:19], s54 offen offset:576 sc1
    buffer_store_dwordx4 v[168:171], v250, s[16:19], s54 offen offset:1152 sc1
    buffer_store_dwordx4 v[172:175], v250, s[16:19], s54 offen offset:1728 sc1
    s_mov_b64 exec, -1
L_p1_s2_e:
    s_cmp_eq_u32 s23, 2
    s_cbranch_scc1 L_p1_s3_v
    buffer_store_dwordx4 v[176:179], v9, s[16:19], s55 offen sc1
    buffer_store_dwordx4 v[180:183], v9, s[16:19], s55 offen offset:1024 sc1
    s_branch L_p1_s3_e
L_p1_s3_v:
    s_mov_b32 exec_lo, 851967
    s_mov_b32 exec_hi, 851967
    buffer_store_dwordx4 v[176:179], v251, s[16:19], s55 offen offset:0 sc1
    buffer_store_dwordx4 v[180:183], v251, s[16:19], s55 offen offset:576 sc1
    buffer_store_dwordx4 v[184:187], v251, s[16:19], s55 offen offset:1152 sc1
    buffer_store_dwordx4 v[188:191], v251, s[16:19], s55 offen offset:1728 sc1
    s_mov_b64 exec, -1
L_p1_s3_e:
    s_cmp_eq_u32 s24, 2
    s_cbranch_scc1 L_p1_h4_v
    ds_read2_b64 v[192:195], v8 offset0:18 offset1:19
    ds_read2_b64 v[196:199], v240 offset0:18 offset1:19
    ds_read_b64 v[200:201], v10 offset:176
    s_branch L_p1_h4_e
L_p1_h4_v:
    ds_read_b64_tr_b16 v[192:193], v246 offset:0
    ds_read_b64_tr_b16 v[194:195], v246 offset:928
    ds_read_b64_tr_b16 v[196:197], v246 offset:3712
    ds_read_b64_tr_b16 v[198:199], v246 offset:4640
    ds_read_b64_tr_b16 v[200:201], v246 offset:7424
    ds_read_b64_tr_b16 v[202:203], v246 offset:8352
    ds_read_b64_tr_b16 v[204:205], v246 offset:11136
    ds_read_b64_tr_b16 v[206:207], v246 offset:12064
L_p1_h4_e:
    s_cmp_eq_u32 s25, 2
    s_cbranch_scc1 L_p1_h5_v
    ds_read2_b64 v[208:211], v8 offset0:23 offset1:24
    ds_read2_b64 v[212:215], v240 offset0:23 offset1:24
    s_branch L_p1_h5_e
L_p1_h5_v:
    ds_read_b64_tr_b16 v[208:209], v247 offset:0
    ds_read_b64_tr_b16 v[210:211], v247 offset:928
    ds_read_b64_tr_b16 v[212:213], v247 offset:3712
    ds_read_b64_tr_b16 v[214:215], v247 offset:4640
    ds_read_b64_tr_b16 v[216:217], v247 offset:7424
    ds_read_b64_tr_b16 v[218:219], v247 offset:8352
    ds_read_b64_tr_b16 v[220:221], v247 offset:11136
    ds_read_b64_tr_b16 v[222:223], v247 offset:12064
L_p1_h5_e:
    s_waitcnt lgkmcnt(0)
    s_cmp_eq_u32 s24, 2
    s_cbranch_scc1 L_p1_s4_v
    buffer_store_dwordx4 v[192:195], v9, s[16:19], s56 offen sc1
    buffer_store_dwordx4 v[196:199], v9, s[16:19], s56 offen offset:1024 sc1
    buffer_store_dwordx2 v[200:201], v11, s[16:19], s50 offen sc1
    s_branch L_p1_s4_e
L_p1_s4_v:
    s_mov_b32 exec_lo, 262143
    s_mov_b32 exec_hi, 262143
    buffer_store_dwordx4 v[192:195], v250, s[16:19], s56 offen offset:0 sc1
    buffer_store_dwordx4 v[196:199], v250, s[16:19], s56 offen offset:576 sc1
    buffer_store_dwordx4 v[200:203], v250, s[16:19], s56 offen offset:1152 sc1
    buffer_store_dwordx4 v[204:207], v250, s[16:19], s56 offen offset:1728 sc1
    s_mov_b64 exec, -1
L_p1_s4_e:
    s_cmp_eq_u32 s25, 2
    s_cbranch_scc1 L_p1_s5_v
    buffer_store_dwordx4 v[208:211], v9, s[16:19], s57 offen sc1
    buffer_store_dwordx4 v[212:215], v9, s[16:19], s57 offen offset:1024 sc1
    s_branch L_p1_s5_e
L_p1_s5_v:
    s_mov_b32 exec_lo, 851967
    s_mov_b32 exec_hi, 851967
    buffer_store_dwordx4 v[208:211], v251, s[16:19], s57 offen offset:0 sc1
    buffer_store_dwordx4 v[212:215], v251, s[16:19], s57 offen offset:576 sc1
    buffer_store_dwordx4 v[216:219], v251, s[16:19], s57 offen offset:1152 sc1
    buffer_store_dwordx4 v[220:223], v251, s[16:19], s57 offen offset:1728 sc1
    s_mov_b64 exec, -1
L_p1_s5_e:
    s_branch L_p1_done
L_p1_done:
    s_lshl_b32 s39, s33, 4
    s_add_u32 s39, s39, s35
    s_lshl_b32 s39, s39, 3
    s_add_u32 s39, s39, s34
    s_waitcnt vmcnt(0)
    s_barrier
    s_cmp_lg_u32 s3, 0
    s_cbranch_scc1 L_sig_p1
    s_lshl_b32 s39, s39, 7
    s_add_u32 s39, s39, 19922944
    v_mov_b32 v254, s39
    v_mov_b32 v255, s63
    s_mov_b64 exec, 1
    global_store_dword v254, v255, s[80:81] sc1
    s_mov_b64 exec, -1
L_sig_p1:
    s_and_b32 s18, s2, 7
    s_lshr_b32 s19, s2, 3
    s_lshr_b32 s12, s19, 2
    s_lshl_b32 s18, s18, 3
    s_add_u32 s12, s12, s18
    s_and_b32 s13, s19, 3
    s_mov_b32 s14, s3
    s_and_b32 s18, s12, 31
    s_lshr_b32 s19, s12, 5
    s_lshl_b32 s19, s19, 4
    v_lshrrev_b32 v7, 3, v0
    v_lshlrev_b32 v7, 5, v7
    v_add_u32 v7, s18, v7
    v_mul_u32_u24 v7, 171, v7
    v_lshrrev_b32 v7, 10, v7
    v_add_u32 v7, s19, v7
    v_and_b32 v8, 7, v0
    v_lshl_add_u32 v7, v7, 3, v8
    v_lshlrev_b32 v7, 7, v7
    v_add_u32 v7, 19922944, v7
    s_mov_b32 s8, s80
    s_mov_b32 s9, s81
    s_mov_b32 s10, 20971520
    s_mov_b32 s11, 0x00020000
    v_lshlrev_b32 v2, 4, v0
    v_and_b32 v8, 31, v0
    v_lshlrev_b32 v9, 3, v8
    s_mov_b32 s15, 0
    s_mov_b32 s16, 0x0003ffff
    s_mov_b32 s17, 0x0003ffff
    s_lshl_b32 s30, s14, 10
    s_lshl_b32 s25, s12, 16
    s_add_u32 s35, s25, 4194304
    s_add_u32 s25, s35, s30
    s_mul_i32 s28, s12, 73728
    s_add_u32 s36, s28, 8388608
    s_add_u32 s28, s36, s30
    s_lshr_b32 s38, s12, 1
    s_lshl_b32 s38, s38, 14
    s_and_b32 s39, s12, 1
    s_lshl_b32 s39, s39, 2
    s_add_u32 s37, s38, 14155776
    s_add_u32 s33, s37, s30
    s_add_u32 s29, s30, 65536
    s_add_u32 s34, s30, 139264
    s_mov_b32 s26, s30
    s_lshl_b32 s18, s13, 4
    s_lshl_b32 s19, s14, 1
    s_add_u32 s24, s18, s19
    s_lshr_b32 s18, s12, 5
    s_and_b32 s19, s12, 31
    s_lshl_b32 s46, s18, 21
    s_lshl_b32 s21, s24, 15
    s_add_u32 s46, s46, s21
    s_lshl_b32 s21, s19, 10
    s_add_u32 s46, s46, s21
    s_add_u32 s46, s46, 14680064
    s_lshl_b32 s47, s18, 18
    s_lshl_b32 s21, s24, 12
    s_add_u32 s47, s47, s21
    s_lshl_b32 s21, s19, 7
    s_add_u32 s47, s47, s21
    s_add_u32 s47, s47, 18874368
    s_lshl_b32 s48, s18, 2
    s_add_u32 s48, s48, s13
    s_lshl_b32 s48, s48, 5
    s_add_u32 s48, s48, s19
    s_add_u32 s48, s48, 256
    v_lshlrev_b32 v197, 2, v8
    s_lshl_b32 s49, s12, 16
    s_lshl_b32 s19, s24, 10
    s_add_u32 s49, s49, s19
    s_lshl_b32 s20, s24, 8
    s_add_u32 s50, s38, s20
    s_add_u32 s50, s50, s39
    s_add_u32 s50, s50, 13631488
    v_lshlrev_b32 v196, 3, v0
    s_cmp_lt_u32 s12, 32
    s_cselect_b32 s20, s68, s74
    s_cselect_b32 s21, s69, s75
    s_mov_b32 s22, 663552
    s_mov_b32 s23, 0x00020000
    s_lshr_b32 s18, s2, 3
    s_lshl_b32 s18, s18, 3
    s_add_u32 s18, s18, s14
    s_lshl_b32 s27, s18, 12
    v_lshlrev_b32 v198, 6, v0
    v_lshrrev_b32 v10, 5, v0
    v_add_u32 v3, 139264, v9
    v_add_u32 v3, s39, v3
    v_mul_u32_u24 v11, 288, v10
    v_lshlrev_b32 v12, 4, v8
    v_add_u32 v27, v11, v12
    v_add_u32 v4, 65536, v27
    v_add_u32 v5, 102400, v27
    v_mov_b32 v6, 0xdddd
    v_and_b32 v13, 27, v8
    v_cmp_eq_u32 vcc, 18, v13
    v_mov_b32 v14, 0x3f803f80
    v_mov_b32 v15, 0
    v_cndmask_b32 v13, v15, v14, vcc
    v_mov_b32 v33, 0x3f803f80
    v_mov_b32 v40, v13
    v_mov_b32 v44, v13
    v_mov_b32 v41, v13
    v_mov_b32 v45, v13
    v_mov_b32 v42, v13
    v_mov_b32 v46, v13
    v_mov_b32 v43, v13
    v_mov_b32 v47, v13
    v_mov_b32 v39, 0x3f803f80
    v_mov_b32 v48, v13
    v_mov_b32 v52, v13
    v_mov_b32 v49, v13
    v_mov_b32 v53, v13
    v_mov_b32 v50, v13
    v_mov_b32 v54, v13
    v_mov_b32 v51, v13
    v_mov_b32 v55, v13
    v_mov_b32 v25, 0
    v_mov_b32 v120, 0
    v_mov_b32 v121, 0
    v_mov_b32 v122, 0
    v_mov_b32 v123, 0
    v_mov_b32 v124, 0
    v_mov_b32 v125, 0
    v_mov_b32 v126, 0
    v_mov_b32 v127, 0
    v_mov_b32 v128, 0
    v_mov_b32 v129, 0
    v_mov_b32 v130, 0
    v_mov_b32 v131, 0
    v_mov_b32 v132, 0
    v_mov_b32 v133, 0
    v_mov_b32 v134, 0
    v_mov_b32 v135, 0
    v_mov_b32 v136, 0
    v_mov_b32 v137, 0
    v_mov_b32 v138, 0
    v_mov_b32 v139, 0
    v_mov_b32 v140, 0
    v_mov_b32 v141, 0
    v_mov_b32 v142, 0
    v_mov_b32 v143, 0
    v_mov_b32 v144, 0
    v_mov_b32 v145, 0
    v_mov_b32 v146, 0
    v_mov_b32 v147, 0
    v_mov_b32 v148, 0
    v_mov_b32 v149, 0
    v_mov_b32 v150, 0
    v_mov_b32 v151, 0
    s_cmp_lg_u32 s3, 0
    s_cbranch_scc1 L_polled_p1
    s_mov_b32 s40, 0
    s_mov_b32 exec_hi, 0
    s_mov_b32 exec_lo, 16777215
L_poll_p1:
    global_load_dword v255, v7, s[80:81] sc1
    s_waitcnt vmcnt(0)
    v_cmp_ne_u32 vcc, s63, v255
    s_cmp_eq_u64 vcc, 0
    s_cbranch_scc1 L_pollok_p1
    s_sleep 1
    s_add_u32 s40, s40, 1
    s_cmp_lt_u32 s40, 400000
    s_cbranch_scc1 L_poll_p1
L_pollok_p1:
    s_mov_b64 exec, -1
L_polled_p1:
    s_barrier
    s_mov_b32 m0, s34
    s_nop 0
    buffer_load_dwordx4 v2, s[8:11], s33 offen sc1 lds
    s_mov_b32 m0, s26
    s_add_u32 s26, s26, 8192
    buffer_load_dwordx4 v2, s[8:11], s25 offen sc1 lds
    s_add_u32 s25, s25, 8192
    s_mov_b32 m0, s29
    s_add_u32 s29, s29, 8192
    buffer_load_dwordx4 v2, s[8:11], s28 offen sc1 lds
    s_add_u32 s28, s28, 8192
    s_mov_b32 m0, s29
    s_add_u32 s29, s29, 8192
    buffer_load_dwordx4 v2, s[8:11], s28 offen sc1 lds
    s_add_u32 s28, s28, 8192
    buffer_load_dwordx4 v[16:19], v2, s[8:11], s49 offen offset:0 sc1
    buffer_load_dwordx4 v[20:23], v2, s[8:11], s49 offen offset:1024 sc1
    buffer_load_dword v24, v196, s[8:11], s50 offen sc1
    s_waitcnt vmcnt(0)
    s_barrier
    s_cmp_ge_u32 s14, 4
    s_cbranch_scc1 L_p2_loopB
    ds_read_b128 v[28:31], v2 offset:0
    ds_read_b32 v32, v3 offset:0
    s_mov_b64 exec, s[16:17]
    ds_read_b128 v[40:43], v4 offset:0
    ds_read_b128 v[44:47], v4 offset:576
    s_mov_b64 exec, -1
    s_waitcnt lgkmcnt(0)
    v_mfma_f32_32x32x4_2b_bf16 v[56:87], v[32:33], v[24:25], 0
    ds_read_b128 v[34:37], v2 offset:1024
    ds_read_b32 v38, v3 offset:256
    s_nop 15
    s_nop 1
    v_mfma_f32_32x32x16_bf16 v[56:71], v[28:31], v[16:19], v[56:71]
    v_mfma_f32_32x32x16_bf16 v[72:87], v[28:31], v[20:23], v[72:87]
    s_nop 7
    s_nop 3
    s_mov_b32 m0, s26
    s_add_u32 s26, s26, 8192
    buffer_load_dwordx4 v2, s[8:11], s25 offen sc1 lds
    s_add_u32 s25, s25, 8192
    s_mov_b32 m0, s29
    s_add_u32 s29, s29, 8192
    buffer_load_dwordx4 v2, s[8:11], s28 offen sc1 lds
    s_add_u32 s28, s28, 8192
    s_add_u32 m0, s34, 8192
    s_add_u32 s33, s33, 8192
    buffer_load_dwordx4 v2, s[8:11], s33 offen sc1 lds
    s_setprio 1
    s_waitcnt lgkmcnt(0)
    s_mov_b64 exec, s[16:17]
    ds_read_b128 v[48:51], v4 offset:1152
    ds_read_b128 v[52:55], v4 offset:1728
    s_mov_b64 exec, -1
    v_exp_f32 v56, v56
    v_exp_f32 v57, v57
    v_exp_f32 v58, v58
    v_exp_f32 v59, v59
    v_mfma_f32_32x32x4_2b_bf16 v[88:119], v[38:39], v[24:25], 0
    v_exp_f32 v60, v60
    v_exp_f32 v61, v61
    v_exp_f32 v62, v62
    v_exp_f32 v63, v63
    v_exp_f32 v64, v64
    v_exp_f32 v65, v65
    v_exp_f32 v66, v66
    v_exp_f32 v67, v67
    v_smfmac_f32_32x32x32_bf16 v[120:135], v[40:43], v[56:63], v6
    v_exp_f32 v68, v68
    v_exp_f32 v69, v69
    v_exp_f32 v70, v70
    v_exp_f32 v71, v71
    ds_read_b128 v[28:31], v2 offset:2048
    ds_read_b32 v32, v3 offset:512
    v_smfmac_f32_32x32x32_bf16 v[120:135], v[44:47], v[64:71], v6
    v_exp_f32 v72, v72
    v_exp_f32 v73, v73
    v_exp_f32 v74, v74
    v_exp_f32 v75, v75
    v_mfma_f32_32x32x16_bf16 v[88:103], v[34:37], v[16:19], v[88:103]
    v_exp_f32 v76, v76
    v_exp_f32 v77, v77
    v_exp_f32 v78, v78
    v_exp_f32 v79, v79
    v_mfma_f32_32x32x16_bf16 v[104:119], v[34:37], v[20:23], v[104:119]
    v_exp_f32 v80, v80
    v_exp_f32 v81, v81
    v_exp_f32 v82, v82
    v_exp_f32 v83, v83
    v_smfmac_f32_32x32x32_bf16 v[136:151], v[40:43], v[72:79], v6
    v_exp_f32 v84, v84
    v_exp_f32 v85, v85
    v_exp_f32 v86, v86
    v_exp_f32 v87, v87
    s_mov_b32 m0, s26
    s_add_u32 s26, s26, 8192
    buffer_load_dwordx4 v2, s[8:11], s25 offen sc1 lds
    s_add_u32 s25, s25, 8192
    s_mov_b32 m0, s29
    s_add_u32 s29, s29, 8192
    buffer_load_dwordx4 v2, s[8:11], s28 offen sc1 lds
    s_add_u32 s28, s28, 8192
    s_nop 0
    s_waitcnt lgkmcnt(0)
    v_smfmac_f32_32x32x32_bf16 v[136:151], v[44:47], v[80:87], v6
    s_mov_b64 exec, s[16:17]
    ds_read_b128 v[40:43], v4 offset:2304
    ds_read_b128 v[44:47], v4 offset:2880
    s_mov_b64 exec, -1
    v_exp_f32 v88, v88
    v_exp_f32 v89, v89
    v_exp_f32 v90, v90
    v_exp_f32 v91, v91
    v_mfma_f32_32x32x4_2b_bf16 v[56:87], v[32:33], v[24:25], 0
    v_exp_f32 v92, v92
    v_exp_f32 v93, v93
    v_exp_f32 v94, v94
    v_exp_f32 v95, v95
    v_exp_f32 v96, v96
    v_exp_f32 v97, v97
    v_exp_f32 v98, v98
    v_exp_f32 v99, v99
    v_smfmac_f32_32x32x32_bf16 v[120:135], v[48:51], v[88:95], v6
    v_exp_f32 v100, v100
    v_exp_f32 v101, v101
    v_exp_f32 v102, v102
    v_exp_f32 v103, v103
    ds_read_b128 v[34:37], v2 offset:3072
    ds_read_b32 v38, v3 offset:768
    v_smfmac_f32_32x32x32_bf16 v[120:135], v[52:55], v[96:103], v6
    v_exp_f32 v104, v104
    v_exp_f32 v105, v105
    v_exp_f32 v106, v106
    v_exp_f32 v107, v107
    v_mfma_f32_32x32x16_bf16 v[56:71], v[28:31], v[16:19], v[56:71]
    v_exp_f32 v108, v108
    v_exp_f32 v109, v109
    v_exp_f32 v110, v110
    v_exp_f32 v111, v111
    v_mfma_f32_32x32x16_bf16 v[72:87], v[28:31], v[20:23], v[72:87]
    v_exp_f32 v112, v112
    v_exp_f32 v113, v113
    v_exp_f32 v114, v114
    v_exp_f32 v115, v115
    v_smfmac_f32_32x32x32_bf16 v[136:151], v[48:51], v[104:111], v6
    v_exp_f32 v116, v116
    v_exp_f32 v117, v117
    v_exp_f32 v118, v118
    v_exp_f32 v119, v119
    s_mov_b32 m0, s26
    s_add_u32 s26, s26, 8192
    buffer_load_dwordx4 v2, s[8:11], s25 offen sc1 lds
    s_add_u32 s25, s25, 8192
    s_mov_b32 m0, s29
    s_add_u32 s29, s29, 8192
    buffer_load_dwordx4 v2, s[8:11], s28 offen sc1 lds
    s_add_u32 s28, s28, 8192
    s_nop 0
    s_waitcnt lgkmcnt(0)
    v_smfmac_f32_32x32x32_bf16 v[136:151], v[52:55], v[112:119], v6
    s_mov_b64 exec, s[16:17]
    ds_read_b128 v[48:51], v4 offset:3456
    ds_read_b128 v[52:55], v4 offset:4032
    s_mov_b64 exec, -1
    v_exp_f32 v56, v56
    v_exp_f32 v57, v57
    v_exp_f32 v58, v58
    v_exp_f32 v59, v59
    v_mfma_f32_32x32x4_2b_bf16 v[88:119], v[38:39], v[24:25], 0
    v_exp_f32 v60, v60
    v_exp_f32 v61, v61
    v_exp_f32 v62, v62
    v_exp_f32 v63, v63
    v_exp_f32 v64, v64
    v_exp_f32 v65, v65
    v_exp_f32 v66, v66
    v_exp_f32 v67, v67
    v_smfmac_f32_32x32x32_bf16 v[120:135], v[40:43], v[56:63], v6
    v_exp_f32 v68, v68
    v_exp_f32 v69, v69
    v_exp_f32 v70, v70
    v_exp_f32 v71, v71
    ds_read_b128 v[28:31], v2 offset:4096
    ds_read_b32 v32, v3 offset:1024
    v_smfmac_f32_32x32x32_bf16 v[120:135], v[44:47], v[64:71], v6
    v_exp_f32 v72, v72
    v_exp_f32 v73, v73
    v_exp_f32 v74, v74
    v_exp_f32 v75, v75
    v_mfma_f32_32x32x16_bf16 v[88:103], v[34:37], v[16:19], v[88:103]
    v_exp_f32 v76, v76
    v_exp_f32 v77, v77
    v_exp_f32 v78, v78
    v_exp_f32 v79, v79
    v_mfma_f32_32x32x16_bf16 v[104:119], v[34:37], v[20:23], v[104:119]
    v_exp_f32 v80, v80
    v_exp_f32 v81, v81
    v_exp_f32 v82, v82
    v_exp_f32 v83, v83
    v_smfmac_f32_32x32x32_bf16 v[136:151], v[40:43], v[72:79], v6
    v_exp_f32 v84, v84
    v_exp_f32 v85, v85
    v_exp_f32 v86, v86
    v_exp_f32 v87, v87
    s_mov_b32 m0, s26
    s_add_u32 s26, s26, 8192
    buffer_load_dwordx4 v2, s[8:11], s25 offen sc1 lds
    s_add_u32 s25, s25, 8192
    s_mov_b32 m0, s29
    s_add_u32 s29, s29, 8192
    buffer_load_dwordx4 v2, s[8:11], s28 offen sc1 lds
    s_add_u32 s28, s28, 8192
    s_nop 0
    s_waitcnt lgkmcnt(0)
    v_smfmac_f32_32x32x32_bf16 v[136:151], v[44:47], v[80:87], v6
    s_mov_b64 exec, s[16:17]
    ds_read_b128 v[40:43], v4 offset:4608
    ds_read_b128 v[44:47], v4 offset:5184
    s_mov_b64 exec, -1
    v_exp_f32 v88, v88
    v_exp_f32 v89, v89
    v_exp_f32 v90, v90
    v_exp_f32 v91, v91
    v_mfma_f32_32x32x4_2b_bf16 v[56:87], v[32:33], v[24:25], 0
    v_exp_f32 v92, v92
    v_exp_f32 v93, v93
    v_exp_f32 v94, v94
    v_exp_f32 v95, v95
    v_exp_f32 v96, v96
    v_exp_f32 v97, v97
    v_exp_f32 v98, v98
    v_exp_f32 v99, v99
    v_smfmac_f32_32x32x32_bf16 v[120:135], v[48:51], v[88:95], v6
    v_exp_f32 v100, v100
    v_exp_f32 v101, v101
    v_exp_f32 v102, v102
    v_exp_f32 v103, v103
    ds_read_b128 v[34:37], v2 offset:5120
    ds_read_b32 v38, v3 offset:1280
    v_smfmac_f32_32x32x32_bf16 v[120:135], v[52:55], v[96:103], v6
    v_exp_f32 v104, v104
    v_exp_f32 v105, v105
    v_exp_f32 v106, v106
    v_exp_f32 v107, v107
    v_mfma_f32_32x32x16_bf16 v[56:71], v[28:31], v[16:19], v[56:71]
    v_exp_f32 v108, v108
    v_exp_f32 v109, v109
    v_exp_f32 v110, v110
    v_exp_f32 v111, v111
    v_mfma_f32_32x32x16_bf16 v[72:87], v[28:31], v[20:23], v[72:87]
    v_exp_f32 v112, v112
    v_exp_f32 v113, v113
    v_exp_f32 v114, v114
    v_exp_f32 v115, v115
    v_smfmac_f32_32x32x32_bf16 v[136:151], v[48:51], v[104:111], v6
    v_exp_f32 v116, v116
    v_exp_f32 v117, v117
    v_exp_f32 v118, v118
    v_exp_f32 v119, v119
    s_mov_b32 m0, s26
    s_add_u32 s26, s26, 8192
    buffer_load_dwordx4 v2, s[8:11], s25 offen sc1 lds
    s_add_u32 s25, s25, 8192
    s_mov_b32 m0, s29
    s_add_u32 s29, s29, 8192
    buffer_load_dwordx4 v2, s[8:11], s28 offen sc1 lds
    s_add_u32 s28, s28, 8192
    s_nop 0
    s_waitcnt lgkmcnt(0)
    v_smfmac_f32_32x32x32_bf16 v[136:151], v[52:55], v[112:119], v6
    s_mov_b64 exec, s[16:17]
    ds_read_b128 v[48:51], v4 offset:5760
    ds_read_b128 v[52:55], v4 offset:6336
    s_mov_b64 exec, -1
    v_exp_f32 v56, v56
    v_exp_f32 v57, v57
    v_exp_f32 v58, v58
    v_exp_f32 v59, v59
    v_mfma_f32_32x32x4_2b_bf16 v[88:119], v[38:39], v[24:25], 0
    v_exp_f32 v60, v60
    v_exp_f32 v61, v61
    v_exp_f32 v62, v62
    v_exp_f32 v63, v63
    v_exp_f32 v64, v64
    v_exp_f32 v65, v65
    v_exp_f32 v66, v66
    v_exp_f32 v67, v67
    v_smfmac_f32_32x32x32_bf16 v[120:135], v[40:43], v[56:63], v6
    v_exp_f32 v68, v68
    v_exp_f32 v69, v69
    v_exp_f32 v70, v70
    v_exp_f32 v71, v71
    ds_read_b128 v[28:31], v2 offset:6144
    ds_read_b32 v32, v3 offset:1536
    v_smfmac_f32_32x32x32_bf16 v[120:135], v[44:47], v[64:71], v6
    v_exp_f32 v72, v72
    v_exp_f32 v73, v73
    v_exp_f32 v74, v74
    v_exp_f32 v75, v75
    v_mfma_f32_32x32x16_bf16 v[88:103], v[34:37], v[16:19], v[88:103]
    v_exp_f32 v76, v76
    v_exp_f32 v77, v77
    v_exp_f32 v78, v78
    v_exp_f32 v79, v79
    v_mfma_f32_32x32x16_bf16 v[104:119], v[34:37], v[20:23], v[104:119]
    v_exp_f32 v80, v80
    v_exp_f32 v81, v81
    v_exp_f32 v82, v82
    v_exp_f32 v83, v83
    v_smfmac_f32_32x32x32_bf16 v[136:151], v[40:43], v[72:79], v6
    v_exp_f32 v84, v84
    v_exp_f32 v85, v85
    v_exp_f32 v86, v86
    v_exp_f32 v87, v87
    s_waitcnt vmcnt(4)
    s_barrier
    s_mov_b32 m0, s26
    s_add_u32 s26, s26, 8192
    buffer_load_dwordx4 v2, s[8:11], s25 offen sc1 lds
    s_add_u32 s25, s25, 8192
    s_mov_b32 m0, s29
    s_add_u32 s29, s29, 8192
    buffer_load_dwordx4 v2, s[8:11], s28 offen sc1 lds
    s_add_u32 s28, s28, 8192
    s_nop 0
    s_waitcnt lgkmcnt(0)
    v_smfmac_f32_32x32x32_bf16 v[136:151], v[44:47], v[80:87], v6
    s_mov_b64 exec, s[16:17]
    ds_read_b128 v[40:43], v4 offset:6912
    ds_read_b128 v[44:47], v4 offset:7488
    s_mov_b64 exec, -1
    v_exp_f32 v88, v88
    v_exp_f32 v89, v89
    v_exp_f32 v90, v90
    v_exp_f32 v91, v91
    v_mfma_f32_32x32x4_2b_bf16 v[56:87], v[32:33], v[24:25], 0
    v_exp_f32 v92, v92
    v_exp_f32 v93, v93
    v_exp_f32 v94, v94
    v_exp_f32 v95, v95
    v_exp_f32 v96, v96
    v_exp_f32 v97, v97
    v_exp_f32 v98, v98
    v_exp_f32 v99, v99
    v_smfmac_f32_32x32x32_bf16 v[120:135], v[48:51], v[88:95], v6
    v_exp_f32 v100, v100
    v_exp_f32 v101, v101
    v_exp_f32 v102, v102
    v_exp_f32 v103, v103
    ds_read_b128 v[34:37], v2 offset:7168
    ds_read_b32 v38, v3 offset:1792
    v_smfmac_f32_32x32x32_bf16 v[120:135], v[52:55], v[96:103], v6
    v_exp_f32 v104, v104
    v_exp_f32 v105, v105
    v_exp_f32 v106, v106
    v_exp_f32 v107, v107
    v_mfma_f32_32x32x16_bf16 v[56:71], v[28:31], v[16:19], v[56:71]
    v_exp_f32 v108, v108
    v_exp_f32 v109, v109
    v_exp_f32 v110, v110
    v_exp_f32 v111, v111
    v_mfma_f32_32x32x16_bf16 v[72:87], v[28:31], v[20:23], v[72:87]
    v_exp_f32 v112, v112
    v_exp_f32 v113, v113
    v_exp_f32 v114, v114
    v_exp_f32 v115, v115
    v_smfmac_f32_32x32x32_bf16 v[136:151], v[48:51], v[104:111], v6
    v_exp_f32 v116, v116
    v_exp_f32 v117, v117
    v_exp_f32 v118, v118
    v_exp_f32 v119, v119
    s_mov_b32 m0, s26
    s_add_u32 s26, s26, 8192
    buffer_load_dwordx4 v2, s[8:11], s25 offen sc1 lds
    s_add_u32 s25, s25, 8192
    s_mov_b32 m0, s29
    s_add_u32 s29, s29, 8192
    buffer_load_dwordx4 v2, s[8:11], s28 offen sc1 lds
    s_add_u32 s28, s28, 8192
    s_nop 0
    s_waitcnt lgkmcnt(0)
    v_smfmac_f32_32x32x32_bf16 v[136:151], v[52:55], v[112:119], v6
    s_mov_b64 exec, s[16:17]
    ds_read_b128 v[48:51], v4 offset:8064
    ds_read_b128 v[52:55], v4 offset:8640
    s_mov_b64 exec, -1
    v_exp_f32 v56, v56
    v_exp_f32 v57, v57
    v_exp_f32 v58, v58
    v_exp_f32 v59, v59
    v_mfma_f32_32x32x4_2b_bf16 v[88:119], v[38:39], v[24:25], 0
    v_exp_f32 v60, v60
    v_exp_f32 v61, v61
    v_exp_f32 v62, v62
    v_exp_f32 v63, v63
    v_exp_f32 v64, v64
    v_exp_f32 v65, v65
    v_exp_f32 v66, v66
    v_exp_f32 v67, v67
    v_smfmac_f32_32x32x32_bf16 v[120:135], v[40:43], v[56:63], v6
    v_exp_f32 v68, v68
    v_exp_f32 v69, v69
    v_exp_f32 v70, v70
    v_exp_f32 v71, v71
    ds_read_b128 v[28:31], v2 offset:8192
    ds_read_b32 v32, v3 offset:2048
    v_smfmac_f32_32x32x32_bf16 v[120:135], v[44:47], v[64:71], v6
    v_exp_f32 v72, v72
    v_exp_f32 v73, v73
    v_exp_f32 v74, v74
    v_exp_f32 v75, v75
    v_mfma_f32_32x32x16_bf16 v[88:103], v[34:37], v[16:19], v[88:103]
    v_exp_f32 v76, v76
    v_exp_f32 v77, v77
    v_exp_f32 v78, v78
    v_exp_f32 v79, v79
    v_mfma_f32_32x32x16_bf16 v[104:119], v[34:37], v[20:23], v[104:119]
    v_exp_f32 v80, v80
    v_exp_f32 v81, v81
    v_exp_f32 v82, v82
    v_exp_f32 v83, v83
    v_smfmac_f32_32x32x32_bf16 v[136:151], v[40:43], v[72:79], v6
    v_exp_f32 v84, v84
    v_exp_f32 v85, v85
    v_exp_f32 v86, v86
    v_exp_f32 v87, v87
    s_nop 0
    s_waitcnt lgkmcnt(0)
    v_smfmac_f32_32x32x32_bf16 v[136:151], v[44:47], v[80:87], v6
    s_mov_b64 exec, s[16:17]
    ds_read_b128 v[40:43], v4 offset:9216
    ds_read_b128 v[44:47], v4 offset:9792
    s_mov_b64 exec, -1
    v_exp_f32 v88, v88
    v_exp_f32 v89, v89
    v_exp_f32 v90, v90
    v_exp_f32 v91, v91
    v_mfma_f32_32x32x4_2b_bf16 v[56:87], v[32:33], v[24:25], 0
    v_exp_f32 v92, v92
    v_exp_f32 v93, v93
    v_exp_f32 v94, v94
    v_exp_f32 v95, v95
    v_exp_f32 v96, v96
    v_exp_f32 v97, v97
    v_exp_f32 v98, v98
    v_exp_f32 v99, v99
    v_smfmac_f32_32x32x32_bf16 v[120:135], v[48:51], v[88:95], v6
    v_exp_f32 v100, v100
    v_exp_f32 v101, v101
    v_exp_f32 v102, v102
    v_exp_f32 v103, v103
    ds_read_b128 v[34:37], v2 offset:9216
    ds_read_b32 v38, v3 offset:2304
    v_smfmac_f32_32x32x32_bf16 v[120:135], v[52:55], v[96:103], v6
    v_exp_f32 v104, v104
    v_exp_f32 v105, v105
    v_exp_f32 v106, v106
    v_exp_f32 v107, v107
    v_mfma_f32_32x32x16_bf16 v[56:71], v[28:31], v[16:19], v[56:71]
    v_exp_f32 v108, v108
    v_exp_f32 v109, v109
    v_exp_f32 v110, v110
    v_exp_f32 v111, v111
    v_mfma_f32_32x32x16_bf16 v[72:87], v[28:31], v[20:23], v[72:87]
    v_exp_f32 v112, v112
    v_exp_f32 v113, v113
    v_exp_f32 v114, v114
    v_exp_f32 v115, v115
    v_smfmac_f32_32x32x32_bf16 v[136:151], v[48:51], v[104:111], v6
    v_exp_f32 v116, v116
    v_exp_f32 v117, v117
    v_exp_f32 v118, v118
    v_exp_f32 v119, v119
    s_nop 0
    s_waitcnt lgkmcnt(0)
    v_smfmac_f32_32x32x32_bf16 v[136:151], v[52:55], v[112:119], v6
    s_mov_b64 exec, s[16:17]
    ds_read_b128 v[48:51], v4 offset:10368
    ds_read_b128 v[52:55], v4 offset:10944
    s_mov_b64 exec, -1
    v_exp_f32 v56, v56
    v_exp_f32 v57, v57
    v_exp_f32 v58, v58
    v_exp_f32 v59, v59
    v_mfma_f32_32x32x4_2b_bf16 v[88:119], v[38:39], v[24:25], 0
    v_exp_f32 v60, v60
    v_exp_f32 v61, v61
    v_exp_f32 v62, v62
    v_exp_f32 v63, v63
    v_exp_f32 v64, v64
    v_exp_f32 v65, v65
    v_exp_f32 v66, v66
    v_exp_f32 v67, v67
    v_smfmac_f32_32x32x32_bf16 v[120:135], v[40:43], v[56:63], v6
    v_exp_f32 v68, v68
    v_exp_f32 v69, v69
    v_exp_f32 v70, v70
    v_exp_f32 v71, v71
    ds_read_b128 v[28:31], v2 offset:10240
    ds_read_b32 v32, v3 offset:2560
    v_smfmac_f32_32x32x32_bf16 v[120:135], v[44:47], v[64:71], v6
    v_exp_f32 v72, v72
    v_exp_f32 v73, v73
    v_exp_f32 v74, v74
    v_exp_f32 v75, v75
    v_mfma_f32_32x32x16_bf16 v[88:103], v[34:37], v[16:19], v[88:103]
    v_exp_f32 v76, v76
    v_exp_f32 v77, v77
    v_exp_f32 v78, v78
    v_exp_f32 v79, v79
    v_mfma_f32_32x32x16_bf16 v[104:119], v[34:37], v[20:23], v[104:119]
    v_exp_f32 v80, v80
    v_exp_f32 v81, v81
    v_exp_f32 v82, v82
    v_exp_f32 v83, v83
    v_smfmac_f32_32x32x32_bf16 v[136:151], v[40:43], v[72:79], v6
    v_exp_f32 v84, v84
    v_exp_f32 v85, v85
    v_exp_f32 v86, v86
    v_exp_f32 v87, v87
    buffer_load_dword v199, v198, s[20:23], s27 offen
    s_nop 0
    s_waitcnt lgkmcnt(0)
    v_smfmac_f32_32x32x32_bf16 v[136:151], v[44:47], v[80:87], v6
    s_mov_b64 exec, s[16:17]
    ds_read_b128 v[40:43], v4 offset:11520
    ds_read_b128 v[44:47], v4 offset:12096
    s_mov_b64 exec, -1
    v_exp_f32 v88, v88
    v_exp_f32 v89, v89
    v_exp_f32 v90, v90
    v_exp_f32 v91, v91
    v_mfma_f32_32x32x4_2b_bf16 v[56:87], v[32:33], v[24:25], 0
    v_exp_f32 v92, v92
    v_exp_f32 v93, v93
    v_exp_f32 v94, v94
    v_exp_f32 v95, v95
    v_exp_f32 v96, v96
    v_exp_f32 v97, v97
    v_exp_f32 v98, v98
    v_exp_f32 v99, v99
    v_smfmac_f32_32x32x32_bf16 v[120:135], v[48:51], v[88:95], v6
    v_exp_f32 v100, v100
    v_exp_f32 v101, v101
    v_exp_f32 v102, v102
    v_exp_f32 v103, v103
    ds_read_b128 v[34:37], v2 offset:11264
    ds_read_b32 v38, v3 offset:2816
    v_smfmac_f32_32x32x32_bf16 v[120:135], v[52:55], v[96:103], v6
    v_exp_f32 v104, v104
    v_exp_f32 v105, v105
    v_exp_f32 v106, v106
    v_exp_f32 v107, v107
    v_mfma_f32_32x32x16_bf16 v[56:71], v[28:31], v[16:19], v[56:71]
    v_exp_f32 v108, v108
    v_exp_f32 v109, v109
    v_exp_f32 v110, v110
    v_exp_f32 v111, v111
    v_mfma_f32_32x32x16_bf16 v[72:87], v[28:31], v[20:23], v[72:87]
    v_exp_f32 v112, v112
    v_exp_f32 v113, v113
    v_exp_f32 v114, v114
    v_exp_f32 v115, v115
    v_smfmac_f32_32x32x32_bf16 v[136:151], v[48:51], v[104:111], v6
    v_exp_f32 v116, v116
    v_exp_f32 v117, v117
    v_exp_f32 v118, v118
    v_exp_f32 v119, v119
    s_nop 0
    s_waitcnt lgkmcnt(0)
    v_smfmac_f32_32x32x32_bf16 v[136:151], v[52:55], v[112:119], v6
    s_mov_b64 exec, s[16:17]
    ds_read_b128 v[48:51], v4 offset:12672
    ds_read_b128 v[52:55], v4 offset:13248
    s_mov_b64 exec, -1
    v_exp_f32 v56, v56
    v_exp_f32 v57, v57
    v_exp_f32 v58, v58
    v_exp_f32 v59, v59
    v_mfma_f32_32x32x4_2b_bf16 v[88:119], v[38:39], v[24:25], 0
    v_exp_f32 v60, v60
    v_exp_f32 v61, v61
    v_exp_f32 v62, v62
    v_exp_f32 v63, v63
    v_exp_f32 v64, v64
    v_exp_f32 v65, v65
    v_exp_f32 v66, v66
    v_exp_f32 v67, v67
    v_smfmac_f32_32x32x32_bf16 v[120:135], v[40:43], v[56:63], v6
    v_exp_f32 v68, v68
    v_exp_f32 v69, v69
    v_exp_f32 v70, v70
    v_exp_f32 v71, v71
    ds_read_b128 v[28:31], v2 offset:12288
    ds_read_b32 v32, v3 offset:3072
    v_smfmac_f32_32x32x32_bf16 v[120:135], v[44:47], v[64:71], v6
    v_exp_f32 v72, v72
    v_exp_f32 v73, v73
    v_exp_f32 v74, v74
    v_exp_f32 v75, v75
    v_mfma_f32_32x32x16_bf16 v[88:103], v[34:37], v[16:19], v[88:103]
    v_exp_f32 v76, v76
    v_exp_f32 v77, v77
    v_exp_f32 v78, v78
    v_exp_f32 v79, v79
    v_mfma_f32_32x32x16_bf16 v[104:119], v[34:37], v[20:23], v[104:119]
    v_exp_f32 v80, v80
    v_exp_f32 v81, v81
    v_exp_f32 v82, v82
    v_exp_f32 v83, v83
    v_smfmac_f32_32x32x32_bf16 v[136:151], v[40:43], v[72:79], v6
    v_exp_f32 v84, v84
    v_exp_f32 v85, v85
    v_exp_f32 v86, v86
    v_exp_f32 v87, v87
    s_nop 0
    s_waitcnt lgkmcnt(0)
    v_smfmac_f32_32x32x32_bf16 v[136:151], v[44:47], v[80:87], v6
    s_mov_b64 exec, s[16:17]
    ds_read_b128 v[40:43], v4 offset:13824
    ds_read_b128 v[44:47], v4 offset:14400
    s_mov_b64 exec, -1
    v_exp_f32 v88, v88
    v_exp_f32 v89, v89
    v_exp_f32 v90, v90
    v_exp_f32 v91, v91
    v_mfma_f32_32x32x4_2b_bf16 v[56:87], v[32:33], v[24:25], 0
    v_exp_f32 v92, v92
    v_exp_f32 v93, v93
    v_exp_f32 v94, v94
    v_exp_f32 v95, v95
    v_exp_f32 v96, v96
    v_exp_f32 v97, v97
    v_exp_f32 v98, v98
    v_exp_f32 v99, v99
    v_smfmac_f32_32x32x32_bf16 v[120:135], v[48:51], v[88:95], v6
    v_exp_f32 v100, v100
    v_exp_f32 v101, v101
    v_exp_f32 v102, v102
    v_exp_f32 v103, v103
    ds_read_b128 v[34:37], v2 offset:13312
    ds_read_b32 v38, v3 offset:3328
    v_smfmac_f32_32x32x32_bf16 v[120:135], v[52:55], v[96:103], v6
    v_exp_f32 v104, v104
    v_exp_f32 v105, v105
    v_exp_f32 v106, v106
    v_exp_f32 v107, v107
    v_mfma_f32_32x32x16_bf16 v[56:71], v[28:31], v[16:19], v[56:71]
    v_exp_f32 v108, v108
    v_exp_f32 v109, v109
    v_exp_f32 v110, v110
    v_exp_f32 v111, v111
    v_mfma_f32_32x32x16_bf16 v[72:87], v[28:31], v[20:23], v[72:87]
    v_exp_f32 v112, v112
    v_exp_f32 v113, v113
    v_exp_f32 v114, v114
    v_exp_f32 v115, v115
    v_smfmac_f32_32x32x32_bf16 v[136:151], v[48:51], v[104:111], v6
    v_exp_f32 v116, v116
    v_exp_f32 v117, v117
    v_exp_f32 v118, v118
    v_exp_f32 v119, v119
    s_nop 0
    s_waitcnt lgkmcnt(0)
    v_smfmac_f32_32x32x32_bf16 v[136:151], v[52:55], v[112:119], v6
    s_mov_b64 exec, s[16:17]
    ds_read_b128 v[48:51], v4 offset:14976
    ds_read_b128 v[52:55], v4 offset:15552
    s_mov_b64 exec, -1
    v_exp_f32 v56, v56
    v_exp_f32 v57, v57
    v_exp_f32 v58, v58
    v_exp_f32 v59, v59
    v_mfma_f32_32x32x4_2b_bf16 v[88:119], v[38:39], v[24:25], 0
    v_exp_f32 v60, v60
    v_exp_f32 v61, v61
    v_exp_f32 v62, v62
    v_exp_f32 v63, v63
    v_exp_f32 v64, v64
    v_exp_f32 v65, v65
    v_exp_f32 v66, v66
    v_exp_f32 v67, v67
    v_smfmac_f32_32x32x32_bf16 v[120:135], v[40:43], v[56:63], v6
    v_exp_f32 v68, v68
    v_exp_f32 v69, v69
    v_exp_f32 v70, v70
    v_exp_f32 v71, v71
    ds_read_b128 v[28:31], v2 offset:14336
    ds_read_b32 v32, v3 offset:3584
    v_smfmac_f32_32x32x32_bf16 v[120:135], v[44:47], v[64:71], v6
    v_exp_f32 v72, v72
    v_exp_f32 v73, v73
    v_exp_f32 v74, v74
    v_exp_f32 v75, v75
    v_mfma_f32_32x32x16_bf16 v[88:103], v[34:37], v[16:19], v[88:103]
    v_exp_f32 v76, v76
    v_exp_f32 v77, v77
    v_exp_f32 v78, v78
    v_exp_f32 v79, v79
    v_mfma_f32_32x32x16_bf16 v[104:119], v[34:37], v[20:23], v[104:119]
    v_exp_f32 v80, v80
    v_exp_f32 v81, v81
    v_exp_f32 v82, v82
    v_exp_f32 v83, v83
    v_smfmac_f32_32x32x32_bf16 v[136:151], v[40:43], v[72:79], v6
    v_exp_f32 v84, v84
    v_exp_f32 v85, v85
    v_exp_f32 v86, v86
    v_exp_f32 v87, v87
    s_nop 0
    s_waitcnt lgkmcnt(0)
    v_smfmac_f32_32x32x32_bf16 v[136:151], v[44:47], v[80:87], v6
    s_mov_b64 exec, s[16:17]
    ds_read_b128 v[40:43], v4 offset:16128
    ds_read_b128 v[44:47], v4 offset:16704
    s_mov_b64 exec, -1
    v_exp_f32 v88, v88
    v_exp_f32 v89, v89
    v_exp_f32 v90, v90
    v_exp_f32 v91, v91
    v_mfma_f32_32x32x4_2b_bf16 v[56:87], v[32:33], v[24:25], 0
    v_exp_f32 v92, v92
    v_exp_f32 v93, v93
    v_exp_f32 v94, v94
    v_exp_f32 v95, v95
    v_exp_f32 v96, v96
    v_exp_f32 v97, v97
    v_exp_f32 v98, v98
    v_exp_f32 v99, v99
    v_smfmac_f32_32x32x32_bf16 v[120:135], v[48:51], v[88:95], v6
    v_exp_f32 v100, v100
    v_exp_f32 v101, v101
    v_exp_f32 v102, v102
    v_exp_f32 v103, v103
    ds_read_b128 v[34:37], v2 offset:15360
    ds_read_b32 v38, v3 offset:3840
    v_smfmac_f32_32x32x32_bf16 v[120:135], v[52:55], v[96:103], v6
    v_exp_f32 v104, v104
    v_exp_f32 v105, v105
    v_exp_f32 v106, v106
    v_exp_f32 v107, v107
    v_mfma_f32_32x32x16_bf16 v[56:71], v[28:31], v[16:19], v[56:71]
    v_exp_f32 v108, v108
    v_exp_f32 v109, v109
    v_exp_f32 v110, v110
    v_exp_f32 v111, v111
    v_mfma_f32_32x32x16_bf16 v[72:87], v[28:31], v[20:23], v[72:87]
    v_exp_f32 v112, v112
    v_exp_f32 v113, v113
    v_exp_f32 v114, v114
    v_exp_f32 v115, v115
    v_smfmac_f32_32x32x32_bf16 v[136:151], v[48:51], v[104:111], v6
    v_exp_f32 v116, v116
    v_exp_f32 v117, v117
    v_exp_f32 v118, v118
    v_exp_f32 v119, v119
    s_nop 0
    s_waitcnt lgkmcnt(0)
    v_smfmac_f32_32x32x32_bf16 v[136:151], v[52:55], v[112:119], v6
    s_mov_b64 exec, s[16:17]
    ds_read_b128 v[48:51], v4 offset:17280
    ds_read_b128 v[52:55], v4 offset:17856
    s_mov_b64 exec, -1
    v_exp_f32 v56, v56
    v_exp_f32 v57, v57
    v_exp_f32 v58, v58
    v_exp_f32 v59, v59
    v_mfma_f32_32x32x4_2b_bf16 v[88:119], v[38:39], v[24:25], 0
    v_exp_f32 v60, v60
    v_exp_f32 v61, v61
    v_exp_f32 v62, v62
    v_exp_f32 v63, v63
    v_exp_f32 v64, v64
    v_exp_f32 v65, v65
    v_exp_f32 v66, v66
    v_exp_f32 v67, v67
    v_smfmac_f32_32x32x32_bf16 v[120:135], v[40:43], v[56:63], v6
    v_exp_f32 v68, v68
    v_exp_f32 v69, v69
    v_exp_f32 v70, v70
    v_exp_f32 v71, v71
    ds_read_b128 v[28:31], v2 offset:16384
    ds_read_b32 v32, v3 offset:4096
    v_smfmac_f32_32x32x32_bf16 v[120:135], v[44:47], v[64:71], v6
    v_exp_f32 v72, v72
    v_exp_f32 v73, v73
    v_exp_f32 v74, v74
    v_exp_f32 v75, v75
    v_mfma_f32_32x32x16_bf16 v[88:103], v[34:37], v[16:19], v[88:103]
    v_exp_f32 v76, v76
    v_exp_f32 v77, v77
    v_exp_f32 v78, v78
    v_exp_f32 v79, v79
    v_mfma_f32_32x32x16_bf16 v[104:119], v[34:37], v[20:23], v[104:119]
    v_exp_f32 v80, v80
    v_exp_f32 v81, v81
    v_exp_f32 v82, v82
    v_exp_f32 v83, v83
    v_smfmac_f32_32x32x32_bf16 v[136:151], v[40:43], v[72:79], v6
    v_exp_f32 v84, v84
    v_exp_f32 v85, v85
    v_exp_f32 v86, v86
    v_exp_f32 v87, v87
    s_nop 0
    s_waitcnt lgkmcnt(0)
    v_smfmac_f32_32x32x32_bf16 v[136:151], v[44:47], v[80:87], v6
    s_mov_b64 exec, s[16:17]
    ds_read_b128 v[40:43], v4 offset:18432
    ds_read_b128 v[44:47], v4 offset:19008
    s_mov_b64 exec, -1
    v_exp_f32 v88, v88
    v_exp_f32 v89, v89
    v_exp_f32 v90, v90
    v_exp_f32 v91, v91
    v_mfma_f32_32x32x4_2b_bf16 v[56:87], v[32:33], v[24:25], 0
    v_exp_f32 v92, v92
    v_exp_f32 v93, v93
    v_exp_f32 v94, v94
    v_exp_f32 v95, v95
    v_exp_f32 v96, v96
    v_exp_f32 v97, v97
    v_exp_f32 v98, v98
    v_exp_f32 v99, v99
    v_smfmac_f32_32x32x32_bf16 v[120:135], v[48:51], v[88:95], v6
    v_exp_f32 v100, v100
    v_exp_f32 v101, v101
    v_exp_f32 v102, v102
    v_exp_f32 v103, v103
    ds_read_b128 v[34:37], v2 offset:17408
    ds_read_b32 v38, v3 offset:4352
    v_smfmac_f32_32x32x32_bf16 v[120:135], v[52:55], v[96:103], v6
    v_exp_f32 v104, v104
    v_exp_f32 v105, v105
    v_exp_f32 v106, v106
    v_exp_f32 v107, v107
    v_mfma_f32_32x32x16_bf16 v[56:71], v[28:31], v[16:19], v[56:71]
    v_exp_f32 v108, v108
    v_exp_f32 v109, v109
    v_exp_f32 v110, v110
    v_exp_f32 v111, v111
    v_mfma_f32_32x32x16_bf16 v[72:87], v[28:31], v[20:23], v[72:87]
    v_exp_f32 v112, v112
    v_exp_f32 v113, v113
    v_exp_f32 v114, v114
    v_exp_f32 v115, v115
    v_smfmac_f32_32x32x32_bf16 v[136:151], v[48:51], v[104:111], v6
    v_exp_f32 v116, v116
    v_exp_f32 v117, v117
    v_exp_f32 v118, v118
    v_exp_f32 v119, v119
    s_nop 0
    s_waitcnt lgkmcnt(0)
    v_smfmac_f32_32x32x32_bf16 v[136:151], v[52:55], v[112:119], v6
    s_mov_b64 exec, s[16:17]
    ds_read_b128 v[48:51], v4 offset:19584
    ds_read_b128 v[52:55], v4 offset:20160
    s_mov_b64 exec, -1
    v_exp_f32 v56, v56
    v_exp_f32 v57, v57
    v_exp_f32 v58, v58
    v_exp_f32 v59, v59
    v_mfma_f32_32x32x4_2b_bf16 v[88:119], v[38:39], v[24:25], 0
    v_exp_f32 v60, v60
    v_exp_f32 v61, v61
    v_exp_f32 v62, v62
    v_exp_f32 v63, v63
    v_exp_f32 v64, v64
    v_exp_f32 v65, v65
    v_exp_f32 v66, v66
    v_exp_f32 v67, v67
    v_smfmac_f32_32x32x32_bf16 v[120:135], v[40:43], v[56:63], v6
    v_exp_f32 v68, v68
    v_exp_f32 v69, v69
    v_exp_f32 v70, v70
    v_exp_f32 v71, v71
    ds_read_b128 v[28:31], v2 offset:18432
    ds_read_b32 v32, v3 offset:4608
    v_smfmac_f32_32x32x32_bf16 v[120:135], v[44:47], v[64:71], v6
    v_exp_f32 v72, v72
    v_exp_f32 v73, v73
    v_exp_f32 v74, v74
    v_exp_f32 v75, v75
    v_mfma_f32_32x32x16_bf16 v[88:103], v[34:37], v[16:19], v[88:103]
    v_exp_f32 v76, v76
    v_exp_f32 v77, v77
    v_exp_f32 v78, v78
    v_exp_f32 v79, v79
    v_mfma_f32_32x32x16_bf16 v[104:119], v[34:37], v[20:23], v[104:119]
    v_exp_f32 v80, v80
    v_exp_f32 v81, v81
    v_exp_f32 v82, v82
    v_exp_f32 v83, v83
    v_smfmac_f32_32x32x32_bf16 v[136:151], v[40:43], v[72:79], v6
    v_exp_f32 v84, v84
    v_exp_f32 v85, v85
    v_exp_f32 v86, v86
    v_exp_f32 v87, v87
    s_nop 0
    s_waitcnt lgkmcnt(0)
    v_smfmac_f32_32x32x32_bf16 v[136:151], v[44:47], v[80:87], v6
    s_mov_b64 exec, s[16:17]
    ds_read_b128 v[40:43], v4 offset:20736
    ds_read_b128 v[44:47], v4 offset:21312
    s_mov_b64 exec, -1
    v_exp_f32 v88, v88
    v_exp_f32 v89, v89
    v_exp_f32 v90, v90
    v_exp_f32 v91, v91
    v_mfma_f32_32x32x4_2b_bf16 v[56:87], v[32:33], v[24:25], 0
    v_exp_f32 v92, v92
    v_exp_f32 v93, v93
    v_exp_f32 v94, v94
    v_exp_f32 v95, v95
    v_exp_f32 v96, v96
    v_exp_f32 v97, v97
    v_exp_f32 v98, v98
    v_exp_f32 v99, v99
    v_smfmac_f32_32x32x32_bf16 v[120:135], v[48:51], v[88:95], v6
    v_exp_f32 v100, v100
    v_exp_f32 v101, v101
    v_exp_f32 v102, v102
    v_exp_f32 v103, v103
    ds_read_b128 v[34:37], v2 offset:19456
    ds_read_b32 v38, v3 offset:4864
    v_smfmac_f32_32x32x32_bf16 v[120:135], v[52:55], v[96:103], v6
    v_exp_f32 v104, v104
    v_exp_f32 v105, v105
    v_exp_f32 v106, v106
    v_exp_f32 v107, v107
    v_mfma_f32_32x32x16_bf16 v[56:71], v[28:31], v[16:19], v[56:71]
    v_exp_f32 v108, v108
    v_exp_f32 v109, v109
    v_exp_f32 v110, v110
    v_exp_f32 v111, v111
    v_mfma_f32_32x32x16_bf16 v[72:87], v[28:31], v[20:23], v[72:87]
    v_exp_f32 v112, v112
    v_exp_f32 v113, v113
    v_exp_f32 v114, v114
    v_exp_f32 v115, v115
    v_smfmac_f32_32x32x32_bf16 v[136:151], v[48:51], v[104:111], v6
    v_exp_f32 v116, v116
    v_exp_f32 v117, v117
    v_exp_f32 v118, v118
    v_exp_f32 v119, v119
    s_nop 0
    s_waitcnt lgkmcnt(0)
    v_smfmac_f32_32x32x32_bf16 v[136:151], v[52:55], v[112:119], v6
    s_mov_b64 exec, s[16:17]
    ds_read_b128 v[48:51], v4 offset:21888
    ds_read_b128 v[52:55], v4 offset:22464
    s_mov_b64 exec, -1
    v_exp_f32 v56, v56
    v_exp_f32 v57, v57
    v_exp_f32 v58, v58
    v_exp_f32 v59, v59
    v_mfma_f32_32x32x4_2b_bf16 v[88:119], v[38:39], v[24:25], 0
    v_exp_f32 v60, v60
    v_exp_f32 v61, v61
    v_exp_f32 v62, v62
    v_exp_f32 v63, v63
    v_exp_f32 v64, v64
    v_exp_f32 v65, v65
    v_exp_f32 v66, v66
    v_exp_f32 v67, v67
    v_smfmac_f32_32x32x32_bf16 v[120:135], v[40:43], v[56:63], v6
    v_exp_f32 v68, v68
    v_exp_f32 v69, v69
    v_exp_f32 v70, v70
    v_exp_f32 v71, v71
    ds_read_b128 v[28:31], v2 offset:20480
    ds_read_b32 v32, v3 offset:5120
    v_smfmac_f32_32x32x32_bf16 v[120:135], v[44:47], v[64:71], v6
    v_exp_f32 v72, v72
    v_exp_f32 v73, v73
    v_exp_f32 v74, v74
    v_exp_f32 v75, v75
    v_mfma_f32_32x32x16_bf16 v[88:103], v[34:37], v[16:19], v[88:103]
    v_exp_f32 v76, v76
    v_exp_f32 v77, v77
    v_exp_f32 v78, v78
    v_exp_f32 v79, v79
    v_mfma_f32_32x32x16_bf16 v[104:119], v[34:37], v[20:23], v[104:119]
    v_exp_f32 v80, v80
    v_exp_f32 v81, v81
    v_exp_f32 v82, v82
    v_exp_f32 v83, v83
    v_smfmac_f32_32x32x32_bf16 v[136:151], v[40:43], v[72:79], v6
    v_exp_f32 v84, v84
    v_exp_f32 v85, v85
    v_exp_f32 v86, v86
    v_exp_f32 v87, v87
    s_nop 0
    s_waitcnt lgkmcnt(0)
    v_smfmac_f32_32x32x32_bf16 v[136:151], v[44:47], v[80:87], v6
    s_mov_b64 exec, s[16:17]
    ds_read_b128 v[40:43], v4 offset:23040
    ds_read_b128 v[44:47], v4 offset:23616
    s_mov_b64 exec, -1
    v_exp_f32 v88, v88
    v_exp_f32 v89, v89
    v_exp_f32 v90, v90
    v_exp_f32 v91, v91
    v_mfma_f32_32x32x4_2b_bf16 v[56:87], v[32:33], v[24:25], 0
    v_exp_f32 v92, v92
    v_exp_f32 v93, v93
    v_exp_f32 v94, v94
    v_exp_f32 v95, v95
    v_exp_f32 v96, v96
    v_exp_f32 v97, v97
    v_exp_f32 v98, v98
    v_exp_f32 v99, v99
    v_smfmac_f32_32x32x32_bf16 v[120:135], v[48:51], v[88:95], v6
    v_exp_f32 v100, v100
    v_exp_f32 v101, v101
    v_exp_f32 v102, v102
    v_exp_f32 v103, v103
    ds_read_b128 v[34:37], v2 offset:21504
    ds_read_b32 v38, v3 offset:5376
    v_smfmac_f32_32x32x32_bf16 v[120:135], v[52:55], v[96:103], v6
    v_exp_f32 v104, v104
    v_exp_f32 v105, v105
    v_exp_f32 v106, v106
    v_exp_f32 v107, v107
    v_mfma_f32_32x32x16_bf16 v[56:71], v[28:31], v[16:19], v[56:71]
    v_exp_f32 v108, v108
    v_exp_f32 v109, v109
    v_exp_f32 v110, v110
    v_exp_f32 v111, v111
    v_mfma_f32_32x32x16_bf16 v[72:87], v[28:31], v[20:23], v[72:87]
    v_exp_f32 v112, v112
    v_exp_f32 v113, v113
    v_exp_f32 v114, v114
    v_exp_f32 v115, v115
    v_smfmac_f32_32x32x32_bf16 v[136:151], v[48:51], v[104:111], v6
    v_exp_f32 v116, v116
    v_exp_f32 v117, v117
    v_exp_f32 v118, v118
    v_exp_f32 v119, v119
    s_nop 0
    s_waitcnt lgkmcnt(0)
    v_smfmac_f32_32x32x32_bf16 v[136:151], v[52:55], v[112:119], v6
    s_mov_b64 exec, s[16:17]
    ds_read_b128 v[48:51], v4 offset:24192
    ds_read_b128 v[52:55], v4 offset:24768
    s_mov_b64 exec, -1
    v_exp_f32 v56, v56
    v_exp_f32 v57, v57
    v_exp_f32 v58, v58
    v_exp_f32 v59, v59
    v_mfma_f32_32x32x4_2b_bf16 v[88:119], v[38:39], v[24:25], 0
    v_exp_f32 v60, v60
    v_exp_f32 v61, v61
    v_exp_f32 v62, v62
    v_exp_f32 v63, v63
    v_exp_f32 v64, v64
    v_exp_f32 v65, v65
    v_exp_f32 v66, v66
    v_exp_f32 v67, v67
    v_smfmac_f32_32x32x32_bf16 v[120:135], v[40:43], v[56:63], v6
    v_exp_f32 v68, v68
    v_exp_f32 v69, v69
    v_exp_f32 v70, v70
    v_exp_f32 v71, v71
    ds_read_b128 v[28:31], v2 offset:22528
    ds_read_b32 v32, v3 offset:5632
    v_smfmac_f32_32x32x32_bf16 v[120:135], v[44:47], v[64:71], v6
    v_exp_f32 v72, v72
    v_exp_f32 v73, v73
    v_exp_f32 v74, v74
    v_exp_f32 v75, v75
    v_mfma_f32_32x32x16_bf16 v[88:103], v[34:37], v[16:19], v[88:103]
    v_exp_f32 v76, v76
    v_exp_f32 v77, v77
    v_exp_f32 v78, v78
    v_exp_f32 v79, v79
    v_mfma_f32_32x32x16_bf16 v[104:119], v[34:37], v[20:23], v[104:119]
    v_exp_f32 v80, v80
    v_exp_f32 v81, v81
    v_exp_f32 v82, v82
    v_exp_f32 v83, v83
    v_smfmac_f32_32x32x32_bf16 v[136:151], v[40:43], v[72:79], v6
    v_exp_f32 v84, v84
    v_exp_f32 v85, v85
    v_exp_f32 v86, v86
    v_exp_f32 v87, v87
    s_nop 0
    s_waitcnt lgkmcnt(0)
    v_smfmac_f32_32x32x32_bf16 v[136:151], v[44:47], v[80:87], v6
    s_mov_b64 exec, s[16:17]
    ds_read_b128 v[40:43], v4 offset:25344
    ds_read_b128 v[44:47], v4 offset:25920
    s_mov_b64 exec, -1
    v_exp_f32 v88, v88
    v_exp_f32 v89, v89
    v_exp_f32 v90, v90
    v_exp_f32 v91, v91
    v_mfma_f32_32x32x4_2b_bf16 v[56:87], v[32:33], v[24:25], 0
    v_exp_f32 v92, v92
    v_exp_f32 v93, v93
    v_exp_f32 v94, v94
    v_exp_f32 v95, v95
    v_exp_f32 v96, v96
    v_exp_f32 v97, v97
    v_exp_f32 v98, v98
    v_exp_f32 v99, v99
    v_smfmac_f32_32x32x32_bf16 v[120:135], v[48:51], v[88:95], v6
    v_exp_f32 v100, v100
    v_exp_f32 v101, v101
    v_exp_f32 v102, v102
    v_exp_f32 v103, v103
    ds_read_b128 v[34:37], v2 offset:23552
    ds_read_b32 v38, v3 offset:5888
    v_smfmac_f32_32x32x32_bf16 v[120:135], v[52:55], v[96:103], v6
    v_exp_f32 v104, v104
    v_exp_f32 v105, v105
    v_exp_f32 v106, v106
    v_exp_f32 v107, v107
    v_mfma_f32_32x32x16_bf16 v[56:71], v[28:31], v[16:19], v[56:71]
    v_exp_f32 v108, v108
    v_exp_f32 v109, v109
    v_exp_f32 v110, v110
    v_exp_f32 v111, v111
    v_mfma_f32_32x32x16_bf16 v[72:87], v[28:31], v[20:23], v[72:87]
    v_exp_f32 v112, v112
    v_exp_f32 v113, v113
    v_exp_f32 v114, v114
    v_exp_f32 v115, v115
    v_smfmac_f32_32x32x32_bf16 v[136:151], v[48:51], v[104:111], v6
    v_exp_f32 v116, v116
    v_exp_f32 v117, v117
    v_exp_f32 v118, v118
    v_exp_f32 v119, v119
    s_nop 0
    s_waitcnt lgkmcnt(0)
    v_smfmac_f32_32x32x32_bf16 v[136:151], v[52:55], v[112:119], v6
    s_mov_b64 exec, s[16:17]
    ds_read_b128 v[48:51], v4 offset:26496
    ds_read_b128 v[52:55], v4 offset:27072
    s_mov_b64 exec, -1
    v_exp_f32 v56, v56
    v_exp_f32 v57, v57
    v_exp_f32 v58, v58
    v_exp_f32 v59, v59
    v_mfma_f32_32x32x4_2b_bf16 v[88:119], v[38:39], v[24:25], 0
    v_exp_f32 v60, v60
    v_exp_f32 v61, v61
    v_exp_f32 v62, v62
    v_exp_f32 v63, v63
    v_exp_f32 v64, v64
    v_exp_f32 v65, v65
    v_exp_f32 v66, v66
    v_exp_f32 v67, v67
    v_smfmac_f32_32x32x32_bf16 v[120:135], v[40:43], v[56:63], v6
    v_exp_f32 v68, v68
    v_exp_f32 v69, v69
    v_exp_f32 v70, v70
    v_exp_f32 v71, v71
    ds_read_b128 v[28:31], v2 offset:24576
    ds_read_b32 v32, v3 offset:6144
    v_smfmac_f32_32x32x32_bf16 v[120:135], v[44:47], v[64:71], v6
    v_exp_f32 v72, v72
    v_exp_f32 v73, v73
    v_exp_f32 v74, v74
    v_exp_f32 v75, v75
    v_mfma_f32_32x32x16_bf16 v[88:103], v[34:37], v[16:19], v[88:103]
    v_exp_f32 v76, v76
    v_exp_f32 v77, v77
    v_exp_f32 v78, v78
    v_exp_f32 v79, v79
    v_mfma_f32_32x32x16_bf16 v[104:119], v[34:37], v[20:23], v[104:119]
    v_exp_f32 v80, v80
    v_exp_f32 v81, v81
    v_exp_f32 v82, v82
    v_exp_f32 v83, v83
    v_smfmac_f32_32x32x32_bf16 v[136:151], v[40:43], v[72:79], v6
    v_exp_f32 v84, v84
    v_exp_f32 v85, v85
    v_exp_f32 v86, v86
    v_exp_f32 v87, v87
    s_nop 0
    s_waitcnt lgkmcnt(0)
    v_smfmac_f32_32x32x32_bf16 v[136:151], v[44:47], v[80:87], v6
    s_mov_b64 exec, s[16:17]
    ds_read_b128 v[40:43], v4 offset:27648
    ds_read_b128 v[44:47], v4 offset:28224
    s_mov_b64 exec, -1
    v_exp_f32 v88, v88
    v_exp_f32 v89, v89
    v_exp_f32 v90, v90
    v_exp_f32 v91, v91
    v_mfma_f32_32x32x4_2b_bf16 v[56:87], v[32:33], v[24:25], 0
    v_exp_f32 v92, v92
    v_exp_f32 v93, v93
    v_exp_f32 v94, v94
    v_exp_f32 v95, v95
    v_exp_f32 v96, v96
    v_exp_f32 v97, v97
    v_exp_f32 v98, v98
    v_exp_f32 v99, v99
    v_smfmac_f32_32x32x32_bf16 v[120:135], v[48:51], v[88:95], v6
    v_exp_f32 v100, v100
    v_exp_f32 v101, v101
    v_exp_f32 v102, v102
    v_exp_f32 v103, v103
    ds_read_b128 v[34:37], v2 offset:25600
    ds_read_b32 v38, v3 offset:6400
    v_smfmac_f32_32x32x32_bf16 v[120:135], v[52:55], v[96:103], v6
    v_exp_f32 v104, v104
    v_exp_f32 v105, v105
    v_exp_f32 v106, v106
    v_exp_f32 v107, v107
    v_mfma_f32_32x32x16_bf16 v[56:71], v[28:31], v[16:19], v[56:71]
    v_exp_f32 v108, v108
    v_exp_f32 v109, v109
    v_exp_f32 v110, v110
    v_exp_f32 v111, v111
    v_mfma_f32_32x32x16_bf16 v[72:87], v[28:31], v[20:23], v[72:87]
    v_exp_f32 v112, v112
    v_exp_f32 v113, v113
    v_exp_f32 v114, v114
    v_exp_f32 v115, v115
    v_smfmac_f32_32x32x32_bf16 v[136:151], v[48:51], v[104:111], v6
    v_exp_f32 v116, v116
    v_exp_f32 v117, v117
    v_exp_f32 v118, v118
    v_exp_f32 v119, v119
    s_nop 0
    s_waitcnt lgkmcnt(0)
    v_smfmac_f32_32x32x32_bf16 v[136:151], v[52:55], v[112:119], v6
    s_mov_b64 exec, s[16:17]
    ds_read_b128 v[48:51], v4 offset:28800
    ds_read_b128 v[52:55], v4 offset:29376
    s_mov_b64 exec, -1
    v_exp_f32 v56, v56
    v_exp_f32 v57, v57
    v_exp_f32 v58, v58
    v_exp_f32 v59, v59
    v_mfma_f32_32x32x4_2b_bf16 v[88:119], v[38:39], v[24:25], 0
    v_exp_f32 v60, v60
    v_exp_f32 v61, v61
    v_exp_f32 v62, v62
    v_exp_f32 v63, v63
    v_exp_f32 v64, v64
    v_exp_f32 v65, v65
    v_exp_f32 v66, v66
    v_exp_f32 v67, v67
    v_smfmac_f32_32x32x32_bf16 v[120:135], v[40:43], v[56:63], v6
    v_exp_f32 v68, v68
    v_exp_f32 v69, v69
    v_exp_f32 v70, v70
    v_exp_f32 v71, v71
    ds_read_b128 v[28:31], v2 offset:26624
    ds_read_b32 v32, v3 offset:6656
    v_smfmac_f32_32x32x32_bf16 v[120:135], v[44:47], v[64:71], v6
    v_exp_f32 v72, v72
    v_exp_f32 v73, v73
    v_exp_f32 v74, v74
    v_exp_f32 v75, v75
    v_mfma_f32_32x32x16_bf16 v[88:103], v[34:37], v[16:19], v[88:103]
    v_exp_f32 v76, v76
    v_exp_f32 v77, v77
    v_exp_f32 v78, v78
    v_exp_f32 v79, v79
    v_mfma_f32_32x32x16_bf16 v[104:119], v[34:37], v[20:23], v[104:119]
    v_exp_f32 v80, v80
    v_exp_f32 v81, v81
    v_exp_f32 v82, v82
    v_exp_f32 v83, v83
    v_smfmac_f32_32x32x32_bf16 v[136:151], v[40:43], v[72:79], v6
    v_exp_f32 v84, v84
    v_exp_f32 v85, v85
    v_exp_f32 v86, v86
    v_exp_f32 v87, v87
    s_nop 0
    s_waitcnt lgkmcnt(0)
    v_smfmac_f32_32x32x32_bf16 v[136:151], v[44:47], v[80:87], v6
    s_mov_b64 exec, s[16:17]
    ds_read_b128 v[40:43], v4 offset:29952
    ds_read_b128 v[44:47], v4 offset:30528
    s_mov_b64 exec, -1
    v_exp_f32 v88, v88
    v_exp_f32 v89, v89
    v_exp_f32 v90, v90
    v_exp_f32 v91, v91
    v_mfma_f32_32x32x4_2b_bf16 v[56:87], v[32:33], v[24:25], 0
    v_exp_f32 v92, v92
    v_exp_f32 v93, v93
    v_exp_f32 v94, v94
    v_exp_f32 v95, v95
    v_exp_f32 v96, v96
    v_exp_f32 v97, v97
    v_exp_f32 v98, v98
    v_exp_f32 v99, v99
    v_smfmac_f32_32x32x32_bf16 v[120:135], v[48:51], v[88:95], v6
    v_exp_f32 v100, v100
    v_exp_f32 v101, v101
    v_exp_f32 v102, v102
    v_exp_f32 v103, v103
    ds_read_b128 v[34:37], v2 offset:27648
    ds_read_b32 v38, v3 offset:6912
    v_smfmac_f32_32x32x32_bf16 v[120:135], v[52:55], v[96:103], v6
    v_exp_f32 v104, v104
    v_exp_f32 v105, v105
    v_exp_f32 v106, v106
    v_exp_f32 v107, v107
    v_mfma_f32_32x32x16_bf16 v[56:71], v[28:31], v[16:19], v[56:71]
    v_exp_f32 v108, v108
    v_exp_f32 v109, v109
    v_exp_f32 v110, v110
    v_exp_f32 v111, v111
    v_mfma_f32_32x32x16_bf16 v[72:87], v[28:31], v[20:23], v[72:87]
    v_exp_f32 v112, v112
    v_exp_f32 v113, v113
    v_exp_f32 v114, v114
    v_exp_f32 v115, v115
    v_smfmac_f32_32x32x32_bf16 v[136:151], v[48:51], v[104:111], v6
    v_exp_f32 v116, v116
    v_exp_f32 v117, v117
    v_exp_f32 v118, v118
    v_exp_f32 v119, v119
    s_waitcnt vmcnt(0)
    s_barrier
    s_nop 0
    s_waitcnt lgkmcnt(0)
    v_smfmac_f32_32x32x32_bf16 v[136:151], v[52:55], v[112:119], v6
    s_mov_b64 exec, s[16:17]
    ds_read_b128 v[48:51], v4 offset:31104
    ds_read_b128 v[52:55], v4 offset:31680
    s_mov_b64 exec, -1
    v_exp_f32 v56, v56
    v_exp_f32 v57, v57
    v_exp_f32 v58, v58
    v_exp_f32 v59, v59
    v_mfma_f32_32x32x4_2b_bf16 v[88:119], v[38:39], v[24:25], 0
    v_exp_f32 v60, v60
    v_exp_f32 v61, v61
    v_exp_f32 v62, v62
    v_exp_f32 v63, v63
    v_exp_f32 v64, v64
    v_exp_f32 v65, v65
    v_exp_f32 v66, v66
    v_exp_f32 v67, v67
    v_smfmac_f32_32x32x32_bf16 v[120:135], v[40:43], v[56:63], v6
    v_exp_f32 v68, v68
    v_exp_f32 v69, v69
    v_exp_f32 v70, v70
    v_exp_f32 v71, v71
    ds_read_b128 v[28:31], v2 offset:28672
    ds_read_b32 v32, v3 offset:7168
    v_smfmac_f32_32x32x32_bf16 v[120:135], v[44:47], v[64:71], v6
    v_exp_f32 v72, v72
    v_exp_f32 v73, v73
    v_exp_f32 v74, v74
    v_exp_f32 v75, v75
    v_mfma_f32_32x32x16_bf16 v[88:103], v[34:37], v[16:19], v[88:103]
    v_exp_f32 v76, v76
    v_exp_f32 v77, v77
    v_exp_f32 v78, v78
    v_exp_f32 v79, v79
    v_mfma_f32_32x32x16_bf16 v[104:119], v[34:37], v[20:23], v[104:119]
    v_exp_f32 v80, v80
    v_exp_f32 v81, v81
    v_exp_f32 v82, v82
    v_exp_f32 v83, v83
    v_smfmac_f32_32x32x32_bf16 v[136:151], v[40:43], v[72:79], v6
    v_exp_f32 v84, v84
    v_exp_f32 v85, v85
    v_exp_f32 v86, v86
    v_exp_f32 v87, v87
    s_nop 0
    s_waitcnt lgkmcnt(0)
    v_smfmac_f32_32x32x32_bf16 v[136:151], v[44:47], v[80:87], v6
    s_mov_b64 exec, s[16:17]
    ds_read_b128 v[40:43], v4 offset:32256
    ds_read_b128 v[44:47], v4 offset:32832
    s_mov_b64 exec, -1
    v_exp_f32 v88, v88
    v_exp_f32 v89, v89
    v_exp_f32 v90, v90
    v_exp_f32 v91, v91
    v_mfma_f32_32x32x4_2b_bf16 v[56:87], v[32:33], v[24:25], 0
    v_exp_f32 v92, v92
    v_exp_f32 v93, v93
    v_exp_f32 v94, v94
    v_exp_f32 v95, v95
    v_exp_f32 v96, v96
    v_exp_f32 v97, v97
    v_exp_f32 v98, v98
    v_exp_f32 v99, v99
    v_smfmac_f32_32x32x32_bf16 v[120:135], v[48:51], v[88:95], v6
    v_exp_f32 v100, v100
    v_exp_f32 v101, v101
    v_exp_f32 v102, v102
    v_exp_f32 v103, v103
    ds_read_b128 v[34:37], v2 offset:29696
    ds_read_b32 v38, v3 offset:7424
    v_smfmac_f32_32x32x32_bf16 v[120:135], v[52:55], v[96:103], v6
    v_exp_f32 v104, v104
    v_exp_f32 v105, v105
    v_exp_f32 v106, v106
    v_exp_f32 v107, v107
    v_mfma_f32_32x32x16_bf16 v[56:71], v[28:31], v[16:19], v[56:71]
    v_exp_f32 v108, v108
    v_exp_f32 v109, v109
    v_exp_f32 v110, v110
    v_exp_f32 v111, v111
    v_mfma_f32_32x32x16_bf16 v[72:87], v[28:31], v[20:23], v[72:87]
    v_exp_f32 v112, v112
    v_exp_f32 v113, v113
    v_exp_f32 v114, v114
    v_exp_f32 v115, v115
    v_smfmac_f32_32x32x32_bf16 v[136:151], v[48:51], v[104:111], v6
    v_exp_f32 v116, v116
    v_exp_f32 v117, v117
    v_exp_f32 v118, v118
    v_exp_f32 v119, v119
    s_nop 0
    s_waitcnt lgkmcnt(0)
    v_smfmac_f32_32x32x32_bf16 v[136:151], v[52:55], v[112:119], v6
    s_mov_b64 exec, s[16:17]
    ds_read_b128 v[48:51], v4 offset:33408
    ds_read_b128 v[52:55], v4 offset:33984
    s_mov_b64 exec, -1
    v_exp_f32 v56, v56
    v_exp_f32 v57, v57
    v_exp_f32 v58, v58
    v_exp_f32 v59, v59
    v_mfma_f32_32x32x4_2b_bf16 v[88:119], v[38:39], v[24:25], 0
    v_exp_f32 v60, v60
    v_exp_f32 v61, v61
    v_exp_f32 v62, v62
    v_exp_f32 v63, v63
    v_exp_f32 v64, v64
    v_exp_f32 v65, v65
    v_exp_f32 v66, v66
    v_exp_f32 v67, v67
    v_smfmac_f32_32x32x32_bf16 v[120:135], v[40:43], v[56:63], v6
    v_exp_f32 v68, v68
    v_exp_f32 v69, v69
    v_exp_f32 v70, v70
    v_exp_f32 v71, v71
    ds_read_b128 v[28:31], v2 offset:30720
    ds_read_b32 v32, v3 offset:7680
    v_smfmac_f32_32x32x32_bf16 v[120:135], v[44:47], v[64:71], v6
    v_exp_f32 v72, v72
    v_exp_f32 v73, v73
    v_exp_f32 v74, v74
    v_exp_f32 v75, v75
    v_mfma_f32_32x32x16_bf16 v[88:103], v[34:37], v[16:19], v[88:103]
    v_exp_f32 v76, v76
    v_exp_f32 v77, v77
    v_exp_f32 v78, v78
    v_exp_f32 v79, v79
    v_mfma_f32_32x32x16_bf16 v[104:119], v[34:37], v[20:23], v[104:119]
    v_exp_f32 v80, v80
    v_exp_f32 v81, v81
    v_exp_f32 v82, v82
    v_exp_f32 v83, v83
    v_smfmac_f32_32x32x32_bf16 v[136:151], v[40:43], v[72:79], v6
    v_exp_f32 v84, v84
    v_exp_f32 v85, v85
    v_exp_f32 v86, v86
    v_exp_f32 v87, v87
    s_nop 0
    s_waitcnt lgkmcnt(0)
    v_smfmac_f32_32x32x32_bf16 v[136:151], v[44:47], v[80:87], v6
    s_mov_b64 exec, s[16:17]
    ds_read_b128 v[40:43], v4 offset:34560
    ds_read_b128 v[44:47], v4 offset:35136
    s_mov_b64 exec, -1
    v_exp_f32 v88, v88
    v_exp_f32 v89, v89
    v_exp_f32 v90, v90
    v_exp_f32 v91, v91
    v_mfma_f32_32x32x4_2b_bf16 v[56:87], v[32:33], v[24:25], 0
    v_exp_f32 v92, v92
    v_exp_f32 v93, v93
    v_exp_f32 v94, v94
    v_exp_f32 v95, v95
    v_exp_f32 v96, v96
    v_exp_f32 v97, v97
    v_exp_f32 v98, v98
    v_exp_f32 v99, v99
    v_smfmac_f32_32x32x32_bf16 v[120:135], v[48:51], v[88:95], v6
    v_exp_f32 v100, v100
    v_exp_f32 v101, v101
    v_exp_f32 v102, v102
    v_exp_f32 v103, v103
    ds_read_b128 v[34:37], v2 offset:31744
    ds_read_b32 v38, v3 offset:7936
    v_smfmac_f32_32x32x32_bf16 v[120:135], v[52:55], v[96:103], v6
    v_exp_f32 v104, v104
    v_exp_f32 v105, v105
    v_exp_f32 v106, v106
    v_exp_f32 v107, v107
    v_mfma_f32_32x32x16_bf16 v[56:71], v[28:31], v[16:19], v[56:71]
    v_exp_f32 v108, v108
    v_exp_f32 v109, v109
    v_exp_f32 v110, v110
    v_exp_f32 v111, v111
    v_mfma_f32_32x32x16_bf16 v[72:87], v[28:31], v[20:23], v[72:87]
    v_exp_f32 v112, v112
    v_exp_f32 v113, v113
    v_exp_f32 v114, v114
    v_exp_f32 v115, v115
    v_smfmac_f32_32x32x32_bf16 v[136:151], v[48:51], v[104:111], v6
    v_exp_f32 v116, v116
    v_exp_f32 v117, v117
    v_exp_f32 v118, v118
    v_exp_f32 v119, v119
    s_nop 0
    s_waitcnt lgkmcnt(0)
    v_smfmac_f32_32x32x32_bf16 v[136:151], v[52:55], v[112:119], v6
    s_mov_b64 exec, s[16:17]
    ds_read_b128 v[48:51], v4 offset:35712
    ds_read_b128 v[52:55], v4 offset:36288
    s_mov_b64 exec, -1
    v_exp_f32 v56, v56
    v_exp_f32 v57, v57
    v_exp_f32 v58, v58
    v_exp_f32 v59, v59
    v_mfma_f32_32x32x4_2b_bf16 v[88:119], v[38:39], v[24:25], 0
    v_exp_f32 v60, v60
    v_exp_f32 v61, v61
    v_exp_f32 v62, v62
    v_exp_f32 v63, v63
    v_exp_f32 v64, v64
    v_exp_f32 v65, v65
    v_exp_f32 v66, v66
    v_exp_f32 v67, v67
    v_smfmac_f32_32x32x32_bf16 v[120:135], v[40:43], v[56:63], v6
    v_exp_f32 v68, v68
    v_exp_f32 v69, v69
    v_exp_f32 v70, v70
    v_exp_f32 v71, v71
    ds_read_b128 v[28:31], v2 offset:32768
    ds_read_b32 v32, v3 offset:8192
    v_smfmac_f32_32x32x32_bf16 v[120:135], v[44:47], v[64:71], v6
    v_exp_f32 v72, v72
    v_exp_f32 v73, v73
    v_exp_f32 v74, v74
    v_exp_f32 v75, v75
    v_mfma_f32_32x32x16_bf16 v[88:103], v[34:37], v[16:19], v[88:103]
    v_exp_f32 v76, v76
    v_exp_f32 v77, v77
    v_exp_f32 v78, v78
    v_exp_f32 v79, v79
    v_mfma_f32_32x32x16_bf16 v[104:119], v[34:37], v[20:23], v[104:119]
    v_exp_f32 v80, v80
    v_exp_f32 v81, v81
    v_exp_f32 v82, v82
    v_exp_f32 v83, v83
    v_smfmac_f32_32x32x32_bf16 v[136:151], v[40:43], v[72:79], v6
    v_exp_f32 v84, v84
    v_exp_f32 v85, v85
    v_exp_f32 v86, v86
    v_exp_f32 v87, v87
    s_nop 0
    s_waitcnt lgkmcnt(0)
    v_smfmac_f32_32x32x32_bf16 v[136:151], v[44:47], v[80:87], v6
    s_mov_b64 exec, s[16:17]
    ds_read_b128 v[40:43], v5 offset:0
    ds_read_b128 v[44:47], v5 offset:576
    s_mov_b64 exec, -1
    v_exp_f32 v88, v88
    v_exp_f32 v89, v89
    v_exp_f32 v90, v90
    v_exp_f32 v91, v91
    v_mfma_f32_32x32x4_2b_bf16 v[56:87], v[32:33], v[24:25], 0
    v_exp_f32 v92, v92
    v_exp_f32 v93, v93
    v_exp_f32 v94, v94
    v_exp_f32 v95, v95
    v_exp_f32 v96, v96
    v_exp_f32 v97, v97
    v_exp_f32 v98, v98
    v_exp_f32 v99, v99
    v_smfmac_f32_32x32x32_bf16 v[120:135], v[48:51], v[88:95], v6
    v_exp_f32 v100, v100
    v_exp_f32 v101, v101
    v_exp_f32 v102, v102
    v_exp_f32 v103, v103
    ds_read_b128 v[34:37], v2 offset:33792
    ds_read_b32 v38, v3 offset:8448
    v_smfmac_f32_32x32x32_bf16 v[120:135], v[52:55], v[96:103], v6
    v_exp_f32 v104, v104
    v_exp_f32 v105, v105
    v_exp_f32 v106, v106
    v_exp_f32 v107, v107
    v_mfma_f32_32x32x16_bf16 v[56:71], v[28:31], v[16:19], v[56:71]
    v_exp_f32 v108, v108
    v_exp_f32 v109, v109
    v_exp_f32 v110, v110
    v_exp_f32 v111, v111
    v_mfma_f32_32x32x16_bf16 v[72:87], v[28:31], v[20:23], v[72:87]
    v_exp_f32 v112, v112
    v_exp_f32 v113, v113
    v_exp_f32 v114, v114
    v_exp_f32 v115, v115
    v_smfmac_f32_32x32x32_bf16 v[136:151], v[48:51], v[104:111], v6
    v_exp_f32 v116, v116
    v_exp_f32 v117, v117
    v_exp_f32 v118, v118
    v_exp_f32 v119, v119
    s_nop 0
    s_waitcnt lgkmcnt(0)
    v_smfmac_f32_32x32x32_bf16 v[136:151], v[52:55], v[112:119], v6
    s_mov_b64 exec, s[16:17]
    ds_read_b128 v[48:51], v5 offset:1152
    ds_read_b128 v[52:55], v5 offset:1728
    s_mov_b64 exec, -1
    v_exp_f32 v56, v56
    v_exp_f32 v57, v57
    v_exp_f32 v58, v58
    v_exp_f32 v59, v59
    v_mfma_f32_32x32x4_2b_bf16 v[88:119], v[38:39], v[24:25], 0
    v_exp_f32 v60, v60
    v_exp_f32 v61, v61
    v_exp_f32 v62, v62
    v_exp_f32 v63, v63
    v_exp_f32 v64, v64
    v_exp_f32 v65, v65
    v_exp_f32 v66, v66
    v_exp_f32 v67, v67
    v_smfmac_f32_32x32x32_bf16 v[120:135], v[40:43], v[56:63], v6
    v_exp_f32 v68, v68
    v_exp_f32 v69, v69
    v_exp_f32 v70, v70
    v_exp_f32 v71, v71
    ds_read_b128 v[28:31], v2 offset:34816
    ds_read_b32 v32, v3 offset:8704
    v_smfmac_f32_32x32x32_bf16 v[120:135], v[44:47], v[64:71], v6
    v_exp_f32 v72, v72
    v_exp_f32 v73, v73
    v_exp_f32 v74, v74
    v_exp_f32 v75, v75
    v_mfma_f32_32x32x16_bf16 v[88:103], v[34:37], v[16:19], v[88:103]
    v_exp_f32 v76, v76
    v_exp_f32 v77, v77
    v_exp_f32 v78, v78
    v_exp_f32 v79, v79
    v_mfma_f32_32x32x16_bf16 v[104:119], v[34:37], v[20:23], v[104:119]
    v_exp_f32 v80, v80
    v_exp_f32 v81, v81
    v_exp_f32 v82, v82
    v_exp_f32 v83, v83
    v_smfmac_f32_32x32x32_bf16 v[136:151], v[40:43], v[72:79], v6
    v_exp_f32 v84, v84
    v_exp_f32 v85, v85
    v_exp_f32 v86, v86
    v_exp_f32 v87, v87
    s_nop 0
    s_waitcnt lgkmcnt(0)
    v_smfmac_f32_32x32x32_bf16 v[136:151], v[44:47], v[80:87], v6
    s_mov_b64 exec, s[16:17]
    ds_read_b128 v[40:43], v5 offset:2304
    ds_read_b128 v[44:47], v5 offset:2880
    s_mov_b64 exec, -1
    v_exp_f32 v88, v88
    v_exp_f32 v89, v89
    v_exp_f32 v90, v90
    v_exp_f32 v91, v91
    v_mfma_f32_32x32x4_2b_bf16 v[56:87], v[32:33], v[24:25], 0
    v_exp_f32 v92, v92
    v_exp_f32 v93, v93
    v_exp_f32 v94, v94
    v_exp_f32 v95, v95
    v_exp_f32 v96, v96
    v_exp_f32 v97, v97
    v_exp_f32 v98, v98
    v_exp_f32 v99, v99
    v_smfmac_f32_32x32x32_bf16 v[120:135], v[48:51], v[88:95], v6
    v_exp_f32 v100, v100
    v_exp_f32 v101, v101
    v_exp_f32 v102, v102
    v_exp_f32 v103, v103
    ds_read_b128 v[34:37], v2 offset:35840
    ds_read_b32 v38, v3 offset:8960
    v_smfmac_f32_32x32x32_bf16 v[120:135], v[52:55], v[96:103], v6
    v_exp_f32 v104, v104
    v_exp_f32 v105, v105
    v_exp_f32 v106, v106
    v_exp_f32 v107, v107
    v_mfma_f32_32x32x16_bf16 v[56:71], v[28:31], v[16:19], v[56:71]
    v_exp_f32 v108, v108
    v_exp_f32 v109, v109
    v_exp_f32 v110, v110
    v_exp_f32 v111, v111
    v_mfma_f32_32x32x16_bf16 v[72:87], v[28:31], v[20:23], v[72:87]
    v_exp_f32 v112, v112
    v_exp_f32 v113, v113
    v_exp_f32 v114, v114
    v_exp_f32 v115, v115
    v_smfmac_f32_32x32x32_bf16 v[136:151], v[48:51], v[104:111], v6
    v_exp_f32 v116, v116
    v_exp_f32 v117, v117
    v_exp_f32 v118, v118
    v_exp_f32 v119, v119
    s_nop 0
    s_waitcnt lgkmcnt(0)
    v_smfmac_f32_32x32x32_bf16 v[136:151], v[52:55], v[112:119], v6
    s_mov_b64 exec, s[16:17]
    ds_read_b128 v[48:51], v5 offset:3456
    ds_read_b128 v[52:55], v5 offset:4032
    s_mov_b64 exec, -1
    v_exp_f32 v56, v56
    v_exp_f32 v57, v57
    v_exp_f32 v58, v58
    v_exp_f32 v59, v59
    v_mfma_f32_32x32x4_2b_bf16 v[88:119], v[38:39], v[24:25], 0
    v_exp_f32 v60, v60
    v_exp_f32 v61, v61
    v_exp_f32 v62, v62
    v_exp_f32 v63, v63
    v_exp_f32 v64, v64
    v_exp_f32 v65, v65
    v_exp_f32 v66, v66
    v_exp_f32 v67, v67
    v_smfmac_f32_32x32x32_bf16 v[120:135], v[40:43], v[56:63], v6
    v_exp_f32 v68, v68
    v_exp_f32 v69, v69
    v_exp_f32 v70, v70
    v_exp_f32 v71, v71
    ds_read_b128 v[28:31], v2 offset:36864
    ds_read_b32 v32, v3 offset:9216
    v_smfmac_f32_32x32x32_bf16 v[120:135], v[44:47], v[64:71], v6
    v_exp_f32 v72, v72
    v_exp_f32 v73, v73
    v_exp_f32 v74, v74
    v_exp_f32 v75, v75
    v_mfma_f32_32x32x16_bf16 v[88:103], v[34:37], v[16:19], v[88:103]
    v_exp_f32 v76, v76
    v_exp_f32 v77, v77
    v_exp_f32 v78, v78
    v_exp_f32 v79, v79
    v_mfma_f32_32x32x16_bf16 v[104:119], v[34:37], v[20:23], v[104:119]
    v_exp_f32 v80, v80
    v_exp_f32 v81, v81
    v_exp_f32 v82, v82
    v_exp_f32 v83, v83
    v_smfmac_f32_32x32x32_bf16 v[136:151], v[40:43], v[72:79], v6
    v_exp_f32 v84, v84
    v_exp_f32 v85, v85
    v_exp_f32 v86, v86
    v_exp_f32 v87, v87
    s_nop 0
    s_waitcnt lgkmcnt(0)
    v_smfmac_f32_32x32x32_bf16 v[136:151], v[44:47], v[80:87], v6
    s_mov_b64 exec, s[16:17]
    ds_read_b128 v[40:43], v5 offset:4608
    ds_read_b128 v[44:47], v5 offset:5184
    s_mov_b64 exec, -1
    v_exp_f32 v88, v88
    v_exp_f32 v89, v89
    v_exp_f32 v90, v90
    v_exp_f32 v91, v91
    v_mfma_f32_32x32x4_2b_bf16 v[56:87], v[32:33], v[24:25], 0
    v_exp_f32 v92, v92
    v_exp_f32 v93, v93
    v_exp_f32 v94, v94
    v_exp_f32 v95, v95
    v_exp_f32 v96, v96
    v_exp_f32 v97, v97
    v_exp_f32 v98, v98
    v_exp_f32 v99, v99
    v_smfmac_f32_32x32x32_bf16 v[120:135], v[48:51], v[88:95], v6
    v_exp_f32 v100, v100
    v_exp_f32 v101, v101
    v_exp_f32 v102, v102
    v_exp_f32 v103, v103
    ds_read_b128 v[34:37], v2 offset:37888
    ds_read_b32 v38, v3 offset:9472
    v_smfmac_f32_32x32x32_bf16 v[120:135], v[52:55], v[96:103], v6
    v_exp_f32 v104, v104
    v_exp_f32 v105, v105
    v_exp_f32 v106, v106
    v_exp_f32 v107, v107
    v_mfma_f32_32x32x16_bf16 v[56:71], v[28:31], v[16:19], v[56:71]
    v_exp_f32 v108, v108
    v_exp_f32 v109, v109
    v_exp_f32 v110, v110
    v_exp_f32 v111, v111
    v_mfma_f32_32x32x16_bf16 v[72:87], v[28:31], v[20:23], v[72:87]
    v_exp_f32 v112, v112
    v_exp_f32 v113, v113
    v_exp_f32 v114, v114
    v_exp_f32 v115, v115
    v_smfmac_f32_32x32x32_bf16 v[136:151], v[48:51], v[104:111], v6
    v_exp_f32 v116, v116
    v_exp_f32 v117, v117
    v_exp_f32 v118, v118
    v_exp_f32 v119, v119
    s_nop 0
    s_waitcnt lgkmcnt(0)
    v_smfmac_f32_32x32x32_bf16 v[136:151], v[52:55], v[112:119], v6
    s_mov_b64 exec, s[16:17]
    ds_read_b128 v[48:51], v5 offset:5760
    ds_read_b128 v[52:55], v5 offset:6336
    s_mov_b64 exec, -1
    v_exp_f32 v56, v56
    v_exp_f32 v57, v57
    v_exp_f32 v58, v58
    v_exp_f32 v59, v59
    v_mfma_f32_32x32x4_2b_bf16 v[88:119], v[38:39], v[24:25], 0
    v_exp_f32 v60, v60
    v_exp_f32 v61, v61
    v_exp_f32 v62, v62
    v_exp_f32 v63, v63
    v_exp_f32 v64, v64
    v_exp_f32 v65, v65
    v_exp_f32 v66, v66
    v_exp_f32 v67, v67
    v_smfmac_f32_32x32x32_bf16 v[120:135], v[40:43], v[56:63], v6
    v_exp_f32 v68, v68
    v_exp_f32 v69, v69
    v_exp_f32 v70, v70
    v_exp_f32 v71, v71
    ds_read_b128 v[28:31], v2 offset:38912
    ds_read_b32 v32, v3 offset:9728
    v_smfmac_f32_32x32x32_bf16 v[120:135], v[44:47], v[64:71], v6
    v_exp_f32 v72, v72
    v_exp_f32 v73, v73
    v_exp_f32 v74, v74
    v_exp_f32 v75, v75
    v_mfma_f32_32x32x16_bf16 v[88:103], v[34:37], v[16:19], v[88:103]
    v_exp_f32 v76, v76
    v_exp_f32 v77, v77
    v_exp_f32 v78, v78
    v_exp_f32 v79, v79
    v_mfma_f32_32x32x16_bf16 v[104:119], v[34:37], v[20:23], v[104:119]
    v_exp_f32 v80, v80
    v_exp_f32 v81, v81
    v_exp_f32 v82, v82
    v_exp_f32 v83, v83
    v_smfmac_f32_32x32x32_bf16 v[136:151], v[40:43], v[72:79], v6
    v_exp_f32 v84, v84
    v_exp_f32 v85, v85
    v_exp_f32 v86, v86
    v_exp_f32 v87, v87
    s_nop 0
    s_waitcnt lgkmcnt(0)
    v_smfmac_f32_32x32x32_bf16 v[136:151], v[44:47], v[80:87], v6
    s_mov_b64 exec, s[16:17]
    ds_read_b128 v[40:43], v5 offset:6912
    ds_read_b128 v[44:47], v5 offset:7488
    s_mov_b64 exec, -1
    v_exp_f32 v88, v88
    v_exp_f32 v89, v89
    v_exp_f32 v90, v90
    v_exp_f32 v91, v91
    v_mfma_f32_32x32x4_2b_bf16 v[56:87], v[32:33], v[24:25], 0
    v_exp_f32 v92, v92
    v_exp_f32 v93, v93
    v_exp_f32 v94, v94
    v_exp_f32 v95, v95
    v_exp_f32 v96, v96
    v_exp_f32 v97, v97
    v_exp_f32 v98, v98
    v_exp_f32 v99, v99
    v_smfmac_f32_32x32x32_bf16 v[120:135], v[48:51], v[88:95], v6
    v_exp_f32 v100, v100
    v_exp_f32 v101, v101
    v_exp_f32 v102, v102
    v_exp_f32 v103, v103
    ds_read_b128 v[34:37], v2 offset:39936
    ds_read_b32 v38, v3 offset:9984
    v_smfmac_f32_32x32x32_bf16 v[120:135], v[52:55], v[96:103], v6
    v_exp_f32 v104, v104
    v_exp_f32 v105, v105
    v_exp_f32 v106, v106
    v_exp_f32 v107, v107
    v_mfma_f32_32x32x16_bf16 v[56:71], v[28:31], v[16:19], v[56:71]
    v_exp_f32 v108, v108
    v_exp_f32 v109, v109
    v_exp_f32 v110, v110
    v_exp_f32 v111, v111
    v_mfma_f32_32x32x16_bf16 v[72:87], v[28:31], v[20:23], v[72:87]
    v_exp_f32 v112, v112
    v_exp_f32 v113, v113
    v_exp_f32 v114, v114
    v_exp_f32 v115, v115
    v_smfmac_f32_32x32x32_bf16 v[136:151], v[48:51], v[104:111], v6
    v_exp_f32 v116, v116
    v_exp_f32 v117, v117
    v_exp_f32 v118, v118
    v_exp_f32 v119, v119
    s_nop 0
    s_waitcnt lgkmcnt(0)
    v_smfmac_f32_32x32x32_bf16 v[136:151], v[52:55], v[112:119], v6
    s_mov_b64 exec, s[16:17]
    ds_read_b128 v[48:51], v5 offset:8064
    ds_read_b128 v[52:55], v5 offset:8640
    s_mov_b64 exec, -1
    v_exp_f32 v56, v56
    v_exp_f32 v57, v57
    v_exp_f32 v58, v58
    v_exp_f32 v59, v59
    v_mfma_f32_32x32x4_2b_bf16 v[88:119], v[38:39], v[24:25], 0
    v_exp_f32 v60, v60
    v_exp_f32 v61, v61
    v_exp_f32 v62, v62
    v_exp_f32 v63, v63
    v_exp_f32 v64, v64
    v_exp_f32 v65, v65
    v_exp_f32 v66, v66
    v_exp_f32 v67, v67
    v_smfmac_f32_32x32x32_bf16 v[120:135], v[40:43], v[56:63], v6
    v_exp_f32 v68, v68
    v_exp_f32 v69, v69
    v_exp_f32 v70, v70
    v_exp_f32 v71, v71
    ds_read_b128 v[28:31], v2 offset:40960
    ds_read_b32 v32, v3 offset:10240
    v_smfmac_f32_32x32x32_bf16 v[120:135], v[44:47], v[64:71], v6
    v_exp_f32 v72, v72
    v_exp_f32 v73, v73
    v_exp_f32 v74, v74
    v_exp_f32 v75, v75
    v_mfma_f32_32x32x16_bf16 v[88:103], v[34:37], v[16:19], v[88:103]
    v_exp_f32 v76, v76
    v_exp_f32 v77, v77
    v_exp_f32 v78, v78
    v_exp_f32 v79, v79
    v_mfma_f32_32x32x16_bf16 v[104:119], v[34:37], v[20:23], v[104:119]
    v_exp_f32 v80, v80
    v_exp_f32 v81, v81
    v_exp_f32 v82, v82
    v_exp_f32 v83, v83
    v_smfmac_f32_32x32x32_bf16 v[136:151], v[40:43], v[72:79], v6
    v_exp_f32 v84, v84
    v_exp_f32 v85, v85
    v_exp_f32 v86, v86
    v_exp_f32 v87, v87
    s_nop 0
    s_waitcnt lgkmcnt(0)
    v_smfmac_f32_32x32x32_bf16 v[136:151], v[44:47], v[80:87], v6
    s_mov_b64 exec, s[16:17]
    ds_read_b128 v[40:43], v5 offset:9216
    ds_read_b128 v[44:47], v5 offset:9792
    s_mov_b64 exec, -1
    v_exp_f32 v88, v88
    v_exp_f32 v89, v89
    v_exp_f32 v90, v90
    v_exp_f32 v91, v91
    v_mfma_f32_32x32x4_2b_bf16 v[56:87], v[32:33], v[24:25], 0
    v_exp_f32 v92, v92
    v_exp_f32 v93, v93
    v_exp_f32 v94, v94
    v_exp_f32 v95, v95
    v_exp_f32 v96, v96
    v_exp_f32 v97, v97
    v_exp_f32 v98, v98
    v_exp_f32 v99, v99
    v_smfmac_f32_32x32x32_bf16 v[120:135], v[48:51], v[88:95], v6
    v_exp_f32 v100, v100
    v_exp_f32 v101, v101
    v_exp_f32 v102, v102
    v_exp_f32 v103, v103
    ds_read_b128 v[34:37], v2 offset:41984
    ds_read_b32 v38, v3 offset:10496
    v_smfmac_f32_32x32x32_bf16 v[120:135], v[52:55], v[96:103], v6
    v_exp_f32 v104, v104
    v_exp_f32 v105, v105
    v_exp_f32 v106, v106
    v_exp_f32 v107, v107
    v_mfma_f32_32x32x16_bf16 v[56:71], v[28:31], v[16:19], v[56:71]
    v_exp_f32 v108, v108
    v_exp_f32 v109, v109
    v_exp_f32 v110, v110
    v_exp_f32 v111, v111
    v_mfma_f32_32x32x16_bf16 v[72:87], v[28:31], v[20:23], v[72:87]
    v_exp_f32 v112, v112
    v_exp_f32 v113, v113
    v_exp_f32 v114, v114
    v_exp_f32 v115, v115
    v_smfmac_f32_32x32x32_bf16 v[136:151], v[48:51], v[104:111], v6
    v_exp_f32 v116, v116
    v_exp_f32 v117, v117
    v_exp_f32 v118, v118
    v_exp_f32 v119, v119
    s_nop 0
    s_waitcnt lgkmcnt(0)
    v_smfmac_f32_32x32x32_bf16 v[136:151], v[52:55], v[112:119], v6
    s_mov_b64 exec, s[16:17]
    ds_read_b128 v[48:51], v5 offset:10368
    ds_read_b128 v[52:55], v5 offset:10944
    s_mov_b64 exec, -1
    v_exp_f32 v56, v56
    v_exp_f32 v57, v57
    v_exp_f32 v58, v58
    v_exp_f32 v59, v59
    v_mfma_f32_32x32x4_2b_bf16 v[88:119], v[38:39], v[24:25], 0
    v_exp_f32 v60, v60
    v_exp_f32 v61, v61
    v_exp_f32 v62, v62
    v_exp_f32 v63, v63
    v_exp_f32 v64, v64
    v_exp_f32 v65, v65
    v_exp_f32 v66, v66
    v_exp_f32 v67, v67
    v_smfmac_f32_32x32x32_bf16 v[120:135], v[40:43], v[56:63], v6
    v_exp_f32 v68, v68
    v_exp_f32 v69, v69
    v_exp_f32 v70, v70
    v_exp_f32 v71, v71
    ds_read_b128 v[28:31], v2 offset:43008
    ds_read_b32 v32, v3 offset:10752
    v_smfmac_f32_32x32x32_bf16 v[120:135], v[44:47], v[64:71], v6
    v_exp_f32 v72, v72
    v_exp_f32 v73, v73
    v_exp_f32 v74, v74
    v_exp_f32 v75, v75
    v_mfma_f32_32x32x16_bf16 v[88:103], v[34:37], v[16:19], v[88:103]
    v_exp_f32 v76, v76
    v_exp_f32 v77, v77
    v_exp_f32 v78, v78
    v_exp_f32 v79, v79
    v_mfma_f32_32x32x16_bf16 v[104:119], v[34:37], v[20:23], v[104:119]
    v_exp_f32 v80, v80
    v_exp_f32 v81, v81
    v_exp_f32 v82, v82
    v_exp_f32 v83, v83
    v_smfmac_f32_32x32x32_bf16 v[136:151], v[40:43], v[72:79], v6
    v_exp_f32 v84, v84
    v_exp_f32 v85, v85
    v_exp_f32 v86, v86
    v_exp_f32 v87, v87
    s_nop 0
    s_waitcnt lgkmcnt(0)
    v_smfmac_f32_32x32x32_bf16 v[136:151], v[44:47], v[80:87], v6
    s_mov_b64 exec, s[16:17]
    ds_read_b128 v[40:43], v5 offset:11520
    ds_read_b128 v[44:47], v5 offset:12096
    s_mov_b64 exec, -1
    v_exp_f32 v88, v88
    v_exp_f32 v89, v89
    v_exp_f32 v90, v90
    v_exp_f32 v91, v91
    v_mfma_f32_32x32x4_2b_bf16 v[56:87], v[32:33], v[24:25], 0
    v_exp_f32 v92, v92
    v_exp_f32 v93, v93
    v_exp_f32 v94, v94
    v_exp_f32 v95, v95
    v_exp_f32 v96, v96
    v_exp_f32 v97, v97
    v_exp_f32 v98, v98
    v_exp_f32 v99, v99
    v_smfmac_f32_32x32x32_bf16 v[120:135], v[48:51], v[88:95], v6
    v_exp_f32 v100, v100
    v_exp_f32 v101, v101
    v_exp_f32 v102, v102
    v_exp_f32 v103, v103
    ds_read_b128 v[34:37], v2 offset:44032
    ds_read_b32 v38, v3 offset:11008
    v_smfmac_f32_32x32x32_bf16 v[120:135], v[52:55], v[96:103], v6
    v_exp_f32 v104, v104
    v_exp_f32 v105, v105
    v_exp_f32 v106, v106
    v_exp_f32 v107, v107
    v_mfma_f32_32x32x16_bf16 v[56:71], v[28:31], v[16:19], v[56:71]
    v_exp_f32 v108, v108
    v_exp_f32 v109, v109
    v_exp_f32 v110, v110
    v_exp_f32 v111, v111
    v_mfma_f32_32x32x16_bf16 v[72:87], v[28:31], v[20:23], v[72:87]
    v_exp_f32 v112, v112
    v_exp_f32 v113, v113
    v_exp_f32 v114, v114
    v_exp_f32 v115, v115
    v_smfmac_f32_32x32x32_bf16 v[136:151], v[48:51], v[104:111], v6
    v_exp_f32 v116, v116
    v_exp_f32 v117, v117
    v_exp_f32 v118, v118
    v_exp_f32 v119, v119
    s_nop 0
    s_waitcnt lgkmcnt(0)
    v_smfmac_f32_32x32x32_bf16 v[136:151], v[52:55], v[112:119], v6
    s_mov_b64 exec, s[16:17]
    ds_read_b128 v[48:51], v5 offset:12672
    ds_read_b128 v[52:55], v5 offset:13248
    s_mov_b64 exec, -1
    v_exp_f32 v56, v56
    v_exp_f32 v57, v57
    v_exp_f32 v58, v58
    v_exp_f32 v59, v59
    v_mfma_f32_32x32x4_2b_bf16 v[88:119], v[38:39], v[24:25], 0
    v_exp_f32 v60, v60
    v_exp_f32 v61, v61
    v_exp_f32 v62, v62
    v_exp_f32 v63, v63
    v_exp_f32 v64, v64
    v_exp_f32 v65, v65
    v_exp_f32 v66, v66
    v_exp_f32 v67, v67
    v_smfmac_f32_32x32x32_bf16 v[120:135], v[40:43], v[56:63], v6
    v_exp_f32 v68, v68
    v_exp_f32 v69, v69
    v_exp_f32 v70, v70
    v_exp_f32 v71, v71
    ds_read_b128 v[28:31], v2 offset:45056
    ds_read_b32 v32, v3 offset:11264
    v_smfmac_f32_32x32x32_bf16 v[120:135], v[44:47], v[64:71], v6
    v_exp_f32 v72, v72
    v_exp_f32 v73, v73
    v_exp_f32 v74, v74
    v_exp_f32 v75, v75
    v_mfma_f32_32x32x16_bf16 v[88:103], v[34:37], v[16:19], v[88:103]
    v_exp_f32 v76, v76
    v_exp_f32 v77, v77
    v_exp_f32 v78, v78
    v_exp_f32 v79, v79
    v_mfma_f32_32x32x16_bf16 v[104:119], v[34:37], v[20:23], v[104:119]
    v_exp_f32 v80, v80
    v_exp_f32 v81, v81
    v_exp_f32 v82, v82
    v_exp_f32 v83, v83
    v_smfmac_f32_32x32x32_bf16 v[136:151], v[40:43], v[72:79], v6
    v_exp_f32 v84, v84
    v_exp_f32 v85, v85
    v_exp_f32 v86, v86
    v_exp_f32 v87, v87
    s_nop 0
    s_waitcnt lgkmcnt(0)
    v_smfmac_f32_32x32x32_bf16 v[136:151], v[44:47], v[80:87], v6
    s_mov_b64 exec, s[16:17]
    ds_read_b128 v[40:43], v5 offset:13824
    ds_read_b128 v[44:47], v5 offset:14400
    s_mov_b64 exec, -1
    v_exp_f32 v88, v88
    v_exp_f32 v89, v89
    v_exp_f32 v90, v90
    v_exp_f32 v91, v91
    v_mfma_f32_32x32x4_2b_bf16 v[56:87], v[32:33], v[24:25], 0
    v_exp_f32 v92, v92
    v_exp_f32 v93, v93
    v_exp_f32 v94, v94
    v_exp_f32 v95, v95
    v_exp_f32 v96, v96
    v_exp_f32 v97, v97
    v_exp_f32 v98, v98
    v_exp_f32 v99, v99
    v_smfmac_f32_32x32x32_bf16 v[120:135], v[48:51], v[88:95], v6
    v_exp_f32 v100, v100
    v_exp_f32 v101, v101
    v_exp_f32 v102, v102
    v_exp_f32 v103, v103
    ds_read_b128 v[34:37], v2 offset:46080
    ds_read_b32 v38, v3 offset:11520
    v_smfmac_f32_32x32x32_bf16 v[120:135], v[52:55], v[96:103], v6
    v_exp_f32 v104, v104
    v_exp_f32 v105, v105
    v_exp_f32 v106, v106
    v_exp_f32 v107, v107
    v_mfma_f32_32x32x16_bf16 v[56:71], v[28:31], v[16:19], v[56:71]
    v_exp_f32 v108, v108
    v_exp_f32 v109, v109
    v_exp_f32 v110, v110
    v_exp_f32 v111, v111
    v_mfma_f32_32x32x16_bf16 v[72:87], v[28:31], v[20:23], v[72:87]
    v_exp_f32 v112, v112
    v_exp_f32 v113, v113
    v_exp_f32 v114, v114
    v_exp_f32 v115, v115
    v_smfmac_f32_32x32x32_bf16 v[136:151], v[48:51], v[104:111], v6
    v_exp_f32 v116, v116
    v_exp_f32 v117, v117
    v_exp_f32 v118, v118
    v_exp_f32 v119, v119
    s_nop 0
    s_waitcnt lgkmcnt(0)
    v_smfmac_f32_32x32x32_bf16 v[136:151], v[52:55], v[112:119], v6
    s_mov_b64 exec, s[16:17]
    ds_read_b128 v[48:51], v5 offset:14976
    ds_read_b128 v[52:55], v5 offset:15552
    s_mov_b64 exec, -1
    v_exp_f32 v56, v56
    v_exp_f32 v57, v57
    v_exp_f32 v58, v58
    v_exp_f32 v59, v59
    v_mfma_f32_32x32x4_2b_bf16 v[88:119], v[38:39], v[24:25], 0
    v_exp_f32 v60, v60
    v_exp_f32 v61, v61
    v_exp_f32 v62, v62
    v_exp_f32 v63, v63
    v_exp_f32 v64, v64
    v_exp_f32 v65, v65
    v_exp_f32 v66, v66
    v_exp_f32 v67, v67
    v_smfmac_f32_32x32x32_bf16 v[120:135], v[40:43], v[56:63], v6
    v_exp_f32 v68, v68
    v_exp_f32 v69, v69
    v_exp_f32 v70, v70
    v_exp_f32 v71, v71
    ds_read_b128 v[28:31], v2 offset:47104
    ds_read_b32 v32, v3 offset:11776
    v_smfmac_f32_32x32x32_bf16 v[120:135], v[44:47], v[64:71], v6
    v_exp_f32 v72, v72
    v_exp_f32 v73, v73
    v_exp_f32 v74, v74
    v_exp_f32 v75, v75
    v_mfma_f32_32x32x16_bf16 v[88:103], v[34:37], v[16:19], v[88:103]
    v_exp_f32 v76, v76
    v_exp_f32 v77, v77
    v_exp_f32 v78, v78
    v_exp_f32 v79, v79
    v_mfma_f32_32x32x16_bf16 v[104:119], v[34:37], v[20:23], v[104:119]
    v_exp_f32 v80, v80
    v_exp_f32 v81, v81
    v_exp_f32 v82, v82
    v_exp_f32 v83, v83
    v_smfmac_f32_32x32x32_bf16 v[136:151], v[40:43], v[72:79], v6
    v_exp_f32 v84, v84
    v_exp_f32 v85, v85
    v_exp_f32 v86, v86
    v_exp_f32 v87, v87
    s_nop 0
    s_waitcnt lgkmcnt(0)
    v_smfmac_f32_32x32x32_bf16 v[136:151], v[44:47], v[80:87], v6
    s_mov_b64 exec, s[16:17]
    ds_read_b128 v[40:43], v5 offset:16128
    ds_read_b128 v[44:47], v5 offset:16704
    s_mov_b64 exec, -1
    v_exp_f32 v88, v88
    v_exp_f32 v89, v89
    v_exp_f32 v90, v90
    v_exp_f32 v91, v91
    v_mfma_f32_32x32x4_2b_bf16 v[56:87], v[32:33], v[24:25], 0
    v_exp_f32 v92, v92
    v_exp_f32 v93, v93
    v_exp_f32 v94, v94
    v_exp_f32 v95, v95
    v_exp_f32 v96, v96
    v_exp_f32 v97, v97
    v_exp_f32 v98, v98
    v_exp_f32 v99, v99
    v_smfmac_f32_32x32x32_bf16 v[120:135], v[48:51], v[88:95], v6
    v_exp_f32 v100, v100
    v_exp_f32 v101, v101
    v_exp_f32 v102, v102
    v_exp_f32 v103, v103
    ds_read_b128 v[34:37], v2 offset:48128
    ds_read_b32 v38, v3 offset:12032
    v_smfmac_f32_32x32x32_bf16 v[120:135], v[52:55], v[96:103], v6
    v_exp_f32 v104, v104
    v_exp_f32 v105, v105
    v_exp_f32 v106, v106
    v_exp_f32 v107, v107
    v_mfma_f32_32x32x16_bf16 v[56:71], v[28:31], v[16:19], v[56:71]
    v_exp_f32 v108, v108
    v_exp_f32 v109, v109
    v_exp_f32 v110, v110
    v_exp_f32 v111, v111
    v_mfma_f32_32x32x16_bf16 v[72:87], v[28:31], v[20:23], v[72:87]
    v_exp_f32 v112, v112
    v_exp_f32 v113, v113
    v_exp_f32 v114, v114
    v_exp_f32 v115, v115
    v_smfmac_f32_32x32x32_bf16 v[136:151], v[48:51], v[104:111], v6
    v_exp_f32 v116, v116
    v_exp_f32 v117, v117
    v_exp_f32 v118, v118
    v_exp_f32 v119, v119
    s_nop 0
    s_waitcnt lgkmcnt(0)
    v_smfmac_f32_32x32x32_bf16 v[136:151], v[52:55], v[112:119], v6
    s_mov_b64 exec, s[16:17]
    ds_read_b128 v[48:51], v5 offset:17280
    ds_read_b128 v[52:55], v5 offset:17856
    s_mov_b64 exec, -1
    v_exp_f32 v56, v56
    v_exp_f32 v57, v57
    v_exp_f32 v58, v58
    v_exp_f32 v59, v59
    v_mfma_f32_32x32x4_2b_bf16 v[88:119], v[38:39], v[24:25], 0
    v_exp_f32 v60, v60
    v_exp_f32 v61, v61
    v_exp_f32 v62, v62
    v_exp_f32 v63, v63
    v_exp_f32 v64, v64
    v_exp_f32 v65, v65
    v_exp_f32 v66, v66
    v_exp_f32 v67, v67
    v_smfmac_f32_32x32x32_bf16 v[120:135], v[40:43], v[56:63], v6
    v_exp_f32 v68, v68
    v_exp_f32 v69, v69
    v_exp_f32 v70, v70
    v_exp_f32 v71, v71
    ds_read_b128 v[28:31], v2 offset:49152
    ds_read_b32 v32, v3 offset:12288
    v_smfmac_f32_32x32x32_bf16 v[120:135], v[44:47], v[64:71], v6
    v_exp_f32 v72, v72
    v_exp_f32 v73, v73
    v_exp_f32 v74, v74
    v_exp_f32 v75, v75
    v_mfma_f32_32x32x16_bf16 v[88:103], v[34:37], v[16:19], v[88:103]
    v_exp_f32 v76, v76
    v_exp_f32 v77, v77
    v_exp_f32 v78, v78
    v_exp_f32 v79, v79
    v_mfma_f32_32x32x16_bf16 v[104:119], v[34:37], v[20:23], v[104:119]
    v_exp_f32 v80, v80
    v_exp_f32 v81, v81
    v_exp_f32 v82, v82
    v_exp_f32 v83, v83
    v_smfmac_f32_32x32x32_bf16 v[136:151], v[40:43], v[72:79], v6
    v_exp_f32 v84, v84
    v_exp_f32 v85, v85
    v_exp_f32 v86, v86
    v_exp_f32 v87, v87
    s_nop 0
    s_waitcnt lgkmcnt(0)
    v_smfmac_f32_32x32x32_bf16 v[136:151], v[44:47], v[80:87], v6
    s_mov_b64 exec, s[16:17]
    ds_read_b128 v[40:43], v5 offset:18432
    ds_read_b128 v[44:47], v5 offset:19008
    s_mov_b64 exec, -1
    v_exp_f32 v88, v88
    v_exp_f32 v89, v89
    v_exp_f32 v90, v90
    v_exp_f32 v91, v91
    v_mfma_f32_32x32x4_2b_bf16 v[56:87], v[32:33], v[24:25], 0
    v_exp_f32 v92, v92
    v_exp_f32 v93, v93
    v_exp_f32 v94, v94
    v_exp_f32 v95, v95
    v_exp_f32 v96, v96
    v_exp_f32 v97, v97
    v_exp_f32 v98, v98
    v_exp_f32 v99, v99
    v_smfmac_f32_32x32x32_bf16 v[120:135], v[48:51], v[88:95], v6
    v_exp_f32 v100, v100
    v_exp_f32 v101, v101
    v_exp_f32 v102, v102
    v_exp_f32 v103, v103
    ds_read_b128 v[34:37], v2 offset:50176
    ds_read_b32 v38, v3 offset:12544
    v_smfmac_f32_32x32x32_bf16 v[120:135], v[52:55], v[96:103], v6
    v_exp_f32 v104, v104
    v_exp_f32 v105, v105
    v_exp_f32 v106, v106
    v_exp_f32 v107, v107
    v_mfma_f32_32x32x16_bf16 v[56:71], v[28:31], v[16:19], v[56:71]
    v_exp_f32 v108, v108
    v_exp_f32 v109, v109
    v_exp_f32 v110, v110
    v_exp_f32 v111, v111
    v_mfma_f32_32x32x16_bf16 v[72:87], v[28:31], v[20:23], v[72:87]
    v_exp_f32 v112, v112
    v_exp_f32 v113, v113
    v_exp_f32 v114, v114
    v_exp_f32 v115, v115
    v_smfmac_f32_32x32x32_bf16 v[136:151], v[48:51], v[104:111], v6
    v_exp_f32 v116, v116
    v_exp_f32 v117, v117
    v_exp_f32 v118, v118
    v_exp_f32 v119, v119
    s_nop 0
    s_waitcnt lgkmcnt(0)
    v_smfmac_f32_32x32x32_bf16 v[136:151], v[52:55], v[112:119], v6
    s_mov_b64 exec, s[16:17]
    ds_read_b128 v[48:51], v5 offset:19584
    ds_read_b128 v[52:55], v5 offset:20160
    s_mov_b64 exec, -1
    v_exp_f32 v56, v56
    v_exp_f32 v57, v57
    v_exp_f32 v58, v58
    v_exp_f32 v59, v59
    v_mfma_f32_32x32x4_2b_bf16 v[88:119], v[38:39], v[24:25], 0
    v_exp_f32 v60, v60
    v_exp_f32 v61, v61
    v_exp_f32 v62, v62
    v_exp_f32 v63, v63
    v_exp_f32 v64, v64
    v_exp_f32 v65, v65
    v_exp_f32 v66, v66
    v_exp_f32 v67, v67
    v_smfmac_f32_32x32x32_bf16 v[120:135], v[40:43], v[56:63], v6
    v_exp_f32 v68, v68
    v_exp_f32 v69, v69
    v_exp_f32 v70, v70
    v_exp_f32 v71, v71
    ds_read_b128 v[28:31], v2 offset:51200
    ds_read_b32 v32, v3 offset:12800
    v_smfmac_f32_32x32x32_bf16 v[120:135], v[44:47], v[64:71], v6
    v_exp_f32 v72, v72
    v_exp_f32 v73, v73
    v_exp_f32 v74, v74
    v_exp_f32 v75, v75
    v_mfma_f32_32x32x16_bf16 v[88:103], v[34:37], v[16:19], v[88:103]
    v_exp_f32 v76, v76
    v_exp_f32 v77, v77
    v_exp_f32 v78, v78
    v_exp_f32 v79, v79
    v_mfma_f32_32x32x16_bf16 v[104:119], v[34:37], v[20:23], v[104:119]
    v_exp_f32 v80, v80
    v_exp_f32 v81, v81
    v_exp_f32 v82, v82
    v_exp_f32 v83, v83
    v_smfmac_f32_32x32x32_bf16 v[136:151], v[40:43], v[72:79], v6
    v_exp_f32 v84, v84
    v_exp_f32 v85, v85
    v_exp_f32 v86, v86
    v_exp_f32 v87, v87
    s_nop 0
    s_waitcnt lgkmcnt(0)
    v_smfmac_f32_32x32x32_bf16 v[136:151], v[44:47], v[80:87], v6
    s_mov_b64 exec, s[16:17]
    ds_read_b128 v[40:43], v5 offset:20736
    ds_read_b128 v[44:47], v5 offset:21312
    s_mov_b64 exec, -1
    v_exp_f32 v88, v88
    v_exp_f32 v89, v89
    v_exp_f32 v90, v90
    v_exp_f32 v91, v91
    v_mfma_f32_32x32x4_2b_bf16 v[56:87], v[32:33], v[24:25], 0
    v_exp_f32 v92, v92
    v_exp_f32 v93, v93
    v_exp_f32 v94, v94
    v_exp_f32 v95, v95
    v_exp_f32 v96, v96
    v_exp_f32 v97, v97
    v_exp_f32 v98, v98
    v_exp_f32 v99, v99
    v_smfmac_f32_32x32x32_bf16 v[120:135], v[48:51], v[88:95], v6
    v_exp_f32 v100, v100
    v_exp_f32 v101, v101
    v_exp_f32 v102, v102
    v_exp_f32 v103, v103
    ds_read_b128 v[34:37], v2 offset:52224
    ds_read_b32 v38, v3 offset:13056
    v_smfmac_f32_32x32x32_bf16 v[120:135], v[52:55], v[96:103], v6
    v_exp_f32 v104, v104
    v_exp_f32 v105, v105
    v_exp_f32 v106, v106
    v_exp_f32 v107, v107
    v_mfma_f32_32x32x16_bf16 v[56:71], v[28:31], v[16:19], v[56:71]
    v_exp_f32 v108, v108
    v_exp_f32 v109, v109
    v_exp_f32 v110, v110
    v_exp_f32 v111, v111
    v_mfma_f32_32x32x16_bf16 v[72:87], v[28:31], v[20:23], v[72:87]
    v_exp_f32 v112, v112
    v_exp_f32 v113, v113
    v_exp_f32 v114, v114
    v_exp_f32 v115, v115
    v_smfmac_f32_32x32x32_bf16 v[136:151], v[48:51], v[104:111], v6
    v_exp_f32 v116, v116
    v_exp_f32 v117, v117
    v_exp_f32 v118, v118
    v_exp_f32 v119, v119
    s_nop 0
    s_waitcnt lgkmcnt(0)
    v_smfmac_f32_32x32x32_bf16 v[136:151], v[52:55], v[112:119], v6
    s_mov_b64 exec, s[16:17]
    ds_read_b128 v[48:51], v5 offset:21888
    ds_read_b128 v[52:55], v5 offset:22464
    s_mov_b64 exec, -1
    v_exp_f32 v56, v56
    v_exp_f32 v57, v57
    v_exp_f32 v58, v58
    v_exp_f32 v59, v59
    v_mfma_f32_32x32x4_2b_bf16 v[88:119], v[38:39], v[24:25], 0
    v_exp_f32 v60, v60
    v_exp_f32 v61, v61
    v_exp_f32 v62, v62
    v_exp_f32 v63, v63
    v_exp_f32 v64, v64
    v_exp_f32 v65, v65
    v_exp_f32 v66, v66
    v_exp_f32 v67, v67
    v_smfmac_f32_32x32x32_bf16 v[120:135], v[40:43], v[56:63], v6
    v_exp_f32 v68, v68
    v_exp_f32 v69, v69
    v_exp_f32 v70, v70
    v_exp_f32 v71, v71
    ds_read_b128 v[28:31], v2 offset:53248
    ds_read_b32 v32, v3 offset:13312
    v_smfmac_f32_32x32x32_bf16 v[120:135], v[44:47], v[64:71], v6
    v_exp_f32 v72, v72
    v_exp_f32 v73, v73
    v_exp_f32 v74, v74
    v_exp_f32 v75, v75
    v_mfma_f32_32x32x16_bf16 v[88:103], v[34:37], v[16:19], v[88:103]
    v_exp_f32 v76, v76
    v_exp_f32 v77, v77
    v_exp_f32 v78, v78
    v_exp_f32 v79, v79
    v_mfma_f32_32x32x16_bf16 v[104:119], v[34:37], v[20:23], v[104:119]
    v_exp_f32 v80, v80
    v_exp_f32 v81, v81
    v_exp_f32 v82, v82
    v_exp_f32 v83, v83
    v_smfmac_f32_32x32x32_bf16 v[136:151], v[40:43], v[72:79], v6
    v_exp_f32 v84, v84
    v_exp_f32 v85, v85
    v_exp_f32 v86, v86
    v_exp_f32 v87, v87
    s_nop 0
    s_waitcnt lgkmcnt(0)
    v_smfmac_f32_32x32x32_bf16 v[136:151], v[44:47], v[80:87], v6
    s_mov_b64 exec, s[16:17]
    ds_read_b128 v[40:43], v5 offset:23040
    ds_read_b128 v[44:47], v5 offset:23616
    s_mov_b64 exec, -1
    v_exp_f32 v88, v88
    v_exp_f32 v89, v89
    v_exp_f32 v90, v90
    v_exp_f32 v91, v91
    v_mfma_f32_32x32x4_2b_bf16 v[56:87], v[32:33], v[24:25], 0
    v_exp_f32 v92, v92
    v_exp_f32 v93, v93
    v_exp_f32 v94, v94
    v_exp_f32 v95, v95
    v_exp_f32 v96, v96
    v_exp_f32 v97, v97
    v_exp_f32 v98, v98
    v_exp_f32 v99, v99
    v_smfmac_f32_32x32x32_bf16 v[120:135], v[48:51], v[88:95], v6
    v_exp_f32 v100, v100
    v_exp_f32 v101, v101
    v_exp_f32 v102, v102
    v_exp_f32 v103, v103
    ds_read_b128 v[34:37], v2 offset:54272
    ds_read_b32 v38, v3 offset:13568
    v_smfmac_f32_32x32x32_bf16 v[120:135], v[52:55], v[96:103], v6
    v_exp_f32 v104, v104
    v_exp_f32 v105, v105
    v_exp_f32 v106, v106
    v_exp_f32 v107, v107
    v_mfma_f32_32x32x16_bf16 v[56:71], v[28:31], v[16:19], v[56:71]
    v_exp_f32 v108, v108
    v_exp_f32 v109, v109
    v_exp_f32 v110, v110
    v_exp_f32 v111, v111
    v_mfma_f32_32x32x16_bf16 v[72:87], v[28:31], v[20:23], v[72:87]
    v_exp_f32 v112, v112
    v_exp_f32 v113, v113
    v_exp_f32 v114, v114
    v_exp_f32 v115, v115
    v_smfmac_f32_32x32x32_bf16 v[136:151], v[48:51], v[104:111], v6
    v_exp_f32 v116, v116
    v_exp_f32 v117, v117
    v_exp_f32 v118, v118
    v_exp_f32 v119, v119
    s_nop 0
    s_waitcnt lgkmcnt(0)
    v_smfmac_f32_32x32x32_bf16 v[136:151], v[52:55], v[112:119], v6
    s_mov_b64 exec, s[16:17]
    ds_read_b128 v[48:51], v5 offset:24192
    ds_read_b128 v[52:55], v5 offset:24768
    s_mov_b64 exec, -1
    v_exp_f32 v56, v56
    v_exp_f32 v57, v57
    v_exp_f32 v58, v58
    v_exp_f32 v59, v59
    v_mfma_f32_32x32x4_2b_bf16 v[88:119], v[38:39], v[24:25], 0
    v_exp_f32 v60, v60
    v_exp_f32 v61, v61
    v_exp_f32 v62, v62
    v_exp_f32 v63, v63
    v_exp_f32 v64, v64
    v_exp_f32 v65, v65
    v_exp_f32 v66, v66
    v_exp_f32 v67, v67
    v_smfmac_f32_32x32x32_bf16 v[120:135], v[40:43], v[56:63], v6
    v_exp_f32 v68, v68
    v_exp_f32 v69, v69
    v_exp_f32 v70, v70
    v_exp_f32 v71, v71
    ds_read_b128 v[28:31], v2 offset:55296
    ds_read_b32 v32, v3 offset:13824
    v_smfmac_f32_32x32x32_bf16 v[120:135], v[44:47], v[64:71], v6
    v_exp_f32 v72, v72
    v_exp_f32 v73, v73
    v_exp_f32 v74, v74
    v_exp_f32 v75, v75
    v_mfma_f32_32x32x16_bf16 v[88:103], v[34:37], v[16:19], v[88:103]
    v_exp_f32 v76, v76
    v_exp_f32 v77, v77
    v_exp_f32 v78, v78
    v_exp_f32 v79, v79
    v_mfma_f32_32x32x16_bf16 v[104:119], v[34:37], v[20:23], v[104:119]
    v_exp_f32 v80, v80
    v_exp_f32 v81, v81
    v_exp_f32 v82, v82
    v_exp_f32 v83, v83
    v_smfmac_f32_32x32x32_bf16 v[136:151], v[40:43], v[72:79], v6
    v_exp_f32 v84, v84
    v_exp_f32 v85, v85
    v_exp_f32 v86, v86
    v_exp_f32 v87, v87
    s_nop 0
    s_waitcnt lgkmcnt(0)
    v_smfmac_f32_32x32x32_bf16 v[136:151], v[44:47], v[80:87], v6
    s_mov_b64 exec, s[16:17]
    ds_read_b128 v[40:43], v5 offset:25344
    ds_read_b128 v[44:47], v5 offset:25920
    s_mov_b64 exec, -1
    v_exp_f32 v88, v88
    v_exp_f32 v89, v89
    v_exp_f32 v90, v90
    v_exp_f32 v91, v91
    v_mfma_f32_32x32x4_2b_bf16 v[56:87], v[32:33], v[24:25], 0
    v_exp_f32 v92, v92
    v_exp_f32 v93, v93
    v_exp_f32 v94, v94
    v_exp_f32 v95, v95
    v_exp_f32 v96, v96
    v_exp_f32 v97, v97
    v_exp_f32 v98, v98
    v_exp_f32 v99, v99
    v_smfmac_f32_32x32x32_bf16 v[120:135], v[48:51], v[88:95], v6
    v_exp_f32 v100, v100
    v_exp_f32 v101, v101
    v_exp_f32 v102, v102
    v_exp_f32 v103, v103
    ds_read_b128 v[34:37], v2 offset:56320
    ds_read_b32 v38, v3 offset:14080
    v_smfmac_f32_32x32x32_bf16 v[120:135], v[52:55], v[96:103], v6
    v_exp_f32 v104, v104
    v_exp_f32 v105, v105
    v_exp_f32 v106, v106
    v_exp_f32 v107, v107
    v_mfma_f32_32x32x16_bf16 v[56:71], v[28:31], v[16:19], v[56:71]
    v_exp_f32 v108, v108
    v_exp_f32 v109, v109
    v_exp_f32 v110, v110
    v_exp_f32 v111, v111
    v_mfma_f32_32x32x16_bf16 v[72:87], v[28:31], v[20:23], v[72:87]
    v_exp_f32 v112, v112
    v_exp_f32 v113, v113
    v_exp_f32 v114, v114
    v_exp_f32 v115, v115
    v_smfmac_f32_32x32x32_bf16 v[136:151], v[48:51], v[104:111], v6
    v_exp_f32 v116, v116
    v_exp_f32 v117, v117
    v_exp_f32 v118, v118
    v_exp_f32 v119, v119
    s_nop 0
    s_waitcnt lgkmcnt(0)
    v_smfmac_f32_32x32x32_bf16 v[136:151], v[52:55], v[112:119], v6
    s_mov_b64 exec, s[16:17]
    ds_read_b128 v[48:51], v5 offset:26496
    ds_read_b128 v[52:55], v5 offset:27072
    s_mov_b64 exec, -1
    v_exp_f32 v56, v56
    v_exp_f32 v57, v57
    v_exp_f32 v58, v58
    v_exp_f32 v59, v59
    v_mfma_f32_32x32x4_2b_bf16 v[88:119], v[38:39], v[24:25], 0
    v_exp_f32 v60, v60
    v_exp_f32 v61, v61
    v_exp_f32 v62, v62
    v_exp_f32 v63, v63
    v_exp_f32 v64, v64
    v_exp_f32 v65, v65
    v_exp_f32 v66, v66
    v_exp_f32 v67, v67
    v_smfmac_f32_32x32x32_bf16 v[120:135], v[40:43], v[56:63], v6
    v_exp_f32 v68, v68
    v_exp_f32 v69, v69
    v_exp_f32 v70, v70
    v_exp_f32 v71, v71
    ds_read_b128 v[28:31], v2 offset:57344
    ds_read_b32 v32, v3 offset:14336
    v_smfmac_f32_32x32x32_bf16 v[120:135], v[44:47], v[64:71], v6
    v_exp_f32 v72, v72
    v_exp_f32 v73, v73
    v_exp_f32 v74, v74
    v_exp_f32 v75, v75
    v_mfma_f32_32x32x16_bf16 v[88:103], v[34:37], v[16:19], v[88:103]
    v_exp_f32 v76, v76
    v_exp_f32 v77, v77
    v_exp_f32 v78, v78
    v_exp_f32 v79, v79
    v_mfma_f32_32x32x16_bf16 v[104:119], v[34:37], v[20:23], v[104:119]
    v_exp_f32 v80, v80
    v_exp_f32 v81, v81
    v_exp_f32 v82, v82
    v_exp_f32 v83, v83
    v_smfmac_f32_32x32x32_bf16 v[136:151], v[40:43], v[72:79], v6
    v_exp_f32 v84, v84
    v_exp_f32 v85, v85
    v_exp_f32 v86, v86
    v_exp_f32 v87, v87
    s_nop 0
    s_waitcnt lgkmcnt(0)
    v_smfmac_f32_32x32x32_bf16 v[136:151], v[44:47], v[80:87], v6
    s_mov_b64 exec, s[16:17]
    ds_read_b128 v[40:43], v5 offset:27648
    ds_read_b128 v[44:47], v5 offset:28224
    s_mov_b64 exec, -1
    v_exp_f32 v88, v88
    v_exp_f32 v89, v89
    v_exp_f32 v90, v90
    v_exp_f32 v91, v91
    v_mfma_f32_32x32x4_2b_bf16 v[56:87], v[32:33], v[24:25], 0
    v_exp_f32 v92, v92
    v_exp_f32 v93, v93
    v_exp_f32 v94, v94
    v_exp_f32 v95, v95
    v_exp_f32 v96, v96
    v_exp_f32 v97, v97
    v_exp_f32 v98, v98
    v_exp_f32 v99, v99
    v_smfmac_f32_32x32x32_bf16 v[120:135], v[48:51], v[88:95], v6
    v_exp_f32 v100, v100
    v_exp_f32 v101, v101
    v_exp_f32 v102, v102
    v_exp_f32 v103, v103
    ds_read_b128 v[34:37], v2 offset:58368
    ds_read_b32 v38, v3 offset:14592
    v_smfmac_f32_32x32x32_bf16 v[120:135], v[52:55], v[96:103], v6
    v_exp_f32 v104, v104
    v_exp_f32 v105, v105
    v_exp_f32 v106, v106
    v_exp_f32 v107, v107
    v_mfma_f32_32x32x16_bf16 v[56:71], v[28:31], v[16:19], v[56:71]
    v_exp_f32 v108, v108
    v_exp_f32 v109, v109
    v_exp_f32 v110, v110
    v_exp_f32 v111, v111
    v_mfma_f32_32x32x16_bf16 v[72:87], v[28:31], v[20:23], v[72:87]
    v_exp_f32 v112, v112
    v_exp_f32 v113, v113
    v_exp_f32 v114, v114
    v_exp_f32 v115, v115
    v_smfmac_f32_32x32x32_bf16 v[136:151], v[48:51], v[104:111], v6
    v_exp_f32 v116, v116
    v_exp_f32 v117, v117
    v_exp_f32 v118, v118
    v_exp_f32 v119, v119
    s_nop 0
    s_waitcnt lgkmcnt(0)
    v_smfmac_f32_32x32x32_bf16 v[136:151], v[52:55], v[112:119], v6
    s_mov_b64 exec, s[16:17]
    ds_read_b128 v[48:51], v5 offset:28800
    ds_read_b128 v[52:55], v5 offset:29376
    s_mov_b64 exec, -1
    v_exp_f32 v56, v56
    v_exp_f32 v57, v57
    v_exp_f32 v58, v58
    v_exp_f32 v59, v59
    v_mfma_f32_32x32x4_2b_bf16 v[88:119], v[38:39], v[24:25], 0
    v_exp_f32 v60, v60
    v_exp_f32 v61, v61
    v_exp_f32 v62, v62
    v_exp_f32 v63, v63
    v_exp_f32 v64, v64
    v_exp_f32 v65, v65
    v_exp_f32 v66, v66
    v_exp_f32 v67, v67
    v_smfmac_f32_32x32x32_bf16 v[120:135], v[40:43], v[56:63], v6
    v_exp_f32 v68, v68
    v_exp_f32 v69, v69
    v_exp_f32 v70, v70
    v_exp_f32 v71, v71
    ds_read_b128 v[28:31], v2 offset:59392
    ds_read_b32 v32, v3 offset:14848
    v_smfmac_f32_32x32x32_bf16 v[120:135], v[44:47], v[64:71], v6
    v_exp_f32 v72, v72
    v_exp_f32 v73, v73
    v_exp_f32 v74, v74
    v_exp_f32 v75, v75
    v_mfma_f32_32x32x16_bf16 v[88:103], v[34:37], v[16:19], v[88:103]
    v_exp_f32 v76, v76
    v_exp_f32 v77, v77
    v_exp_f32 v78, v78
    v_exp_f32 v79, v79
    v_mfma_f32_32x32x16_bf16 v[104:119], v[34:37], v[20:23], v[104:119]
    v_exp_f32 v80, v80
    v_exp_f32 v81, v81
    v_exp_f32 v82, v82
    v_exp_f32 v83, v83
    v_smfmac_f32_32x32x32_bf16 v[136:151], v[40:43], v[72:79], v6
    v_exp_f32 v84, v84
    v_exp_f32 v85, v85
    v_exp_f32 v86, v86
    v_exp_f32 v87, v87
    s_nop 0
    s_waitcnt lgkmcnt(0)
    v_smfmac_f32_32x32x32_bf16 v[136:151], v[44:47], v[80:87], v6
    s_mov_b64 exec, s[16:17]
    ds_read_b128 v[40:43], v5 offset:29952
    ds_read_b128 v[44:47], v5 offset:30528
    s_mov_b64 exec, -1
    v_exp_f32 v88, v88
    v_exp_f32 v89, v89
    v_exp_f32 v90, v90
    v_exp_f32 v91, v91
    v_mfma_f32_32x32x4_2b_bf16 v[56:87], v[32:33], v[24:25], 0
    v_exp_f32 v92, v92
    v_exp_f32 v93, v93
    v_exp_f32 v94, v94
    v_exp_f32 v95, v95
    v_exp_f32 v96, v96
    v_exp_f32 v97, v97
    v_exp_f32 v98, v98
    v_exp_f32 v99, v99
    v_smfmac_f32_32x32x32_bf16 v[120:135], v[48:51], v[88:95], v6
    v_exp_f32 v100, v100
    v_exp_f32 v101, v101
    v_exp_f32 v102, v102
    v_exp_f32 v103, v103
    ds_read_b128 v[34:37], v2 offset:60416
    ds_read_b32 v38, v3 offset:15104
    v_smfmac_f32_32x32x32_bf16 v[120:135], v[52:55], v[96:103], v6
    v_exp_f32 v104, v104
    v_exp_f32 v105, v105
    v_exp_f32 v106, v106
    v_exp_f32 v107, v107
    v_mfma_f32_32x32x16_bf16 v[56:71], v[28:31], v[16:19], v[56:71]
    v_exp_f32 v108, v108
    v_exp_f32 v109, v109
    v_exp_f32 v110, v110
    v_exp_f32 v111, v111
    v_mfma_f32_32x32x16_bf16 v[72:87], v[28:31], v[20:23], v[72:87]
    v_exp_f32 v112, v112
    v_exp_f32 v113, v113
    v_exp_f32 v114, v114
    v_exp_f32 v115, v115
    v_smfmac_f32_32x32x32_bf16 v[136:151], v[48:51], v[104:111], v6
    v_exp_f32 v116, v116
    v_exp_f32 v117, v117
    v_exp_f32 v118, v118
    v_exp_f32 v119, v119
    s_nop 0
    s_waitcnt lgkmcnt(0)
    v_smfmac_f32_32x32x32_bf16 v[136:151], v[52:55], v[112:119], v6
    s_mov_b64 exec, s[16:17]
    ds_read_b128 v[48:51], v5 offset:31104
    ds_read_b128 v[52:55], v5 offset:31680
    s_mov_b64 exec, -1
    v_exp_f32 v56, v56
    v_exp_f32 v57, v57
    v_exp_f32 v58, v58
    v_exp_f32 v59, v59
    v_mfma_f32_32x32x4_2b_bf16 v[88:119], v[38:39], v[24:25], 0
    v_exp_f32 v60, v60
    v_exp_f32 v61, v61
    v_exp_f32 v62, v62
    v_exp_f32 v63, v63
    v_exp_f32 v64, v64
    v_exp_f32 v65, v65
    v_exp_f32 v66, v66
    v_exp_f32 v67, v67
    v_smfmac_f32_32x32x32_bf16 v[120:135], v[40:43], v[56:63], v6
    v_exp_f32 v68, v68
    v_exp_f32 v69, v69
    v_exp_f32 v70, v70
    v_exp_f32 v71, v71
    ds_read_b128 v[28:31], v2 offset:61440
    ds_read_b32 v32, v3 offset:15360
    v_smfmac_f32_32x32x32_bf16 v[120:135], v[44:47], v[64:71], v6
    v_exp_f32 v72, v72
    v_exp_f32 v73, v73
    v_exp_f32 v74, v74
    v_exp_f32 v75, v75
    v_mfma_f32_32x32x16_bf16 v[88:103], v[34:37], v[16:19], v[88:103]
    v_exp_f32 v76, v76
    v_exp_f32 v77, v77
    v_exp_f32 v78, v78
    v_exp_f32 v79, v79
    v_mfma_f32_32x32x16_bf16 v[104:119], v[34:37], v[20:23], v[104:119]
    v_exp_f32 v80, v80
    v_exp_f32 v81, v81
    v_exp_f32 v82, v82
    v_exp_f32 v83, v83
    v_smfmac_f32_32x32x32_bf16 v[136:151], v[40:43], v[72:79], v6
    v_exp_f32 v84, v84
    v_exp_f32 v85, v85
    v_exp_f32 v86, v86
    v_exp_f32 v87, v87
    s_nop 0
    s_waitcnt lgkmcnt(0)
    v_smfmac_f32_32x32x32_bf16 v[136:151], v[44:47], v[80:87], v6
    s_mov_b64 exec, s[16:17]
    ds_read_b128 v[40:43], v5 offset:32256
    ds_read_b128 v[44:47], v5 offset:32832
    s_mov_b64 exec, -1
    v_exp_f32 v88, v88
    v_exp_f32 v89, v89
    v_exp_f32 v90, v90
    v_exp_f32 v91, v91
    v_mfma_f32_32x32x4_2b_bf16 v[56:87], v[32:33], v[24:25], 0
    v_exp_f32 v92, v92
    v_exp_f32 v93, v93
    v_exp_f32 v94, v94
    v_exp_f32 v95, v95
    v_exp_f32 v96, v96
    v_exp_f32 v97, v97
    v_exp_f32 v98, v98
    v_exp_f32 v99, v99
    v_smfmac_f32_32x32x32_bf16 v[120:135], v[48:51], v[88:95], v6
    v_exp_f32 v100, v100
    v_exp_f32 v101, v101
    v_exp_f32 v102, v102
    v_exp_f32 v103, v103
    ds_read_b128 v[34:37], v2 offset:62464
    ds_read_b32 v38, v3 offset:15616
    v_smfmac_f32_32x32x32_bf16 v[120:135], v[52:55], v[96:103], v6
    v_exp_f32 v104, v104
    v_exp_f32 v105, v105
    v_exp_f32 v106, v106
    v_exp_f32 v107, v107
    v_mfma_f32_32x32x16_bf16 v[56:71], v[28:31], v[16:19], v[56:71]
    v_exp_f32 v108, v108
    v_exp_f32 v109, v109
    v_exp_f32 v110, v110
    v_exp_f32 v111, v111
    v_mfma_f32_32x32x16_bf16 v[72:87], v[28:31], v[20:23], v[72:87]
    v_exp_f32 v112, v112
    v_exp_f32 v113, v113
    v_exp_f32 v114, v114
    v_exp_f32 v115, v115
    v_smfmac_f32_32x32x32_bf16 v[136:151], v[48:51], v[104:111], v6
    v_exp_f32 v116, v116
    v_exp_f32 v117, v117
    v_exp_f32 v118, v118
    v_exp_f32 v119, v119
    s_nop 0
    s_waitcnt lgkmcnt(0)
    v_smfmac_f32_32x32x32_bf16 v[136:151], v[52:55], v[112:119], v6
    s_mov_b64 exec, s[16:17]
    ds_read_b128 v[48:51], v5 offset:33408
    ds_read_b128 v[52:55], v5 offset:33984
    s_mov_b64 exec, -1
    v_exp_f32 v56, v56
    v_exp_f32 v57, v57
    v_exp_f32 v58, v58
    v_exp_f32 v59, v59
    v_mfma_f32_32x32x4_2b_bf16 v[88:119], v[38:39], v[24:25], 0
    v_exp_f32 v60, v60
    v_exp_f32 v61, v61
    v_exp_f32 v62, v62
    v_exp_f32 v63, v63
    v_exp_f32 v64, v64
    v_exp_f32 v65, v65
    v_exp_f32 v66, v66
    v_exp_f32 v67, v67
    v_smfmac_f32_32x32x32_bf16 v[120:135], v[40:43], v[56:63], v6
    v_exp_f32 v68, v68
    v_exp_f32 v69, v69
    v_exp_f32 v70, v70
    v_exp_f32 v71, v71
    ds_read_b128 v[28:31], v2 offset:63488
    ds_read_b32 v32, v3 offset:15872
    v_smfmac_f32_32x32x32_bf16 v[120:135], v[44:47], v[64:71], v6
    v_exp_f32 v72, v72
    v_exp_f32 v73, v73
    v_exp_f32 v74, v74
    v_exp_f32 v75, v75
    v_mfma_f32_32x32x16_bf16 v[88:103], v[34:37], v[16:19], v[88:103]
    v_exp_f32 v76, v76
    v_exp_f32 v77, v77
    v_exp_f32 v78, v78
    v_exp_f32 v79, v79
    v_mfma_f32_32x32x16_bf16 v[104:119], v[34:37], v[20:23], v[104:119]
    v_exp_f32 v80, v80
    v_exp_f32 v81, v81
    v_exp_f32 v82, v82
    v_exp_f32 v83, v83
    v_smfmac_f32_32x32x32_bf16 v[136:151], v[40:43], v[72:79], v6
    v_exp_f32 v84, v84
    v_exp_f32 v85, v85
    v_exp_f32 v86, v86
    v_exp_f32 v87, v87
    s_nop 0
    s_waitcnt lgkmcnt(0)
    v_smfmac_f32_32x32x32_bf16 v[136:151], v[44:47], v[80:87], v6
    s_mov_b64 exec, s[16:17]
    ds_read_b128 v[40:43], v5 offset:34560
    ds_read_b128 v[44:47], v5 offset:35136
    s_mov_b64 exec, -1
    v_exp_f32 v88, v88
    v_exp_f32 v89, v89
    v_exp_f32 v90, v90
    v_exp_f32 v91, v91
    v_mfma_f32_32x32x4_2b_bf16 v[56:87], v[32:33], v[24:25], 0
    v_exp_f32 v92, v92
    v_exp_f32 v93, v93
    v_exp_f32 v94, v94
    v_exp_f32 v95, v95
    v_exp_f32 v96, v96
    v_exp_f32 v97, v97
    v_exp_f32 v98, v98
    v_exp_f32 v99, v99
    v_smfmac_f32_32x32x32_bf16 v[120:135], v[48:51], v[88:95], v6
    v_exp_f32 v100, v100
    v_exp_f32 v101, v101
    v_exp_f32 v102, v102
    v_exp_f32 v103, v103
    ds_read_b128 v[34:37], v2 offset:64512
    ds_read_b32 v38, v3 offset:16128
    v_smfmac_f32_32x32x32_bf16 v[120:135], v[52:55], v[96:103], v6
    v_exp_f32 v104, v104
    v_exp_f32 v105, v105
    v_exp_f32 v106, v106
    v_exp_f32 v107, v107
    v_mfma_f32_32x32x16_bf16 v[56:71], v[28:31], v[16:19], v[56:71]
    v_exp_f32 v108, v108
    v_exp_f32 v109, v109
    v_exp_f32 v110, v110
    v_exp_f32 v111, v111
    v_mfma_f32_32x32x16_bf16 v[72:87], v[28:31], v[20:23], v[72:87]
    v_exp_f32 v112, v112
    v_exp_f32 v113, v113
    v_exp_f32 v114, v114
    v_exp_f32 v115, v115
    v_smfmac_f32_32x32x32_bf16 v[136:151], v[48:51], v[104:111], v6
    v_exp_f32 v116, v116
    v_exp_f32 v117, v117
    v_exp_f32 v118, v118
    v_exp_f32 v119, v119
    s_nop 0
    s_waitcnt lgkmcnt(0)
    v_smfmac_f32_32x32x32_bf16 v[136:151], v[52:55], v[112:119], v6
    s_mov_b64 exec, s[16:17]
    ds_read_b128 v[48:51], v5 offset:35712
    ds_read_b128 v[52:55], v5 offset:36288
    s_mov_b64 exec, -1
    v_exp_f32 v56, v56
    v_exp_f32 v57, v57
    v_exp_f32 v58, v58
    v_exp_f32 v59, v59
    v_mfma_f32_32x32x4_2b_bf16 v[88:119], v[38:39], v[24:25], 0
    v_exp_f32 v60, v60
    v_exp_f32 v61, v61
    v_exp_f32 v62, v62
    v_exp_f32 v63, v63
    v_exp_f32 v64, v64
    v_exp_f32 v65, v65
    v_exp_f32 v66, v66
    v_exp_f32 v67, v67
    v_smfmac_f32_32x32x32_bf16 v[120:135], v[40:43], v[56:63], v6
    v_exp_f32 v68, v68
    v_exp_f32 v69, v69
    v_exp_f32 v70, v70
    v_exp_f32 v71, v71
    s_nop 1
    v_smfmac_f32_32x32x32_bf16 v[120:135], v[44:47], v[64:71], v6
    v_exp_f32 v72, v72
    v_exp_f32 v73, v73
    v_exp_f32 v74, v74
    v_exp_f32 v75, v75
    v_mfma_f32_32x32x16_bf16 v[88:103], v[34:37], v[16:19], v[88:103]
    v_exp_f32 v76, v76
    v_exp_f32 v77, v77
    v_exp_f32 v78, v78
    v_exp_f32 v79, v79
    v_mfma_f32_32x32x16_bf16 v[104:119], v[34:37], v[20:23], v[104:119]
    v_exp_f32 v80, v80
    v_exp_f32 v81, v81
    v_exp_f32 v82, v82
    v_exp_f32 v83, v83
    v_smfmac_f32_32x32x32_bf16 v[136:151], v[40:43], v[72:79], v6
    v_exp_f32 v84, v84
    v_exp_f32 v85, v85
    v_exp_f32 v86, v86
    v_exp_f32 v87, v87
    s_nop 0
    s_waitcnt lgkmcnt(0)
    v_smfmac_f32_32x32x32_bf16 v[136:151], v[44:47], v[80:87], v6
    v_exp_f32 v88, v88
    v_exp_f32 v89, v89
    v_exp_f32 v90, v90
    v_exp_f32 v91, v91
    v_exp_f32 v92, v92
    v_exp_f32 v93, v93
    v_exp_f32 v94, v94
    v_exp_f32 v95, v95
    v_exp_f32 v96, v96
    v_exp_f32 v97, v97
    v_exp_f32 v98, v98
    v_exp_f32 v99, v99
    v_smfmac_f32_32x32x32_bf16 v[120:135], v[48:51], v[88:95], v6
    v_exp_f32 v100, v100
    v_exp_f32 v101, v101
    v_exp_f32 v102, v102
    v_exp_f32 v103, v103
    s_nop 1
    v_smfmac_f32_32x32x32_bf16 v[120:135], v[52:55], v[96:103], v6
    v_exp_f32 v104, v104
    v_exp_f32 v105, v105
    v_exp_f32 v106, v106
    v_exp_f32 v107, v107
    v_exp_f32 v108, v108
    v_exp_f32 v109, v109
    v_exp_f32 v110, v110
    v_exp_f32 v111, v111
    v_exp_f32 v112, v112
    v_exp_f32 v113, v113
    v_exp_f32 v114, v114
    v_exp_f32 v115, v115
    v_smfmac_f32_32x32x32_bf16 v[136:151], v[48:51], v[104:111], v6
    v_exp_f32 v116, v116
    v_exp_f32 v117, v117
    v_exp_f32 v118, v118
    v_exp_f32 v119, v119
    s_nop 1
    v_smfmac_f32_32x32x32_bf16 v[136:151], v[52:55], v[112:119], v6
    s_setprio 0
    s_branch L_p2_loopdone
L_p2_loopB:
    ds_read_b128 v[28:31], v2 offset:0
    ds_read_b32 v32, v3 offset:0
    s_mov_b64 exec, s[16:17]
    ds_read_b128 v[40:43], v4 offset:0
    ds_read_b128 v[44:47], v4 offset:576
    s_mov_b64 exec, -1
    s_waitcnt lgkmcnt(0)
    v_mfma_f32_32x32x4_2b_bf16 v[56:87], v[32:33], v[24:25], 0
    ds_read_b128 v[34:37], v2 offset:1024
    ds_read_b32 v38, v3 offset:256
    s_nop 15
    s_nop 1
    v_mfma_f32_32x32x16_bf16 v[56:71], v[28:31], v[16:19], v[56:71]
    v_mfma_f32_32x32x16_bf16 v[72:87], v[28:31], v[20:23], v[72:87]
    s_nop 7
    s_nop 3
    s_mov_b32 m0, s26
    s_add_u32 s26, s26, 8192
    buffer_load_dwordx4 v2, s[8:11], s25 offen sc1 lds
    s_add_u32 s25, s25, 8192
    s_mov_b32 m0, s29
    s_add_u32 s29, s29, 8192
    buffer_load_dwordx4 v2, s[8:11], s28 offen sc1 lds
    s_add_u32 s28, s28, 8192
    s_add_u32 m0, s34, 8192
    s_add_u32 s33, s33, 8192
    buffer_load_dwordx4 v2, s[8:11], s33 offen sc1 lds
    s_setprio 2
    s_waitcnt lgkmcnt(0)
    s_mov_b64 exec, s[16:17]
    ds_read_b128 v[48:51], v4 offset:1152
    ds_read_b128 v[52:55], v4 offset:1728
    s_mov_b64 exec, -1
    v_exp_f32 v56, v56
    v_exp_f32 v57, v57
    v_exp_f32 v58, v58
    v_exp_f32 v59, v59
    v_mfma_f32_32x32x4_2b_bf16 v[88:119], v[38:39], v[24:25], 0
    v_exp_f32 v60, v60
    v_exp_f32 v61, v61
    v_exp_f32 v62, v62
    v_exp_f32 v63, v63
    v_exp_f32 v64, v64
    v_exp_f32 v65, v65
    v_exp_f32 v66, v66
    v_exp_f32 v67, v67
    v_smfmac_f32_32x32x32_bf16 v[120:135], v[40:43], v[56:63], v6
    v_exp_f32 v68, v68
    v_exp_f32 v69, v69
    v_exp_f32 v70, v70
    v_exp_f32 v71, v71
    ds_read_b128 v[28:31], v2 offset:2048
    ds_read_b32 v32, v3 offset:512
    v_smfmac_f32_32x32x32_bf16 v[120:135], v[44:47], v[64:71], v6
    v_exp_f32 v72, v72
    v_exp_f32 v73, v73
    v_exp_f32 v74, v74
    v_exp_f32 v75, v75
    v_mfma_f32_32x32x16_bf16 v[88:103], v[34:37], v[16:19], v[88:103]
    v_exp_f32 v76, v76
    v_exp_f32 v77, v77
    v_exp_f32 v78, v78
    v_exp_f32 v79, v79
    v_mfma_f32_32x32x16_bf16 v[104:119], v[34:37], v[20:23], v[104:119]
    v_exp_f32 v80, v80
    v_exp_f32 v81, v81
    v_exp_f32 v82, v82
    v_exp_f32 v83, v83
    v_smfmac_f32_32x32x32_bf16 v[136:151], v[40:43], v[72:79], v6
    v_exp_f32 v84, v84
    v_exp_f32 v85, v85
    v_exp_f32 v86, v86
    v_exp_f32 v87, v87
    s_mov_b32 m0, s26
    s_add_u32 s26, s26, 8192
    buffer_load_dwordx4 v2, s[8:11], s25 offen sc1 lds
    s_add_u32 s25, s25, 8192
    s_mov_b32 m0, s29
    s_add_u32 s29, s29, 8192
    buffer_load_dwordx4 v2, s[8:11], s28 offen sc1 lds
    s_add_u32 s28, s28, 8192
    s_nop 0
    s_waitcnt lgkmcnt(0)
    v_smfmac_f32_32x32x32_bf16 v[136:151], v[44:47], v[80:87], v6
    s_mov_b64 exec, s[16:17]
    ds_read_b128 v[40:43], v4 offset:2304
    ds_read_b128 v[44:47], v4 offset:2880
    s_mov_b64 exec, -1
    v_exp_f32 v88, v88
    v_exp_f32 v89, v89
    v_exp_f32 v90, v90
    v_exp_f32 v91, v91
    v_mfma_f32_32x32x4_2b_bf16 v[56:87], v[32:33], v[24:25], 0
    v_exp_f32 v92, v92
    v_exp_f32 v93, v93
    v_exp_f32 v94, v94
    v_exp_f32 v95, v95
    v_exp_f32 v96, v96
    v_exp_f32 v97, v97
    v_exp_f32 v98, v98
    v_exp_f32 v99, v99
    v_smfmac_f32_32x32x32_bf16 v[120:135], v[48:51], v[88:95], v6
    v_exp_f32 v100, v100
    v_exp_f32 v101, v101
    v_exp_f32 v102, v102
    v_exp_f32 v103, v103
    ds_read_b128 v[34:37], v2 offset:3072
    ds_read_b32 v38, v3 offset:768
    v_smfmac_f32_32x32x32_bf16 v[120:135], v[52:55], v[96:103], v6
    v_exp_f32 v104, v104
    v_exp_f32 v105, v105
    v_exp_f32 v106, v106
    v_exp_f32 v107, v107
    v_mfma_f32_32x32x16_bf16 v[56:71], v[28:31], v[16:19], v[56:71]
    v_exp_f32 v108, v108
    v_exp_f32 v109, v109
    v_exp_f32 v110, v110
    v_exp_f32 v111, v111
    v_mfma_f32_32x32x16_bf16 v[72:87], v[28:31], v[20:23], v[72:87]
    v_exp_f32 v112, v112
    v_exp_f32 v113, v113
    v_exp_f32 v114, v114
    v_exp_f32 v115, v115
    v_smfmac_f32_32x32x32_bf16 v[136:151], v[48:51], v[104:111], v6
    v_exp_f32 v116, v116
    v_exp_f32 v117, v117
    v_exp_f32 v118, v118
    v_exp_f32 v119, v119
    s_mov_b32 m0, s26
    s_add_u32 s26, s26, 8192
    buffer_load_dwordx4 v2, s[8:11], s25 offen sc1 lds
    s_add_u32 s25, s25, 8192
    s_mov_b32 m0, s29
    s_add_u32 s29, s29, 8192
    buffer_load_dwordx4 v2, s[8:11], s28 offen sc1 lds
    s_add_u32 s28, s28, 8192
    s_nop 0
    s_waitcnt lgkmcnt(0)
    v_smfmac_f32_32x32x32_bf16 v[136:151], v[52:55], v[112:119], v6
    s_mov_b64 exec, s[16:17]
    ds_read_b128 v[48:51], v4 offset:3456
    ds_read_b128 v[52:55], v4 offset:4032
    s_mov_b64 exec, -1
    v_exp_f32 v56, v56
    v_exp_f32 v57, v57
    v_exp_f32 v58, v58
    v_exp_f32 v59, v59
    v_mfma_f32_32x32x4_2b_bf16 v[88:119], v[38:39], v[24:25], 0
    v_exp_f32 v60, v60
    v_exp_f32 v61, v61
    v_exp_f32 v62, v62
    v_exp_f32 v63, v63
    v_exp_f32 v64, v64
    v_exp_f32 v65, v65
    v_exp_f32 v66, v66
    v_exp_f32 v67, v67
    v_smfmac_f32_32x32x32_bf16 v[120:135], v[40:43], v[56:63], v6
    v_exp_f32 v68, v68
    v_exp_f32 v69, v69
    v_exp_f32 v70, v70
    v_exp_f32 v71, v71
    ds_read_b128 v[28:31], v2 offset:4096
    ds_read_b32 v32, v3 offset:1024
    v_smfmac_f32_32x32x32_bf16 v[120:135], v[44:47], v[64:71], v6
    v_exp_f32 v72, v72
    v_exp_f32 v73, v73
    v_exp_f32 v74, v74
    v_exp_f32 v75, v75
    v_mfma_f32_32x32x16_bf16 v[88:103], v[34:37], v[16:19], v[88:103]
    v_exp_f32 v76, v76
    v_exp_f32 v77, v77
    v_exp_f32 v78, v78
    v_exp_f32 v79, v79
    v_mfma_f32_32x32x16_bf16 v[104:119], v[34:37], v[20:23], v[104:119]
    v_exp_f32 v80, v80
    v_exp_f32 v81, v81
    v_exp_f32 v82, v82
    v_exp_f32 v83, v83
    v_smfmac_f32_32x32x32_bf16 v[136:151], v[40:43], v[72:79], v6
    v_exp_f32 v84, v84
    v_exp_f32 v85, v85
    v_exp_f32 v86, v86
    v_exp_f32 v87, v87
    s_mov_b32 m0, s26
    s_add_u32 s26, s26, 8192
    buffer_load_dwordx4 v2, s[8:11], s25 offen sc1 lds
    s_add_u32 s25, s25, 8192
    s_mov_b32 m0, s29
    s_add_u32 s29, s29, 8192
    buffer_load_dwordx4 v2, s[8:11], s28 offen sc1 lds
    s_add_u32 s28, s28, 8192
    s_nop 0
    s_waitcnt lgkmcnt(0)
    v_smfmac_f32_32x32x32_bf16 v[136:151], v[44:47], v[80:87], v6
    s_mov_b64 exec, s[16:17]
    ds_read_b128 v[40:43], v4 offset:4608
    ds_read_b128 v[44:47], v4 offset:5184
    s_mov_b64 exec, -1
    v_exp_f32 v88, v88
    v_exp_f32 v89, v89
    v_exp_f32 v90, v90
    v_exp_f32 v91, v91
    v_mfma_f32_32x32x4_2b_bf16 v[56:87], v[32:33], v[24:25], 0
    v_exp_f32 v92, v92
    v_exp_f32 v93, v93
    v_exp_f32 v94, v94
    v_exp_f32 v95, v95
    v_exp_f32 v96, v96
    v_exp_f32 v97, v97
    v_exp_f32 v98, v98
    v_exp_f32 v99, v99
    v_smfmac_f32_32x32x32_bf16 v[120:135], v[48:51], v[88:95], v6
    v_exp_f32 v100, v100
    v_exp_f32 v101, v101
    v_exp_f32 v102, v102
    v_exp_f32 v103, v103
    ds_read_b128 v[34:37], v2 offset:5120
    ds_read_b32 v38, v3 offset:1280
    v_smfmac_f32_32x32x32_bf16 v[120:135], v[52:55], v[96:103], v6
    v_exp_f32 v104, v104
    v_exp_f32 v105, v105
    v_exp_f32 v106, v106
    v_exp_f32 v107, v107
    v_mfma_f32_32x32x16_bf16 v[56:71], v[28:31], v[16:19], v[56:71]
    v_exp_f32 v108, v108
    v_exp_f32 v109, v109
    v_exp_f32 v110, v110
    v_exp_f32 v111, v111
    v_mfma_f32_32x32x16_bf16 v[72:87], v[28:31], v[20:23], v[72:87]
    v_exp_f32 v112, v112
    v_exp_f32 v113, v113
    v_exp_f32 v114, v114
    v_exp_f32 v115, v115
    v_smfmac_f32_32x32x32_bf16 v[136:151], v[48:51], v[104:111], v6
    v_exp_f32 v116, v116
    v_exp_f32 v117, v117
    v_exp_f32 v118, v118
    v_exp_f32 v119, v119
    s_mov_b32 m0, s26
    s_add_u32 s26, s26, 8192
    buffer_load_dwordx4 v2, s[8:11], s25 offen sc1 lds
    s_add_u32 s25, s25, 8192
    s_mov_b32 m0, s29
    s_add_u32 s29, s29, 8192
    buffer_load_dwordx4 v2, s[8:11], s28 offen sc1 lds
    s_add_u32 s28, s28, 8192
    s_nop 0
    s_waitcnt lgkmcnt(0)
    v_smfmac_f32_32x32x32_bf16 v[136:151], v[52:55], v[112:119], v6
    s_mov_b64 exec, s[16:17]
    ds_read_b128 v[48:51], v4 offset:5760
    ds_read_b128 v[52:55], v4 offset:6336
    s_mov_b64 exec, -1
    v_exp_f32 v56, v56
    v_exp_f32 v57, v57
    v_exp_f32 v58, v58
    v_exp_f32 v59, v59
    v_mfma_f32_32x32x4_2b_bf16 v[88:119], v[38:39], v[24:25], 0
    v_exp_f32 v60, v60
    v_exp_f32 v61, v61
    v_exp_f32 v62, v62
    v_exp_f32 v63, v63
    v_exp_f32 v64, v64
    v_exp_f32 v65, v65
    v_exp_f32 v66, v66
    v_exp_f32 v67, v67
    v_smfmac_f32_32x32x32_bf16 v[120:135], v[40:43], v[56:63], v6
    v_exp_f32 v68, v68
    v_exp_f32 v69, v69
    v_exp_f32 v70, v70
    v_exp_f32 v71, v71
    ds_read_b128 v[28:31], v2 offset:6144
    ds_read_b32 v32, v3 offset:1536
    v_smfmac_f32_32x32x32_bf16 v[120:135], v[44:47], v[64:71], v6
    v_exp_f32 v72, v72
    v_exp_f32 v73, v73
    v_exp_f32 v74, v74
    v_exp_f32 v75, v75
    v_mfma_f32_32x32x16_bf16 v[88:103], v[34:37], v[16:19], v[88:103]
    v_exp_f32 v76, v76
    v_exp_f32 v77, v77
    v_exp_f32 v78, v78
    v_exp_f32 v79, v79
    v_mfma_f32_32x32x16_bf16 v[104:119], v[34:37], v[20:23], v[104:119]
    v_exp_f32 v80, v80
    v_exp_f32 v81, v81
    v_exp_f32 v82, v82
    v_exp_f32 v83, v83
    v_smfmac_f32_32x32x32_bf16 v[136:151], v[40:43], v[72:79], v6
    v_exp_f32 v84, v84
    v_exp_f32 v85, v85
    v_exp_f32 v86, v86
    v_exp_f32 v87, v87
    s_waitcnt vmcnt(4)
    s_barrier
    s_mov_b32 m0, s26
    s_add_u32 s26, s26, 8192
    buffer_load_dwordx4 v2, s[8:11], s25 offen sc1 lds
    s_add_u32 s25, s25, 8192
    s_mov_b32 m0, s29
    s_add_u32 s29, s29, 8192
    buffer_load_dwordx4 v2, s[8:11], s28 offen sc1 lds
    s_add_u32 s28, s28, 8192
    s_nop 0
    s_waitcnt lgkmcnt(0)
    v_smfmac_f32_32x32x32_bf16 v[136:151], v[44:47], v[80:87], v6
    s_mov_b64 exec, s[16:17]
    ds_read_b128 v[40:43], v4 offset:6912
    ds_read_b128 v[44:47], v4 offset:7488
    s_mov_b64 exec, -1
    v_exp_f32 v88, v88
    v_exp_f32 v89, v89
    v_exp_f32 v90, v90
    v_exp_f32 v91, v91
    v_mfma_f32_32x32x4_2b_bf16 v[56:87], v[32:33], v[24:25], 0
    v_exp_f32 v92, v92
    v_exp_f32 v93, v93
    v_exp_f32 v94, v94
    v_exp_f32 v95, v95
    v_exp_f32 v96, v96
    v_exp_f32 v97, v97
    v_exp_f32 v98, v98
    v_exp_f32 v99, v99
    v_smfmac_f32_32x32x32_bf16 v[120:135], v[48:51], v[88:95], v6
    v_exp_f32 v100, v100
    v_exp_f32 v101, v101
    v_exp_f32 v102, v102
    v_exp_f32 v103, v103
    ds_read_b128 v[34:37], v2 offset:7168
    ds_read_b32 v38, v3 offset:1792
    v_smfmac_f32_32x32x32_bf16 v[120:135], v[52:55], v[96:103], v6
    v_exp_f32 v104, v104
    v_exp_f32 v105, v105
    v_exp_f32 v106, v106
    v_exp_f32 v107, v107
    v_mfma_f32_32x32x16_bf16 v[56:71], v[28:31], v[16:19], v[56:71]
    v_exp_f32 v108, v108
    v_exp_f32 v109, v109
    v_exp_f32 v110, v110
    v_exp_f32 v111, v111
    v_mfma_f32_32x32x16_bf16 v[72:87], v[28:31], v[20:23], v[72:87]
    v_exp_f32 v112, v112
    v_exp_f32 v113, v113
    v_exp_f32 v114, v114
    v_exp_f32 v115, v115
    v_smfmac_f32_32x32x32_bf16 v[136:151], v[48:51], v[104:111], v6
    v_exp_f32 v116, v116
    v_exp_f32 v117, v117
    v_exp_f32 v118, v118
    v_exp_f32 v119, v119
    s_mov_b32 m0, s26
    s_add_u32 s26, s26, 8192
    buffer_load_dwordx4 v2, s[8:11], s25 offen sc1 lds
    s_add_u32 s25, s25, 8192
    s_mov_b32 m0, s29
    s_add_u32 s29, s29, 8192
    buffer_load_dwordx4 v2, s[8:11], s28 offen sc1 lds
    s_add_u32 s28, s28, 8192
    s_setprio 0
    s_waitcnt lgkmcnt(0)
    v_smfmac_f32_32x32x32_bf16 v[136:151], v[52:55], v[112:119], v6
    s_mov_b64 exec, s[16:17]
    ds_read_b128 v[48:51], v4 offset:8064
    ds_read_b128 v[52:55], v4 offset:8640
    s_mov_b64 exec, -1
    v_exp_f32 v56, v56
    v_exp_f32 v57, v57
    v_exp_f32 v58, v58
    v_exp_f32 v59, v59
    v_mfma_f32_32x32x4_2b_bf16 v[88:119], v[38:39], v[24:25], 0
    v_exp_f32 v60, v60
    v_exp_f32 v61, v61
    v_exp_f32 v62, v62
    v_exp_f32 v63, v63
    v_exp_f32 v64, v64
    v_exp_f32 v65, v65
    v_exp_f32 v66, v66
    v_exp_f32 v67, v67
    v_smfmac_f32_32x32x32_bf16 v[120:135], v[40:43], v[56:63], v6
    v_exp_f32 v68, v68
    v_exp_f32 v69, v69
    v_exp_f32 v70, v70
    v_exp_f32 v71, v71
    ds_read_b128 v[28:31], v2 offset:8192
    ds_read_b32 v32, v3 offset:2048
    v_smfmac_f32_32x32x32_bf16 v[120:135], v[44:47], v[64:71], v6
    v_exp_f32 v72, v72
    v_exp_f32 v73, v73
    v_exp_f32 v74, v74
    v_exp_f32 v75, v75
    v_mfma_f32_32x32x16_bf16 v[88:103], v[34:37], v[16:19], v[88:103]
    v_exp_f32 v76, v76
    v_exp_f32 v77, v77
    v_exp_f32 v78, v78
    v_exp_f32 v79, v79
    v_mfma_f32_32x32x16_bf16 v[104:119], v[34:37], v[20:23], v[104:119]
    v_exp_f32 v80, v80
    v_exp_f32 v81, v81
    v_exp_f32 v82, v82
    v_exp_f32 v83, v83
    v_smfmac_f32_32x32x32_bf16 v[136:151], v[40:43], v[72:79], v6
    v_exp_f32 v84, v84
    v_exp_f32 v85, v85
    v_exp_f32 v86, v86
    v_exp_f32 v87, v87
    s_setprio 2
    s_waitcnt lgkmcnt(0)
    v_smfmac_f32_32x32x32_bf16 v[136:151], v[44:47], v[80:87], v6
    s_mov_b64 exec, s[16:17]
    ds_read_b128 v[40:43], v4 offset:9216
    ds_read_b128 v[44:47], v4 offset:9792
    s_mov_b64 exec, -1
    v_exp_f32 v88, v88
    v_exp_f32 v89, v89
    v_exp_f32 v90, v90
    v_exp_f32 v91, v91
    v_mfma_f32_32x32x4_2b_bf16 v[56:87], v[32:33], v[24:25], 0
    v_exp_f32 v92, v92
    v_exp_f32 v93, v93
    v_exp_f32 v94, v94
    v_exp_f32 v95, v95
    v_exp_f32 v96, v96
    v_exp_f32 v97, v97
    v_exp_f32 v98, v98
    v_exp_f32 v99, v99
    v_smfmac_f32_32x32x32_bf16 v[120:135], v[48:51], v[88:95], v6
    v_exp_f32 v100, v100
    v_exp_f32 v101, v101
    v_exp_f32 v102, v102
    v_exp_f32 v103, v103
    ds_read_b128 v[34:37], v2 offset:9216
    ds_read_b32 v38, v3 offset:2304
    v_smfmac_f32_32x32x32_bf16 v[120:135], v[52:55], v[96:103], v6
    v_exp_f32 v104, v104
    v_exp_f32 v105, v105
    v_exp_f32 v106, v106
    v_exp_f32 v107, v107
    v_mfma_f32_32x32x16_bf16 v[56:71], v[28:31], v[16:19], v[56:71]
    v_exp_f32 v108, v108
    v_exp_f32 v109, v109
    v_exp_f32 v110, v110
    v_exp_f32 v111, v111
    v_mfma_f32_32x32x16_bf16 v[72:87], v[28:31], v[20:23], v[72:87]
    v_exp_f32 v112, v112
    v_exp_f32 v113, v113
    v_exp_f32 v114, v114
    v_exp_f32 v115, v115
    v_smfmac_f32_32x32x32_bf16 v[136:151], v[48:51], v[104:111], v6
    v_exp_f32 v116, v116
    v_exp_f32 v117, v117
    v_exp_f32 v118, v118
    v_exp_f32 v119, v119
    s_nop 0
    s_waitcnt lgkmcnt(0)
    v_smfmac_f32_32x32x32_bf16 v[136:151], v[52:55], v[112:119], v6
    s_mov_b64 exec, s[16:17]
    ds_read_b128 v[48:51], v4 offset:10368
    ds_read_b128 v[52:55], v4 offset:10944
    s_mov_b64 exec, -1
    v_exp_f32 v56, v56
    v_exp_f32 v57, v57
    v_exp_f32 v58, v58
    v_exp_f32 v59, v59
    v_mfma_f32_32x32x4_2b_bf16 v[88:119], v[38:39], v[24:25], 0
    v_exp_f32 v60, v60
    v_exp_f32 v61, v61
    v_exp_f32 v62, v62
    v_exp_f32 v63, v63
    v_exp_f32 v64, v64
    v_exp_f32 v65, v65
    v_exp_f32 v66, v66
    v_exp_f32 v67, v67
    v_smfmac_f32_32x32x32_bf16 v[120:135], v[40:43], v[56:63], v6
    v_exp_f32 v68, v68
    v_exp_f32 v69, v69
    v_exp_f32 v70, v70
    v_exp_f32 v71, v71
    ds_read_b128 v[28:31], v2 offset:10240
    ds_read_b32 v32, v3 offset:2560
    v_smfmac_f32_32x32x32_bf16 v[120:135], v[44:47], v[64:71], v6
    v_exp_f32 v72, v72
    v_exp_f32 v73, v73
    v_exp_f32 v74, v74
    v_exp_f32 v75, v75
    v_mfma_f32_32x32x16_bf16 v[88:103], v[34:37], v[16:19], v[88:103]
    v_exp_f32 v76, v76
    v_exp_f32 v77, v77
    v_exp_f32 v78, v78
    v_exp_f32 v79, v79
    v_mfma_f32_32x32x16_bf16 v[104:119], v[34:37], v[20:23], v[104:119]
    v_exp_f32 v80, v80
    v_exp_f32 v81, v81
    v_exp_f32 v82, v82
    v_exp_f32 v83, v83
    v_smfmac_f32_32x32x32_bf16 v[136:151], v[40:43], v[72:79], v6
    v_exp_f32 v84, v84
    v_exp_f32 v85, v85
    v_exp_f32 v86, v86
    v_exp_f32 v87, v87
    buffer_load_dword v199, v198, s[20:23], s27 offen
    s_nop 0
    s_waitcnt lgkmcnt(0)
    v_smfmac_f32_32x32x32_bf16 v[136:151], v[44:47], v[80:87], v6
    s_mov_b64 exec, s[16:17]
    ds_read_b128 v[40:43], v4 offset:11520
    ds_read_b128 v[44:47], v4 offset:12096
    s_mov_b64 exec, -1
    v_exp_f32 v88, v88
    v_exp_f32 v89, v89
    v_exp_f32 v90, v90
    v_exp_f32 v91, v91
    v_mfma_f32_32x32x4_2b_bf16 v[56:87], v[32:33], v[24:25], 0
    v_exp_f32 v92, v92
    v_exp_f32 v93, v93
    v_exp_f32 v94, v94
    v_exp_f32 v95, v95
    v_exp_f32 v96, v96
    v_exp_f32 v97, v97
    v_exp_f32 v98, v98
    v_exp_f32 v99, v99
    v_smfmac_f32_32x32x32_bf16 v[120:135], v[48:51], v[88:95], v6
    v_exp_f32 v100, v100
    v_exp_f32 v101, v101
    v_exp_f32 v102, v102
    v_exp_f32 v103, v103
    ds_read_b128 v[34:37], v2 offset:11264
    ds_read_b32 v38, v3 offset:2816
    v_smfmac_f32_32x32x32_bf16 v[120:135], v[52:55], v[96:103], v6
    v_exp_f32 v104, v104
    v_exp_f32 v105, v105
    v_exp_f32 v106, v106
    v_exp_f32 v107, v107
    v_mfma_f32_32x32x16_bf16 v[56:71], v[28:31], v[16:19], v[56:71]
    v_exp_f32 v108, v108
    v_exp_f32 v109, v109
    v_exp_f32 v110, v110
    v_exp_f32 v111, v111
    v_mfma_f32_32x32x16_bf16 v[72:87], v[28:31], v[20:23], v[72:87]
    v_exp_f32 v112, v112
    v_exp_f32 v113, v113
    v_exp_f32 v114, v114
    v_exp_f32 v115, v115
    v_smfmac_f32_32x32x32_bf16 v[136:151], v[48:51], v[104:111], v6
    v_exp_f32 v116, v116
    v_exp_f32 v117, v117
    v_exp_f32 v118, v118
    v_exp_f32 v119, v119
    s_nop 0
    s_waitcnt lgkmcnt(0)
    v_smfmac_f32_32x32x32_bf16 v[136:151], v[52:55], v[112:119], v6
    s_mov_b64 exec, s[16:17]
    ds_read_b128 v[48:51], v4 offset:12672
    ds_read_b128 v[52:55], v4 offset:13248
    s_mov_b64 exec, -1
    v_exp_f32 v56, v56
    v_exp_f32 v57, v57
    v_exp_f32 v58, v58
    v_exp_f32 v59, v59
    v_mfma_f32_32x32x4_2b_bf16 v[88:119], v[38:39], v[24:25], 0
    v_exp_f32 v60, v60
    v_exp_f32 v61, v61
    v_exp_f32 v62, v62
    v_exp_f32 v63, v63
    v_exp_f32 v64, v64
    v_exp_f32 v65, v65
    v_exp_f32 v66, v66
    v_exp_f32 v67, v67
    v_smfmac_f32_32x32x32_bf16 v[120:135], v[40:43], v[56:63], v6
    v_exp_f32 v68, v68
    v_exp_f32 v69, v69
    v_exp_f32 v70, v70
    v_exp_f32 v71, v71
    ds_read_b128 v[28:31], v2 offset:12288
    ds_read_b32 v32, v3 offset:3072
    v_smfmac_f32_32x32x32_bf16 v[120:135], v[44:47], v[64:71], v6
    v_exp_f32 v72, v72
    v_exp_f32 v73, v73
    v_exp_f32 v74, v74
    v_exp_f32 v75, v75
    v_mfma_f32_32x32x16_bf16 v[88:103], v[34:37], v[16:19], v[88:103]
    v_exp_f32 v76, v76
    v_exp_f32 v77, v77
    v_exp_f32 v78, v78
    v_exp_f32 v79, v79
    v_mfma_f32_32x32x16_bf16 v[104:119], v[34:37], v[20:23], v[104:119]
    v_exp_f32 v80, v80
    v_exp_f32 v81, v81
    v_exp_f32 v82, v82
    v_exp_f32 v83, v83
    v_smfmac_f32_32x32x32_bf16 v[136:151], v[40:43], v[72:79], v6
    v_exp_f32 v84, v84
    v_exp_f32 v85, v85
    v_exp_f32 v86, v86
    v_exp_f32 v87, v87
    s_nop 0
    s_waitcnt lgkmcnt(0)
    v_smfmac_f32_32x32x32_bf16 v[136:151], v[44:47], v[80:87], v6
    s_mov_b64 exec, s[16:17]
    ds_read_b128 v[40:43], v4 offset:13824
    ds_read_b128 v[44:47], v4 offset:14400
    s_mov_b64 exec, -1
    v_exp_f32 v88, v88
    v_exp_f32 v89, v89
    v_exp_f32 v90, v90
    v_exp_f32 v91, v91
    v_mfma_f32_32x32x4_2b_bf16 v[56:87], v[32:33], v[24:25], 0
    v_exp_f32 v92, v92
    v_exp_f32 v93, v93
    v_exp_f32 v94, v94
    v_exp_f32 v95, v95
    v_exp_f32 v96, v96
    v_exp_f32 v97, v97
    v_exp_f32 v98, v98
    v_exp_f32 v99, v99
    v_smfmac_f32_32x32x32_bf16 v[120:135], v[48:51], v[88:95], v6
    v_exp_f32 v100, v100
    v_exp_f32 v101, v101
    v_exp_f32 v102, v102
    v_exp_f32 v103, v103
    ds_read_b128 v[34:37], v2 offset:13312
    ds_read_b32 v38, v3 offset:3328
    v_smfmac_f32_32x32x32_bf16 v[120:135], v[52:55], v[96:103], v6
    v_exp_f32 v104, v104
    v_exp_f32 v105, v105
    v_exp_f32 v106, v106
    v_exp_f32 v107, v107
    v_mfma_f32_32x32x16_bf16 v[56:71], v[28:31], v[16:19], v[56:71]
    v_exp_f32 v108, v108
    v_exp_f32 v109, v109
    v_exp_f32 v110, v110
    v_exp_f32 v111, v111
    v_mfma_f32_32x32x16_bf16 v[72:87], v[28:31], v[20:23], v[72:87]
    v_exp_f32 v112, v112
    v_exp_f32 v113, v113
    v_exp_f32 v114, v114
    v_exp_f32 v115, v115
    v_smfmac_f32_32x32x32_bf16 v[136:151], v[48:51], v[104:111], v6
    v_exp_f32 v116, v116
    v_exp_f32 v117, v117
    v_exp_f32 v118, v118
    v_exp_f32 v119, v119
    s_nop 0
    s_waitcnt lgkmcnt(0)
    v_smfmac_f32_32x32x32_bf16 v[136:151], v[52:55], v[112:119], v6
    s_mov_b64 exec, s[16:17]
    ds_read_b128 v[48:51], v4 offset:14976
    ds_read_b128 v[52:55], v4 offset:15552
    s_mov_b64 exec, -1
    v_exp_f32 v56, v56
    v_exp_f32 v57, v57
    v_exp_f32 v58, v58
    v_exp_f32 v59, v59
    v_mfma_f32_32x32x4_2b_bf16 v[88:119], v[38:39], v[24:25], 0
    v_exp_f32 v60, v60
    v_exp_f32 v61, v61
    v_exp_f32 v62, v62
    v_exp_f32 v63, v63
    v_exp_f32 v64, v64
    v_exp_f32 v65, v65
    v_exp_f32 v66, v66
    v_exp_f32 v67, v67
    v_smfmac_f32_32x32x32_bf16 v[120:135], v[40:43], v[56:63], v6
    v_exp_f32 v68, v68
    v_exp_f32 v69, v69
    v_exp_f32 v70, v70
    v_exp_f32 v71, v71
    ds_read_b128 v[28:31], v2 offset:14336
    ds_read_b32 v32, v3 offset:3584
    v_smfmac_f32_32x32x32_bf16 v[120:135], v[44:47], v[64:71], v6
    v_exp_f32 v72, v72
    v_exp_f32 v73, v73
    v_exp_f32 v74, v74
    v_exp_f32 v75, v75
    v_mfma_f32_32x32x16_bf16 v[88:103], v[34:37], v[16:19], v[88:103]
    v_exp_f32 v76, v76
    v_exp_f32 v77, v77
    v_exp_f32 v78, v78
    v_exp_f32 v79, v79
    v_mfma_f32_32x32x16_bf16 v[104:119], v[34:37], v[20:23], v[104:119]
    v_exp_f32 v80, v80
    v_exp_f32 v81, v81
    v_exp_f32 v82, v82
    v_exp_f32 v83, v83
    v_smfmac_f32_32x32x32_bf16 v[136:151], v[40:43], v[72:79], v6
    v_exp_f32 v84, v84
    v_exp_f32 v85, v85
    v_exp_f32 v86, v86
    v_exp_f32 v87, v87
    s_setprio 0
    s_waitcnt lgkmcnt(0)
    v_smfmac_f32_32x32x32_bf16 v[136:151], v[44:47], v[80:87], v6
    s_mov_b64 exec, s[16:17]
    ds_read_b128 v[40:43], v4 offset:16128
    ds_read_b128 v[44:47], v4 offset:16704
    s_mov_b64 exec, -1
    v_exp_f32 v88, v88
    v_exp_f32 v89, v89
    v_exp_f32 v90, v90
    v_exp_f32 v91, v91
    v_mfma_f32_32x32x4_2b_bf16 v[56:87], v[32:33], v[24:25], 0
    v_exp_f32 v92, v92
    v_exp_f32 v93, v93
    v_exp_f32 v94, v94
    v_exp_f32 v95, v95
    v_exp_f32 v96, v96
    v_exp_f32 v97, v97
    v_exp_f32 v98, v98
    v_exp_f32 v99, v99
    v_smfmac_f32_32x32x32_bf16 v[120:135], v[48:51], v[88:95], v6
    v_exp_f32 v100, v100
    v_exp_f32 v101, v101
    v_exp_f32 v102, v102
    v_exp_f32 v103, v103
    ds_read_b128 v[34:37], v2 offset:15360
    ds_read_b32 v38, v3 offset:3840
    v_smfmac_f32_32x32x32_bf16 v[120:135], v[52:55], v[96:103], v6
    v_exp_f32 v104, v104
    v_exp_f32 v105, v105
    v_exp_f32 v106, v106
    v_exp_f32 v107, v107
    v_mfma_f32_32x32x16_bf16 v[56:71], v[28:31], v[16:19], v[56:71]
    v_exp_f32 v108, v108
    v_exp_f32 v109, v109
    v_exp_f32 v110, v110
    v_exp_f32 v111, v111
    v_mfma_f32_32x32x16_bf16 v[72:87], v[28:31], v[20:23], v[72:87]
    v_exp_f32 v112, v112
    v_exp_f32 v113, v113
    v_exp_f32 v114, v114
    v_exp_f32 v115, v115
    v_smfmac_f32_32x32x32_bf16 v[136:151], v[48:51], v[104:111], v6
    v_exp_f32 v116, v116
    v_exp_f32 v117, v117
    v_exp_f32 v118, v118
    v_exp_f32 v119, v119
    s_setprio 2
    s_waitcnt lgkmcnt(0)
    v_smfmac_f32_32x32x32_bf16 v[136:151], v[52:55], v[112:119], v6
    s_mov_b64 exec, s[16:17]
    ds_read_b128 v[48:51], v4 offset:17280
    ds_read_b128 v[52:55], v4 offset:17856
    s_mov_b64 exec, -1
    v_exp_f32 v56, v56
    v_exp_f32 v57, v57
    v_exp_f32 v58, v58
    v_exp_f32 v59, v59
    v_mfma_f32_32x32x4_2b_bf16 v[88:119], v[38:39], v[24:25], 0
    v_exp_f32 v60, v60
    v_exp_f32 v61, v61
    v_exp_f32 v62, v62
    v_exp_f32 v63, v63
    v_exp_f32 v64, v64
    v_exp_f32 v65, v65
    v_exp_f32 v66, v66
    v_exp_f32 v67, v67
    v_smfmac_f32_32x32x32_bf16 v[120:135], v[40:43], v[56:63], v6
    v_exp_f32 v68, v68
    v_exp_f32 v69, v69
    v_exp_f32 v70, v70
    v_exp_f32 v71, v71
    ds_read_b128 v[28:31], v2 offset:16384
    ds_read_b32 v32, v3 offset:4096
    v_smfmac_f32_32x32x32_bf16 v[120:135], v[44:47], v[64:71], v6
    v_exp_f32 v72, v72
    v_exp_f32 v73, v73
    v_exp_f32 v74, v74
    v_exp_f32 v75, v75
    v_mfma_f32_32x32x16_bf16 v[88:103], v[34:37], v[16:19], v[88:103]
    v_exp_f32 v76, v76
    v_exp_f32 v77, v77
    v_exp_f32 v78, v78
    v_exp_f32 v79, v79
    v_mfma_f32_32x32x16_bf16 v[104:119], v[34:37], v[20:23], v[104:119]
    v_exp_f32 v80, v80
    v_exp_f32 v81, v81
    v_exp_f32 v82, v82
    v_exp_f32 v83, v83
    v_smfmac_f32_32x32x32_bf16 v[136:151], v[40:43], v[72:79], v6
    v_exp_f32 v84, v84
    v_exp_f32 v85, v85
    v_exp_f32 v86, v86
    v_exp_f32 v87, v87
    s_nop 0
    s_waitcnt lgkmcnt(0)
    v_smfmac_f32_32x32x32_bf16 v[136:151], v[44:47], v[80:87], v6
    s_mov_b64 exec, s[16:17]
    ds_read_b128 v[40:43], v4 offset:18432
    ds_read_b128 v[44:47], v4 offset:19008
    s_mov_b64 exec, -1
    v_exp_f32 v88, v88
    v_exp_f32 v89, v89
    v_exp_f32 v90, v90
    v_exp_f32 v91, v91
    v_mfma_f32_32x32x4_2b_bf16 v[56:87], v[32:33], v[24:25], 0
    v_exp_f32 v92, v92
    v_exp_f32 v93, v93
    v_exp_f32 v94, v94
    v_exp_f32 v95, v95
    v_exp_f32 v96, v96
    v_exp_f32 v97, v97
    v_exp_f32 v98, v98
    v_exp_f32 v99, v99
    v_smfmac_f32_32x32x32_bf16 v[120:135], v[48:51], v[88:95], v6
    v_exp_f32 v100, v100
    v_exp_f32 v101, v101
    v_exp_f32 v102, v102
    v_exp_f32 v103, v103
    ds_read_b128 v[34:37], v2 offset:17408
    ds_read_b32 v38, v3 offset:4352
    v_smfmac_f32_32x32x32_bf16 v[120:135], v[52:55], v[96:103], v6
    v_exp_f32 v104, v104
    v_exp_f32 v105, v105
    v_exp_f32 v106, v106
    v_exp_f32 v107, v107
    v_mfma_f32_32x32x16_bf16 v[56:71], v[28:31], v[16:19], v[56:71]
    v_exp_f32 v108, v108
    v_exp_f32 v109, v109
    v_exp_f32 v110, v110
    v_exp_f32 v111, v111
    v_mfma_f32_32x32x16_bf16 v[72:87], v[28:31], v[20:23], v[72:87]
    v_exp_f32 v112, v112
    v_exp_f32 v113, v113
    v_exp_f32 v114, v114
    v_exp_f32 v115, v115
    v_smfmac_f32_32x32x32_bf16 v[136:151], v[48:51], v[104:111], v6
    v_exp_f32 v116, v116
    v_exp_f32 v117, v117
    v_exp_f32 v118, v118
    v_exp_f32 v119, v119
    s_nop 0
    s_waitcnt lgkmcnt(0)
    v_smfmac_f32_32x32x32_bf16 v[136:151], v[52:55], v[112:119], v6
    s_mov_b64 exec, s[16:17]
    ds_read_b128 v[48:51], v4 offset:19584
    ds_read_b128 v[52:55], v4 offset:20160
    s_mov_b64 exec, -1
    v_exp_f32 v56, v56
    v_exp_f32 v57, v57
    v_exp_f32 v58, v58
    v_exp_f32 v59, v59
    v_mfma_f32_32x32x4_2b_bf16 v[88:119], v[38:39], v[24:25], 0
    v_exp_f32 v60, v60
    v_exp_f32 v61, v61
    v_exp_f32 v62, v62
    v_exp_f32 v63, v63
    v_exp_f32 v64, v64
    v_exp_f32 v65, v65
    v_exp_f32 v66, v66
    v_exp_f32 v67, v67
    v_smfmac_f32_32x32x32_bf16 v[120:135], v[40:43], v[56:63], v6
    v_exp_f32 v68, v68
    v_exp_f32 v69, v69
    v_exp_f32 v70, v70
    v_exp_f32 v71, v71
    ds_read_b128 v[28:31], v2 offset:18432
    ds_read_b32 v32, v3 offset:4608
    v_smfmac_f32_32x32x32_bf16 v[120:135], v[44:47], v[64:71], v6
    v_exp_f32 v72, v72
    v_exp_f32 v73, v73
    v_exp_f32 v74, v74
    v_exp_f32 v75, v75
    v_mfma_f32_32x32x16_bf16 v[88:103], v[34:37], v[16:19], v[88:103]
    v_exp_f32 v76, v76
    v_exp_f32 v77, v77
    v_exp_f32 v78, v78
    v_exp_f32 v79, v79
    v_mfma_f32_32x32x16_bf16 v[104:119], v[34:37], v[20:23], v[104:119]
    v_exp_f32 v80, v80
    v_exp_f32 v81, v81
    v_exp_f32 v82, v82
    v_exp_f32 v83, v83
    v_smfmac_f32_32x32x32_bf16 v[136:151], v[40:43], v[72:79], v6
    v_exp_f32 v84, v84
    v_exp_f32 v85, v85
    v_exp_f32 v86, v86
    v_exp_f32 v87, v87
    s_nop 0
    s_waitcnt lgkmcnt(0)
    v_smfmac_f32_32x32x32_bf16 v[136:151], v[44:47], v[80:87], v6
    s_mov_b64 exec, s[16:17]
    ds_read_b128 v[40:43], v4 offset:20736
    ds_read_b128 v[44:47], v4 offset:21312
    s_mov_b64 exec, -1
    v_exp_f32 v88, v88
    v_exp_f32 v89, v89
    v_exp_f32 v90, v90
    v_exp_f32 v91, v91
    v_mfma_f32_32x32x4_2b_bf16 v[56:87], v[32:33], v[24:25], 0
    v_exp_f32 v92, v92
    v_exp_f32 v93, v93
    v_exp_f32 v94, v94
    v_exp_f32 v95, v95
    v_exp_f32 v96, v96
    v_exp_f32 v97, v97
    v_exp_f32 v98, v98
    v_exp_f32 v99, v99
    v_smfmac_f32_32x32x32_bf16 v[120:135], v[48:51], v[88:95], v6
    v_exp_f32 v100, v100
    v_exp_f32 v101, v101
    v_exp_f32 v102, v102
    v_exp_f32 v103, v103
    ds_read_b128 v[34:37], v2 offset:19456
    ds_read_b32 v38, v3 offset:4864
    v_smfmac_f32_32x32x32_bf16 v[120:135], v[52:55], v[96:103], v6
    v_exp_f32 v104, v104
    v_exp_f32 v105, v105
    v_exp_f32 v106, v106
    v_exp_f32 v107, v107
    v_mfma_f32_32x32x16_bf16 v[56:71], v[28:31], v[16:19], v[56:71]
    v_exp_f32 v108, v108
    v_exp_f32 v109, v109
    v_exp_f32 v110, v110
    v_exp_f32 v111, v111
    v_mfma_f32_32x32x16_bf16 v[72:87], v[28:31], v[20:23], v[72:87]
    v_exp_f32 v112, v112
    v_exp_f32 v113, v113
    v_exp_f32 v114, v114
    v_exp_f32 v115, v115
    v_smfmac_f32_32x32x32_bf16 v[136:151], v[48:51], v[104:111], v6
    v_exp_f32 v116, v116
    v_exp_f32 v117, v117
    v_exp_f32 v118, v118
    v_exp_f32 v119, v119
    s_nop 0
    s_waitcnt lgkmcnt(0)
    v_smfmac_f32_32x32x32_bf16 v[136:151], v[52:55], v[112:119], v6
    s_mov_b64 exec, s[16:17]
    ds_read_b128 v[48:51], v4 offset:21888
    ds_read_b128 v[52:55], v4 offset:22464
    s_mov_b64 exec, -1
    v_exp_f32 v56, v56
    v_exp_f32 v57, v57
    v_exp_f32 v58, v58
    v_exp_f32 v59, v59
    v_mfma_f32_32x32x4_2b_bf16 v[88:119], v[38:39], v[24:25], 0
    v_exp_f32 v60, v60
    v_exp_f32 v61, v61
    v_exp_f32 v62, v62
    v_exp_f32 v63, v63
    v_exp_f32 v64, v64
    v_exp_f32 v65, v65
    v_exp_f32 v66, v66
    v_exp_f32 v67, v67
    v_smfmac_f32_32x32x32_bf16 v[120:135], v[40:43], v[56:63], v6
    v_exp_f32 v68, v68
    v_exp_f32 v69, v69
    v_exp_f32 v70, v70
    v_exp_f32 v71, v71
    ds_read_b128 v[28:31], v2 offset:20480
    ds_read_b32 v32, v3 offset:5120
    v_smfmac_f32_32x32x32_bf16 v[120:135], v[44:47], v[64:71], v6
    v_exp_f32 v72, v72
    v_exp_f32 v73, v73
    v_exp_f32 v74, v74
    v_exp_f32 v75, v75
    v_mfma_f32_32x32x16_bf16 v[88:103], v[34:37], v[16:19], v[88:103]
    v_exp_f32 v76, v76
    v_exp_f32 v77, v77
    v_exp_f32 v78, v78
    v_exp_f32 v79, v79
    v_mfma_f32_32x32x16_bf16 v[104:119], v[34:37], v[20:23], v[104:119]
    v_exp_f32 v80, v80
    v_exp_f32 v81, v81
    v_exp_f32 v82, v82
    v_exp_f32 v83, v83
    v_smfmac_f32_32x32x32_bf16 v[136:151], v[40:43], v[72:79], v6
    v_exp_f32 v84, v84
    v_exp_f32 v85, v85
    v_exp_f32 v86, v86
    v_exp_f32 v87, v87
    s_nop 0
    s_waitcnt lgkmcnt(0)
    v_smfmac_f32_32x32x32_bf16 v[136:151], v[44:47], v[80:87], v6
    s_mov_b64 exec, s[16:17]
    ds_read_b128 v[40:43], v4 offset:23040
    ds_read_b128 v[44:47], v4 offset:23616
    s_mov_b64 exec, -1
    v_exp_f32 v88, v88
    v_exp_f32 v89, v89
    v_exp_f32 v90, v90
    v_exp_f32 v91, v91
    v_mfma_f32_32x32x4_2b_bf16 v[56:87], v[32:33], v[24:25], 0
    v_exp_f32 v92, v92
    v_exp_f32 v93, v93
    v_exp_f32 v94, v94
    v_exp_f32 v95, v95
    v_exp_f32 v96, v96
    v_exp_f32 v97, v97
    v_exp_f32 v98, v98
    v_exp_f32 v99, v99
    v_smfmac_f32_32x32x32_bf16 v[120:135], v[48:51], v[88:95], v6
    v_exp_f32 v100, v100
    v_exp_f32 v101, v101
    v_exp_f32 v102, v102
    v_exp_f32 v103, v103
    ds_read_b128 v[34:37], v2 offset:21504
    ds_read_b32 v38, v3 offset:5376
    v_smfmac_f32_32x32x32_bf16 v[120:135], v[52:55], v[96:103], v6
    v_exp_f32 v104, v104
    v_exp_f32 v105, v105
    v_exp_f32 v106, v106
    v_exp_f32 v107, v107
    v_mfma_f32_32x32x16_bf16 v[56:71], v[28:31], v[16:19], v[56:71]
    v_exp_f32 v108, v108
    v_exp_f32 v109, v109
    v_exp_f32 v110, v110
    v_exp_f32 v111, v111
    v_mfma_f32_32x32x16_bf16 v[72:87], v[28:31], v[20:23], v[72:87]
    v_exp_f32 v112, v112
    v_exp_f32 v113, v113
    v_exp_f32 v114, v114
    v_exp_f32 v115, v115
    v_smfmac_f32_32x32x32_bf16 v[136:151], v[48:51], v[104:111], v6
    v_exp_f32 v116, v116
    v_exp_f32 v117, v117
    v_exp_f32 v118, v118
    v_exp_f32 v119, v119
    s_setprio 0
    s_waitcnt lgkmcnt(0)
    v_smfmac_f32_32x32x32_bf16 v[136:151], v[52:55], v[112:119], v6
    s_mov_b64 exec, s[16:17]
    ds_read_b128 v[48:51], v4 offset:24192
    ds_read_b128 v[52:55], v4 offset:24768
    s_mov_b64 exec, -1
    v_exp_f32 v56, v56
    v_exp_f32 v57, v57
    v_exp_f32 v58, v58
    v_exp_f32 v59, v59
    v_mfma_f32_32x32x4_2b_bf16 v[88:119], v[38:39], v[24:25], 0
    v_exp_f32 v60, v60
    v_exp_f32 v61, v61
    v_exp_f32 v62, v62
    v_exp_f32 v63, v63
    v_exp_f32 v64, v64
    v_exp_f32 v65, v65
    v_exp_f32 v66, v66
    v_exp_f32 v67, v67
    v_smfmac_f32_32x32x32_bf16 v[120:135], v[40:43], v[56:63], v6
    v_exp_f32 v68, v68
    v_exp_f32 v69, v69
    v_exp_f32 v70, v70
    v_exp_f32 v71, v71
    ds_read_b128 v[28:31], v2 offset:22528
    ds_read_b32 v32, v3 offset:5632
    v_smfmac_f32_32x32x32_bf16 v[120:135], v[44:47], v[64:71], v6
    v_exp_f32 v72, v72
    v_exp_f32 v73, v73
    v_exp_f32 v74, v74
    v_exp_f32 v75, v75
    v_mfma_f32_32x32x16_bf16 v[88:103], v[34:37], v[16:19], v[88:103]
    v_exp_f32 v76, v76
    v_exp_f32 v77, v77
    v_exp_f32 v78, v78
    v_exp_f32 v79, v79
    v_mfma_f32_32x32x16_bf16 v[104:119], v[34:37], v[20:23], v[104:119]
    v_exp_f32 v80, v80
    v_exp_f32 v81, v81
    v_exp_f32 v82, v82
    v_exp_f32 v83, v83
    v_smfmac_f32_32x32x32_bf16 v[136:151], v[40:43], v[72:79], v6
    v_exp_f32 v84, v84
    v_exp_f32 v85, v85
    v_exp_f32 v86, v86
    v_exp_f32 v87, v87
    s_setprio 2
    s_waitcnt lgkmcnt(0)
    v_smfmac_f32_32x32x32_bf16 v[136:151], v[44:47], v[80:87], v6
    s_mov_b64 exec, s[16:17]
    ds_read_b128 v[40:43], v4 offset:25344
    ds_read_b128 v[44:47], v4 offset:25920
    s_mov_b64 exec, -1
    v_exp_f32 v88, v88
    v_exp_f32 v89, v89
    v_exp_f32 v90, v90
    v_exp_f32 v91, v91
    v_mfma_f32_32x32x4_2b_bf16 v[56:87], v[32:33], v[24:25], 0
    v_exp_f32 v92, v92
    v_exp_f32 v93, v93
    v_exp_f32 v94, v94
    v_exp_f32 v95, v95
    v_exp_f32 v96, v96
    v_exp_f32 v97, v97
    v_exp_f32 v98, v98
    v_exp_f32 v99, v99
    v_smfmac_f32_32x32x32_bf16 v[120:135], v[48:51], v[88:95], v6
    v_exp_f32 v100, v100
    v_exp_f32 v101, v101
    v_exp_f32 v102, v102
    v_exp_f32 v103, v103
    ds_read_b128 v[34:37], v2 offset:23552
    ds_read_b32 v38, v3 offset:5888
    v_smfmac_f32_32x32x32_bf16 v[120:135], v[52:55], v[96:103], v6
    v_exp_f32 v104, v104
    v_exp_f32 v105, v105
    v_exp_f32 v106, v106
    v_exp_f32 v107, v107
    v_mfma_f32_32x32x16_bf16 v[56:71], v[28:31], v[16:19], v[56:71]
    v_exp_f32 v108, v108
    v_exp_f32 v109, v109
    v_exp_f32 v110, v110
    v_exp_f32 v111, v111
    v_mfma_f32_32x32x16_bf16 v[72:87], v[28:31], v[20:23], v[72:87]
    v_exp_f32 v112, v112
    v_exp_f32 v113, v113
    v_exp_f32 v114, v114
    v_exp_f32 v115, v115
    v_smfmac_f32_32x32x32_bf16 v[136:151], v[48:51], v[104:111], v6
    v_exp_f32 v116, v116
    v_exp_f32 v117, v117
    v_exp_f32 v118, v118
    v_exp_f32 v119, v119
    s_nop 0
    s_waitcnt lgkmcnt(0)
    v_smfmac_f32_32x32x32_bf16 v[136:151], v[52:55], v[112:119], v6
    s_mov_b64 exec, s[16:17]
    ds_read_b128 v[48:51], v4 offset:26496
    ds_read_b128 v[52:55], v4 offset:27072
    s_mov_b64 exec, -1
    v_exp_f32 v56, v56
    v_exp_f32 v57, v57
    v_exp_f32 v58, v58
    v_exp_f32 v59, v59
    v_mfma_f32_32x32x4_2b_bf16 v[88:119], v[38:39], v[24:25], 0
    v_exp_f32 v60, v60
    v_exp_f32 v61, v61
    v_exp_f32 v62, v62
    v_exp_f32 v63, v63
    v_exp_f32 v64, v64
    v_exp_f32 v65, v65
    v_exp_f32 v66, v66
    v_exp_f32 v67, v67
    v_smfmac_f32_32x32x32_bf16 v[120:135], v[40:43], v[56:63], v6
    v_exp_f32 v68, v68
    v_exp_f32 v69, v69
    v_exp_f32 v70, v70
    v_exp_f32 v71, v71
    ds_read_b128 v[28:31], v2 offset:24576
    ds_read_b32 v32, v3 offset:6144
    v_smfmac_f32_32x32x32_bf16 v[120:135], v[44:47], v[64:71], v6
    v_exp_f32 v72, v72
    v_exp_f32 v73, v73
    v_exp_f32 v74, v74
    v_exp_f32 v75, v75
    v_mfma_f32_32x32x16_bf16 v[88:103], v[34:37], v[16:19], v[88:103]
    v_exp_f32 v76, v76
    v_exp_f32 v77, v77
    v_exp_f32 v78, v78
    v_exp_f32 v79, v79
    v_mfma_f32_32x32x16_bf16 v[104:119], v[34:37], v[20:23], v[104:119]
    v_exp_f32 v80, v80
    v_exp_f32 v81, v81
    v_exp_f32 v82, v82
    v_exp_f32 v83, v83
    v_smfmac_f32_32x32x32_bf16 v[136:151], v[40:43], v[72:79], v6
    v_exp_f32 v84, v84
    v_exp_f32 v85, v85
    v_exp_f32 v86, v86
    v_exp_f32 v87, v87
    s_nop 0
    s_waitcnt lgkmcnt(0)
    v_smfmac_f32_32x32x32_bf16 v[136:151], v[44:47], v[80:87], v6
    s_mov_b64 exec, s[16:17]
    ds_read_b128 v[40:43], v4 offset:27648
    ds_read_b128 v[44:47], v4 offset:28224
    s_mov_b64 exec, -1
    v_exp_f32 v88, v88
    v_exp_f32 v89, v89
    v_exp_f32 v90, v90
    v_exp_f32 v91, v91
    v_mfma_f32_32x32x4_2b_bf16 v[56:87], v[32:33], v[24:25], 0
    v_exp_f32 v92, v92
    v_exp_f32 v93, v93
    v_exp_f32 v94, v94
    v_exp_f32 v95, v95
    v_exp_f32 v96, v96
    v_exp_f32 v97, v97
    v_exp_f32 v98, v98
    v_exp_f32 v99, v99
    v_smfmac_f32_32x32x32_bf16 v[120:135], v[48:51], v[88:95], v6
    v_exp_f32 v100, v100
    v_exp_f32 v101, v101
    v_exp_f32 v102, v102
    v_exp_f32 v103, v103
    ds_read_b128 v[34:37], v2 offset:25600
    ds_read_b32 v38, v3 offset:6400
    v_smfmac_f32_32x32x32_bf16 v[120:135], v[52:55], v[96:103], v6
    v_exp_f32 v104, v104
    v_exp_f32 v105, v105
    v_exp_f32 v106, v106
    v_exp_f32 v107, v107
    v_mfma_f32_32x32x16_bf16 v[56:71], v[28:31], v[16:19], v[56:71]
    v_exp_f32 v108, v108
    v_exp_f32 v109, v109
    v_exp_f32 v110, v110
    v_exp_f32 v111, v111
    v_mfma_f32_32x32x16_bf16 v[72:87], v[28:31], v[20:23], v[72:87]
    v_exp_f32 v112, v112
    v_exp_f32 v113, v113
    v_exp_f32 v114, v114
    v_exp_f32 v115, v115
    v_smfmac_f32_32x32x32_bf16 v[136:151], v[48:51], v[104:111], v6
    v_exp_f32 v116, v116
    v_exp_f32 v117, v117
    v_exp_f32 v118, v118
    v_exp_f32 v119, v119
    s_nop 0
    s_waitcnt lgkmcnt(0)
    v_smfmac_f32_32x32x32_bf16 v[136:151], v[52:55], v[112:119], v6
    s_mov_b64 exec, s[16:17]
    ds_read_b128 v[48:51], v4 offset:28800
    ds_read_b128 v[52:55], v4 offset:29376
    s_mov_b64 exec, -1
    v_exp_f32 v56, v56
    v_exp_f32 v57, v57
    v_exp_f32 v58, v58
    v_exp_f32 v59, v59
    v_mfma_f32_32x32x4_2b_bf16 v[88:119], v[38:39], v[24:25], 0
    v_exp_f32 v60, v60
    v_exp_f32 v61, v61
    v_exp_f32 v62, v62
    v_exp_f32 v63, v63
    v_exp_f32 v64, v64
    v_exp_f32 v65, v65
    v_exp_f32 v66, v66
    v_exp_f32 v67, v67
    v_smfmac_f32_32x32x32_bf16 v[120:135], v[40:43], v[56:63], v6
    v_exp_f32 v68, v68
    v_exp_f32 v69, v69
    v_exp_f32 v70, v70
    v_exp_f32 v71, v71
    ds_read_b128 v[28:31], v2 offset:26624
    ds_read_b32 v32, v3 offset:6656
    v_smfmac_f32_32x32x32_bf16 v[120:135], v[44:47], v[64:71], v6
    v_exp_f32 v72, v72
    v_exp_f32 v73, v73
    v_exp_f32 v74, v74
    v_exp_f32 v75, v75
    v_mfma_f32_32x32x16_bf16 v[88:103], v[34:37], v[16:19], v[88:103]
    v_exp_f32 v76, v76
    v_exp_f32 v77, v77
    v_exp_f32 v78, v78
    v_exp_f32 v79, v79
    v_mfma_f32_32x32x16_bf16 v[104:119], v[34:37], v[20:23], v[104:119]
    v_exp_f32 v80, v80
    v_exp_f32 v81, v81
    v_exp_f32 v82, v82
    v_exp_f32 v83, v83
    v_smfmac_f32_32x32x32_bf16 v[136:151], v[40:43], v[72:79], v6
    v_exp_f32 v84, v84
    v_exp_f32 v85, v85
    v_exp_f32 v86, v86
    v_exp_f32 v87, v87
    s_nop 0
    s_waitcnt lgkmcnt(0)
    v_smfmac_f32_32x32x32_bf16 v[136:151], v[44:47], v[80:87], v6
    s_mov_b64 exec, s[16:17]
    ds_read_b128 v[40:43], v4 offset:29952
    ds_read_b128 v[44:47], v4 offset:30528
    s_mov_b64 exec, -1
    v_exp_f32 v88, v88
    v_exp_f32 v89, v89
    v_exp_f32 v90, v90
    v_exp_f32 v91, v91
    v_mfma_f32_32x32x4_2b_bf16 v[56:87], v[32:33], v[24:25], 0
    v_exp_f32 v92, v92
    v_exp_f32 v93, v93
    v_exp_f32 v94, v94
    v_exp_f32 v95, v95
    v_exp_f32 v96, v96
    v_exp_f32 v97, v97
    v_exp_f32 v98, v98
    v_exp_f32 v99, v99
    v_smfmac_f32_32x32x32_bf16 v[120:135], v[48:51], v[88:95], v6
    v_exp_f32 v100, v100
    v_exp_f32 v101, v101
    v_exp_f32 v102, v102
    v_exp_f32 v103, v103
    ds_read_b128 v[34:37], v2 offset:27648
    ds_read_b32 v38, v3 offset:6912
    v_smfmac_f32_32x32x32_bf16 v[120:135], v[52:55], v[96:103], v6
    v_exp_f32 v104, v104
    v_exp_f32 v105, v105
    v_exp_f32 v106, v106
    v_exp_f32 v107, v107
    v_mfma_f32_32x32x16_bf16 v[56:71], v[28:31], v[16:19], v[56:71]
    v_exp_f32 v108, v108
    v_exp_f32 v109, v109
    v_exp_f32 v110, v110
    v_exp_f32 v111, v111
    v_mfma_f32_32x32x16_bf16 v[72:87], v[28:31], v[20:23], v[72:87]
    v_exp_f32 v112, v112
    v_exp_f32 v113, v113
    v_exp_f32 v114, v114
    v_exp_f32 v115, v115
    v_smfmac_f32_32x32x32_bf16 v[136:151], v[48:51], v[104:111], v6
    v_exp_f32 v116, v116
    v_exp_f32 v117, v117
    v_exp_f32 v118, v118
    v_exp_f32 v119, v119
    s_waitcnt vmcnt(0)
    s_barrier
    s_nop 0
    s_waitcnt lgkmcnt(0)
    v_smfmac_f32_32x32x32_bf16 v[136:151], v[52:55], v[112:119], v6
    s_mov_b64 exec, s[16:17]
    ds_read_b128 v[48:51], v4 offset:31104
    ds_read_b128 v[52:55], v4 offset:31680
    s_mov_b64 exec, -1
    v_exp_f32 v56, v56
    v_exp_f32 v57, v57
    v_exp_f32 v58, v58
    v_exp_f32 v59, v59
    v_mfma_f32_32x32x4_2b_bf16 v[88:119], v[38:39], v[24:25], 0
    v_exp_f32 v60, v60
    v_exp_f32 v61, v61
    v_exp_f32 v62, v62
    v_exp_f32 v63, v63
    v_exp_f32 v64, v64
    v_exp_f32 v65, v65
    v_exp_f32 v66, v66
    v_exp_f32 v67, v67
    v_smfmac_f32_32x32x32_bf16 v[120:135], v[40:43], v[56:63], v6
    v_exp_f32 v68, v68
    v_exp_f32 v69, v69
    v_exp_f32 v70, v70
    v_exp_f32 v71, v71
    ds_read_b128 v[28:31], v2 offset:28672
    ds_read_b32 v32, v3 offset:7168
    v_smfmac_f32_32x32x32_bf16 v[120:135], v[44:47], v[64:71], v6
    v_exp_f32 v72, v72
    v_exp_f32 v73, v73
    v_exp_f32 v74, v74
    v_exp_f32 v75, v75
    v_mfma_f32_32x32x16_bf16 v[88:103], v[34:37], v[16:19], v[88:103]
    v_exp_f32 v76, v76
    v_exp_f32 v77, v77
    v_exp_f32 v78, v78
    v_exp_f32 v79, v79
    v_mfma_f32_32x32x16_bf16 v[104:119], v[34:37], v[20:23], v[104:119]
    v_exp_f32 v80, v80
    v_exp_f32 v81, v81
    v_exp_f32 v82, v82
    v_exp_f32 v83, v83
    v_smfmac_f32_32x32x32_bf16 v[136:151], v[40:43], v[72:79], v6
    v_exp_f32 v84, v84
    v_exp_f32 v85, v85
    v_exp_f32 v86, v86
    v_exp_f32 v87, v87
    s_setprio 0
    s_waitcnt lgkmcnt(0)
    v_smfmac_f32_32x32x32_bf16 v[136:151], v[44:47], v[80:87], v6
    s_mov_b64 exec, s[16:17]
    ds_read_b128 v[40:43], v4 offset:32256
    ds_read_b128 v[44:47], v4 offset:32832
    s_mov_b64 exec, -1
    v_exp_f32 v88, v88
    v_exp_f32 v89, v89
    v_exp_f32 v90, v90
    v_exp_f32 v91, v91
    v_mfma_f32_32x32x4_2b_bf16 v[56:87], v[32:33], v[24:25], 0
    v_exp_f32 v92, v92
    v_exp_f32 v93, v93
    v_exp_f32 v94, v94
    v_exp_f32 v95, v95
    v_exp_f32 v96, v96
    v_exp_f32 v97, v97
    v_exp_f32 v98, v98
    v_exp_f32 v99, v99
    v_smfmac_f32_32x32x32_bf16 v[120:135], v[48:51], v[88:95], v6
    v_exp_f32 v100, v100
    v_exp_f32 v101, v101
    v_exp_f32 v102, v102
    v_exp_f32 v103, v103
    ds_read_b128 v[34:37], v2 offset:29696
    ds_read_b32 v38, v3 offset:7424
    v_smfmac_f32_32x32x32_bf16 v[120:135], v[52:55], v[96:103], v6
    v_exp_f32 v104, v104
    v_exp_f32 v105, v105
    v_exp_f32 v106, v106
    v_exp_f32 v107, v107
    v_mfma_f32_32x32x16_bf16 v[56:71], v[28:31], v[16:19], v[56:71]
    v_exp_f32 v108, v108
    v_exp_f32 v109, v109
    v_exp_f32 v110, v110
    v_exp_f32 v111, v111
    v_mfma_f32_32x32x16_bf16 v[72:87], v[28:31], v[20:23], v[72:87]
    v_exp_f32 v112, v112
    v_exp_f32 v113, v113
    v_exp_f32 v114, v114
    v_exp_f32 v115, v115
    v_smfmac_f32_32x32x32_bf16 v[136:151], v[48:51], v[104:111], v6
    v_exp_f32 v116, v116
    v_exp_f32 v117, v117
    v_exp_f32 v118, v118
    v_exp_f32 v119, v119
    s_setprio 2
    s_waitcnt lgkmcnt(0)
    v_smfmac_f32_32x32x32_bf16 v[136:151], v[52:55], v[112:119], v6
    s_mov_b64 exec, s[16:17]
    ds_read_b128 v[48:51], v4 offset:33408
    ds_read_b128 v[52:55], v4 offset:33984
    s_mov_b64 exec, -1
    v_exp_f32 v56, v56
    v_exp_f32 v57, v57
    v_exp_f32 v58, v58
    v_exp_f32 v59, v59
    v_mfma_f32_32x32x4_2b_bf16 v[88:119], v[38:39], v[24:25], 0
    v_exp_f32 v60, v60
    v_exp_f32 v61, v61
    v_exp_f32 v62, v62
    v_exp_f32 v63, v63
    v_exp_f32 v64, v64
    v_exp_f32 v65, v65
    v_exp_f32 v66, v66
    v_exp_f32 v67, v67
    v_smfmac_f32_32x32x32_bf16 v[120:135], v[40:43], v[56:63], v6
    v_exp_f32 v68, v68
    v_exp_f32 v69, v69
    v_exp_f32 v70, v70
    v_exp_f32 v71, v71
    ds_read_b128 v[28:31], v2 offset:30720
    ds_read_b32 v32, v3 offset:7680
    v_smfmac_f32_32x32x32_bf16 v[120:135], v[44:47], v[64:71], v6
    v_exp_f32 v72, v72
    v_exp_f32 v73, v73
    v_exp_f32 v74, v74
    v_exp_f32 v75, v75
    v_mfma_f32_32x32x16_bf16 v[88:103], v[34:37], v[16:19], v[88:103]
    v_exp_f32 v76, v76
    v_exp_f32 v77, v77
    v_exp_f32 v78, v78
    v_exp_f32 v79, v79
    v_mfma_f32_32x32x16_bf16 v[104:119], v[34:37], v[20:23], v[104:119]
    v_exp_f32 v80, v80
    v_exp_f32 v81, v81
    v_exp_f32 v82, v82
    v_exp_f32 v83, v83
    v_smfmac_f32_32x32x32_bf16 v[136:151], v[40:43], v[72:79], v6
    v_exp_f32 v84, v84
    v_exp_f32 v85, v85
    v_exp_f32 v86, v86
    v_exp_f32 v87, v87
    s_nop 0
    s_waitcnt lgkmcnt(0)
    v_smfmac_f32_32x32x32_bf16 v[136:151], v[44:47], v[80:87], v6
    s_mov_b64 exec, s[16:17]
    ds_read_b128 v[40:43], v4 offset:34560
    ds_read_b128 v[44:47], v4 offset:35136
    s_mov_b64 exec, -1
    v_exp_f32 v88, v88
    v_exp_f32 v89, v89
    v_exp_f32 v90, v90
    v_exp_f32 v91, v91
    v_mfma_f32_32x32x4_2b_bf16 v[56:87], v[32:33], v[24:25], 0
    v_exp_f32 v92, v92
    v_exp_f32 v93, v93
    v_exp_f32 v94, v94
    v_exp_f32 v95, v95
    v_exp_f32 v96, v96
    v_exp_f32 v97, v97
    v_exp_f32 v98, v98
    v_exp_f32 v99, v99
    v_smfmac_f32_32x32x32_bf16 v[120:135], v[48:51], v[88:95], v6
    v_exp_f32 v100, v100
    v_exp_f32 v101, v101
    v_exp_f32 v102, v102
    v_exp_f32 v103, v103
    ds_read_b128 v[34:37], v2 offset:31744
    ds_read_b32 v38, v3 offset:7936
    v_smfmac_f32_32x32x32_bf16 v[120:135], v[52:55], v[96:103], v6
    v_exp_f32 v104, v104
    v_exp_f32 v105, v105
    v_exp_f32 v106, v106
    v_exp_f32 v107, v107
    v_mfma_f32_32x32x16_bf16 v[56:71], v[28:31], v[16:19], v[56:71]
    v_exp_f32 v108, v108
    v_exp_f32 v109, v109
    v_exp_f32 v110, v110
    v_exp_f32 v111, v111
    v_mfma_f32_32x32x16_bf16 v[72:87], v[28:31], v[20:23], v[72:87]
    v_exp_f32 v112, v112
    v_exp_f32 v113, v113
    v_exp_f32 v114, v114
    v_exp_f32 v115, v115
    v_smfmac_f32_32x32x32_bf16 v[136:151], v[48:51], v[104:111], v6
    v_exp_f32 v116, v116
    v_exp_f32 v117, v117
    v_exp_f32 v118, v118
    v_exp_f32 v119, v119
    s_nop 0
    s_waitcnt lgkmcnt(0)
    v_smfmac_f32_32x32x32_bf16 v[136:151], v[52:55], v[112:119], v6
    s_mov_b64 exec, s[16:17]
    ds_read_b128 v[48:51], v4 offset:35712
    ds_read_b128 v[52:55], v4 offset:36288
    s_mov_b64 exec, -1
    v_exp_f32 v56, v56
    v_exp_f32 v57, v57
    v_exp_f32 v58, v58
    v_exp_f32 v59, v59
    v_mfma_f32_32x32x4_2b_bf16 v[88:119], v[38:39], v[24:25], 0
    v_exp_f32 v60, v60
    v_exp_f32 v61, v61
    v_exp_f32 v62, v62
    v_exp_f32 v63, v63
    v_exp_f32 v64, v64
    v_exp_f32 v65, v65
    v_exp_f32 v66, v66
    v_exp_f32 v67, v67
    v_smfmac_f32_32x32x32_bf16 v[120:135], v[40:43], v[56:63], v6
    v_exp_f32 v68, v68
    v_exp_f32 v69, v69
    v_exp_f32 v70, v70
    v_exp_f32 v71, v71
    ds_read_b128 v[28:31], v2 offset:32768
    ds_read_b32 v32, v3 offset:8192
    v_smfmac_f32_32x32x32_bf16 v[120:135], v[44:47], v[64:71], v6
    v_exp_f32 v72, v72
    v_exp_f32 v73, v73
    v_exp_f32 v74, v74
    v_exp_f32 v75, v75
    v_mfma_f32_32x32x16_bf16 v[88:103], v[34:37], v[16:19], v[88:103]
    v_exp_f32 v76, v76
    v_exp_f32 v77, v77
    v_exp_f32 v78, v78
    v_exp_f32 v79, v79
    v_mfma_f32_32x32x16_bf16 v[104:119], v[34:37], v[20:23], v[104:119]
    v_exp_f32 v80, v80
    v_exp_f32 v81, v81
    v_exp_f32 v82, v82
    v_exp_f32 v83, v83
    v_smfmac_f32_32x32x32_bf16 v[136:151], v[40:43], v[72:79], v6
    v_exp_f32 v84, v84
    v_exp_f32 v85, v85
    v_exp_f32 v86, v86
    v_exp_f32 v87, v87
    s_nop 0
    s_waitcnt lgkmcnt(0)
    v_smfmac_f32_32x32x32_bf16 v[136:151], v[44:47], v[80:87], v6
    s_mov_b64 exec, s[16:17]
    ds_read_b128 v[40:43], v5 offset:0
    ds_read_b128 v[44:47], v5 offset:576
    s_mov_b64 exec, -1
    v_exp_f32 v88, v88
    v_exp_f32 v89, v89
    v_exp_f32 v90, v90
    v_exp_f32 v91, v91
    v_mfma_f32_32x32x4_2b_bf16 v[56:87], v[32:33], v[24:25], 0
    v_exp_f32 v92, v92
    v_exp_f32 v93, v93
    v_exp_f32 v94, v94
    v_exp_f32 v95, v95
    v_exp_f32 v96, v96
    v_exp_f32 v97, v97
    v_exp_f32 v98, v98
    v_exp_f32 v99, v99
    v_smfmac_f32_32x32x32_bf16 v[120:135], v[48:51], v[88:95], v6
    v_exp_f32 v100, v100
    v_exp_f32 v101, v101
    v_exp_f32 v102, v102
    v_exp_f32 v103, v103
    ds_read_b128 v[34:37], v2 offset:33792
    ds_read_b32 v38, v3 offset:8448
    v_smfmac_f32_32x32x32_bf16 v[120:135], v[52:55], v[96:103], v6
    v_exp_f32 v104, v104
    v_exp_f32 v105, v105
    v_exp_f32 v106, v106
    v_exp_f32 v107, v107
    v_mfma_f32_32x32x16_bf16 v[56:71], v[28:31], v[16:19], v[56:71]
    v_exp_f32 v108, v108
    v_exp_f32 v109, v109
    v_exp_f32 v110, v110
    v_exp_f32 v111, v111
    v_mfma_f32_32x32x16_bf16 v[72:87], v[28:31], v[20:23], v[72:87]
    v_exp_f32 v112, v112
    v_exp_f32 v113, v113
    v_exp_f32 v114, v114
    v_exp_f32 v115, v115
    v_smfmac_f32_32x32x32_bf16 v[136:151], v[48:51], v[104:111], v6
    v_exp_f32 v116, v116
    v_exp_f32 v117, v117
    v_exp_f32 v118, v118
    v_exp_f32 v119, v119
    s_nop 0
    s_waitcnt lgkmcnt(0)
    v_smfmac_f32_32x32x32_bf16 v[136:151], v[52:55], v[112:119], v6
    s_mov_b64 exec, s[16:17]
    ds_read_b128 v[48:51], v5 offset:1152
    ds_read_b128 v[52:55], v5 offset:1728
    s_mov_b64 exec, -1
    v_exp_f32 v56, v56
    v_exp_f32 v57, v57
    v_exp_f32 v58, v58
    v_exp_f32 v59, v59
    v_mfma_f32_32x32x4_2b_bf16 v[88:119], v[38:39], v[24:25], 0
    v_exp_f32 v60, v60
    v_exp_f32 v61, v61
    v_exp_f32 v62, v62
    v_exp_f32 v63, v63
    v_exp_f32 v64, v64
    v_exp_f32 v65, v65
    v_exp_f32 v66, v66
    v_exp_f32 v67, v67
    v_smfmac_f32_32x32x32_bf16 v[120:135], v[40:43], v[56:63], v6
    v_exp_f32 v68, v68
    v_exp_f32 v69, v69
    v_exp_f32 v70, v70
    v_exp_f32 v71, v71
    ds_read_b128 v[28:31], v2 offset:34816
    ds_read_b32 v32, v3 offset:8704
    v_smfmac_f32_32x32x32_bf16 v[120:135], v[44:47], v[64:71], v6
    v_exp_f32 v72, v72
    v_exp_f32 v73, v73
    v_exp_f32 v74, v74
    v_exp_f32 v75, v75
    v_mfma_f32_32x32x16_bf16 v[88:103], v[34:37], v[16:19], v[88:103]
    v_exp_f32 v76, v76
    v_exp_f32 v77, v77
    v_exp_f32 v78, v78
    v_exp_f32 v79, v79
    v_mfma_f32_32x32x16_bf16 v[104:119], v[34:37], v[20:23], v[104:119]
    v_exp_f32 v80, v80
    v_exp_f32 v81, v81
    v_exp_f32 v82, v82
    v_exp_f32 v83, v83
    v_smfmac_f32_32x32x32_bf16 v[136:151], v[40:43], v[72:79], v6
    v_exp_f32 v84, v84
    v_exp_f32 v85, v85
    v_exp_f32 v86, v86
    v_exp_f32 v87, v87
    s_nop 0
    s_waitcnt lgkmcnt(0)
    v_smfmac_f32_32x32x32_bf16 v[136:151], v[44:47], v[80:87], v6
    s_mov_b64 exec, s[16:17]
    ds_read_b128 v[40:43], v5 offset:2304
    ds_read_b128 v[44:47], v5 offset:2880
    s_mov_b64 exec, -1
    v_exp_f32 v88, v88
    v_exp_f32 v89, v89
    v_exp_f32 v90, v90
    v_exp_f32 v91, v91
    v_mfma_f32_32x32x4_2b_bf16 v[56:87], v[32:33], v[24:25], 0
    v_exp_f32 v92, v92
    v_exp_f32 v93, v93
    v_exp_f32 v94, v94
    v_exp_f32 v95, v95
    v_exp_f32 v96, v96
    v_exp_f32 v97, v97
    v_exp_f32 v98, v98
    v_exp_f32 v99, v99
    v_smfmac_f32_32x32x32_bf16 v[120:135], v[48:51], v[88:95], v6
    v_exp_f32 v100, v100
    v_exp_f32 v101, v101
    v_exp_f32 v102, v102
    v_exp_f32 v103, v103
    ds_read_b128 v[34:37], v2 offset:35840
    ds_read_b32 v38, v3 offset:8960
    v_smfmac_f32_32x32x32_bf16 v[120:135], v[52:55], v[96:103], v6
    v_exp_f32 v104, v104
    v_exp_f32 v105, v105
    v_exp_f32 v106, v106
    v_exp_f32 v107, v107
    v_mfma_f32_32x32x16_bf16 v[56:71], v[28:31], v[16:19], v[56:71]
    v_exp_f32 v108, v108
    v_exp_f32 v109, v109
    v_exp_f32 v110, v110
    v_exp_f32 v111, v111
    v_mfma_f32_32x32x16_bf16 v[72:87], v[28:31], v[20:23], v[72:87]
    v_exp_f32 v112, v112
    v_exp_f32 v113, v113
    v_exp_f32 v114, v114
    v_exp_f32 v115, v115
    v_smfmac_f32_32x32x32_bf16 v[136:151], v[48:51], v[104:111], v6
    v_exp_f32 v116, v116
    v_exp_f32 v117, v117
    v_exp_f32 v118, v118
    v_exp_f32 v119, v119
    s_setprio 0
    s_waitcnt lgkmcnt(0)
    v_smfmac_f32_32x32x32_bf16 v[136:151], v[52:55], v[112:119], v6
    s_mov_b64 exec, s[16:17]
    ds_read_b128 v[48:51], v5 offset:3456
    ds_read_b128 v[52:55], v5 offset:4032
    s_mov_b64 exec, -1
    v_exp_f32 v56, v56
    v_exp_f32 v57, v57
    v_exp_f32 v58, v58
    v_exp_f32 v59, v59
    v_mfma_f32_32x32x4_2b_bf16 v[88:119], v[38:39], v[24:25], 0
    v_exp_f32 v60, v60
    v_exp_f32 v61, v61
    v_exp_f32 v62, v62
    v_exp_f32 v63, v63
    v_exp_f32 v64, v64
    v_exp_f32 v65, v65
    v_exp_f32 v66, v66
    v_exp_f32 v67, v67
    v_smfmac_f32_32x32x32_bf16 v[120:135], v[40:43], v[56:63], v6
    v_exp_f32 v68, v68
    v_exp_f32 v69, v69
    v_exp_f32 v70, v70
    v_exp_f32 v71, v71
    ds_read_b128 v[28:31], v2 offset:36864
    ds_read_b32 v32, v3 offset:9216
    v_smfmac_f32_32x32x32_bf16 v[120:135], v[44:47], v[64:71], v6
    v_exp_f32 v72, v72
    v_exp_f32 v73, v73
    v_exp_f32 v74, v74
    v_exp_f32 v75, v75
    v_mfma_f32_32x32x16_bf16 v[88:103], v[34:37], v[16:19], v[88:103]
    v_exp_f32 v76, v76
    v_exp_f32 v77, v77
    v_exp_f32 v78, v78
    v_exp_f32 v79, v79
    v_mfma_f32_32x32x16_bf16 v[104:119], v[34:37], v[20:23], v[104:119]
    v_exp_f32 v80, v80
    v_exp_f32 v81, v81
    v_exp_f32 v82, v82
    v_exp_f32 v83, v83
    v_smfmac_f32_32x32x32_bf16 v[136:151], v[40:43], v[72:79], v6
    v_exp_f32 v84, v84
    v_exp_f32 v85, v85
    v_exp_f32 v86, v86
    v_exp_f32 v87, v87
    s_setprio 2
    s_waitcnt lgkmcnt(0)
    v_smfmac_f32_32x32x32_bf16 v[136:151], v[44:47], v[80:87], v6
    s_mov_b64 exec, s[16:17]
    ds_read_b128 v[40:43], v5 offset:4608
    ds_read_b128 v[44:47], v5 offset:5184
    s_mov_b64 exec, -1
    v_exp_f32 v88, v88
    v_exp_f32 v89, v89
    v_exp_f32 v90, v90
    v_exp_f32 v91, v91
    v_mfma_f32_32x32x4_2b_bf16 v[56:87], v[32:33], v[24:25], 0
    v_exp_f32 v92, v92
    v_exp_f32 v93, v93
    v_exp_f32 v94, v94
    v_exp_f32 v95, v95
    v_exp_f32 v96, v96
    v_exp_f32 v97, v97
    v_exp_f32 v98, v98
    v_exp_f32 v99, v99
    v_smfmac_f32_32x32x32_bf16 v[120:135], v[48:51], v[88:95], v6
    v_exp_f32 v100, v100
    v_exp_f32 v101, v101
    v_exp_f32 v102, v102
    v_exp_f32 v103, v103
    ds_read_b128 v[34:37], v2 offset:37888
    ds_read_b32 v38, v3 offset:9472
    v_smfmac_f32_32x32x32_bf16 v[120:135], v[52:55], v[96:103], v6
    v_exp_f32 v104, v104
    v_exp_f32 v105, v105
    v_exp_f32 v106, v106
    v_exp_f32 v107, v107
    v_mfma_f32_32x32x16_bf16 v[56:71], v[28:31], v[16:19], v[56:71]
    v_exp_f32 v108, v108
    v_exp_f32 v109, v109
    v_exp_f32 v110, v110
    v_exp_f32 v111, v111
    v_mfma_f32_32x32x16_bf16 v[72:87], v[28:31], v[20:23], v[72:87]
    v_exp_f32 v112, v112
    v_exp_f32 v113, v113
    v_exp_f32 v114, v114
    v_exp_f32 v115, v115
    v_smfmac_f32_32x32x32_bf16 v[136:151], v[48:51], v[104:111], v6
    v_exp_f32 v116, v116
    v_exp_f32 v117, v117
    v_exp_f32 v118, v118
    v_exp_f32 v119, v119
    s_nop 0
    s_waitcnt lgkmcnt(0)
    v_smfmac_f32_32x32x32_bf16 v[136:151], v[52:55], v[112:119], v6
    s_mov_b64 exec, s[16:17]
    ds_read_b128 v[48:51], v5 offset:5760
    ds_read_b128 v[52:55], v5 offset:6336
    s_mov_b64 exec, -1
    v_exp_f32 v56, v56
    v_exp_f32 v57, v57
    v_exp_f32 v58, v58
    v_exp_f32 v59, v59
    v_mfma_f32_32x32x4_2b_bf16 v[88:119], v[38:39], v[24:25], 0
    v_exp_f32 v60, v60
    v_exp_f32 v61, v61
    v_exp_f32 v62, v62
    v_exp_f32 v63, v63
    v_exp_f32 v64, v64
    v_exp_f32 v65, v65
    v_exp_f32 v66, v66
    v_exp_f32 v67, v67
    v_smfmac_f32_32x32x32_bf16 v[120:135], v[40:43], v[56:63], v6
    v_exp_f32 v68, v68
    v_exp_f32 v69, v69
    v_exp_f32 v70, v70
    v_exp_f32 v71, v71
    ds_read_b128 v[28:31], v2 offset:38912
    ds_read_b32 v32, v3 offset:9728
    v_smfmac_f32_32x32x32_bf16 v[120:135], v[44:47], v[64:71], v6
    v_exp_f32 v72, v72
    v_exp_f32 v73, v73
    v_exp_f32 v74, v74
    v_exp_f32 v75, v75
    v_mfma_f32_32x32x16_bf16 v[88:103], v[34:37], v[16:19], v[88:103]
    v_exp_f32 v76, v76
    v_exp_f32 v77, v77
    v_exp_f32 v78, v78
    v_exp_f32 v79, v79
    v_mfma_f32_32x32x16_bf16 v[104:119], v[34:37], v[20:23], v[104:119]
    v_exp_f32 v80, v80
    v_exp_f32 v81, v81
    v_exp_f32 v82, v82
    v_exp_f32 v83, v83
    v_smfmac_f32_32x32x32_bf16 v[136:151], v[40:43], v[72:79], v6
    v_exp_f32 v84, v84
    v_exp_f32 v85, v85
    v_exp_f32 v86, v86
    v_exp_f32 v87, v87
    s_nop 0
    s_waitcnt lgkmcnt(0)
    v_smfmac_f32_32x32x32_bf16 v[136:151], v[44:47], v[80:87], v6
    s_mov_b64 exec, s[16:17]
    ds_read_b128 v[40:43], v5 offset:6912
    ds_read_b128 v[44:47], v5 offset:7488
    s_mov_b64 exec, -1
    v_exp_f32 v88, v88
    v_exp_f32 v89, v89
    v_exp_f32 v90, v90
    v_exp_f32 v91, v91
    v_mfma_f32_32x32x4_2b_bf16 v[56:87], v[32:33], v[24:25], 0
    v_exp_f32 v92, v92
    v_exp_f32 v93, v93
    v_exp_f32 v94, v94
    v_exp_f32 v95, v95
    v_exp_f32 v96, v96
    v_exp_f32 v97, v97
    v_exp_f32 v98, v98
    v_exp_f32 v99, v99
    v_smfmac_f32_32x32x32_bf16 v[120:135], v[48:51], v[88:95], v6
    v_exp_f32 v100, v100
    v_exp_f32 v101, v101
    v_exp_f32 v102, v102
    v_exp_f32 v103, v103
    ds_read_b128 v[34:37], v2 offset:39936
    ds_read_b32 v38, v3 offset:9984
    v_smfmac_f32_32x32x32_bf16 v[120:135], v[52:55], v[96:103], v6
    v_exp_f32 v104, v104
    v_exp_f32 v105, v105
    v_exp_f32 v106, v106
    v_exp_f32 v107, v107
    v_mfma_f32_32x32x16_bf16 v[56:71], v[28:31], v[16:19], v[56:71]
    v_exp_f32 v108, v108
    v_exp_f32 v109, v109
    v_exp_f32 v110, v110
    v_exp_f32 v111, v111
    v_mfma_f32_32x32x16_bf16 v[72:87], v[28:31], v[20:23], v[72:87]
    v_exp_f32 v112, v112
    v_exp_f32 v113, v113
    v_exp_f32 v114, v114
    v_exp_f32 v115, v115
    v_smfmac_f32_32x32x32_bf16 v[136:151], v[48:51], v[104:111], v6
    v_exp_f32 v116, v116
    v_exp_f32 v117, v117
    v_exp_f32 v118, v118
    v_exp_f32 v119, v119
    s_nop 0
    s_waitcnt lgkmcnt(0)
    v_smfmac_f32_32x32x32_bf16 v[136:151], v[52:55], v[112:119], v6
    s_mov_b64 exec, s[16:17]
    ds_read_b128 v[48:51], v5 offset:8064
    ds_read_b128 v[52:55], v5 offset:8640
    s_mov_b64 exec, -1
    v_exp_f32 v56, v56
    v_exp_f32 v57, v57
    v_exp_f32 v58, v58
    v_exp_f32 v59, v59
    v_mfma_f32_32x32x4_2b_bf16 v[88:119], v[38:39], v[24:25], 0
    v_exp_f32 v60, v60
    v_exp_f32 v61, v61
    v_exp_f32 v62, v62
    v_exp_f32 v63, v63
    v_exp_f32 v64, v64
    v_exp_f32 v65, v65
    v_exp_f32 v66, v66
    v_exp_f32 v67, v67
    v_smfmac_f32_32x32x32_bf16 v[120:135], v[40:43], v[56:63], v6
    v_exp_f32 v68, v68
    v_exp_f32 v69, v69
    v_exp_f32 v70, v70
    v_exp_f32 v71, v71
    ds_read_b128 v[28:31], v2 offset:40960
    ds_read_b32 v32, v3 offset:10240
    v_smfmac_f32_32x32x32_bf16 v[120:135], v[44:47], v[64:71], v6
    v_exp_f32 v72, v72
    v_exp_f32 v73, v73
    v_exp_f32 v74, v74
    v_exp_f32 v75, v75
    v_mfma_f32_32x32x16_bf16 v[88:103], v[34:37], v[16:19], v[88:103]
    v_exp_f32 v76, v76
    v_exp_f32 v77, v77
    v_exp_f32 v78, v78
    v_exp_f32 v79, v79
    v_mfma_f32_32x32x16_bf16 v[104:119], v[34:37], v[20:23], v[104:119]
    v_exp_f32 v80, v80
    v_exp_f32 v81, v81
    v_exp_f32 v82, v82
    v_exp_f32 v83, v83
    v_smfmac_f32_32x32x32_bf16 v[136:151], v[40:43], v[72:79], v6
    v_exp_f32 v84, v84
    v_exp_f32 v85, v85
    v_exp_f32 v86, v86
    v_exp_f32 v87, v87
    s_nop 0
    s_waitcnt lgkmcnt(0)
    v_smfmac_f32_32x32x32_bf16 v[136:151], v[44:47], v[80:87], v6
    s_mov_b64 exec, s[16:17]
    ds_read_b128 v[40:43], v5 offset:9216
    ds_read_b128 v[44:47], v5 offset:9792
    s_mov_b64 exec, -1
    v_exp_f32 v88, v88
    v_exp_f32 v89, v89
    v_exp_f32 v90, v90
    v_exp_f32 v91, v91
    v_mfma_f32_32x32x4_2b_bf16 v[56:87], v[32:33], v[24:25], 0
    v_exp_f32 v92, v92
    v_exp_f32 v93, v93
    v_exp_f32 v94, v94
    v_exp_f32 v95, v95
    v_exp_f32 v96, v96
    v_exp_f32 v97, v97
    v_exp_f32 v98, v98
    v_exp_f32 v99, v99
    v_smfmac_f32_32x32x32_bf16 v[120:135], v[48:51], v[88:95], v6
    v_exp_f32 v100, v100
    v_exp_f32 v101, v101
    v_exp_f32 v102, v102
    v_exp_f32 v103, v103
    ds_read_b128 v[34:37], v2 offset:41984
    ds_read_b32 v38, v3 offset:10496
    v_smfmac_f32_32x32x32_bf16 v[120:135], v[52:55], v[96:103], v6
    v_exp_f32 v104, v104
    v_exp_f32 v105, v105
    v_exp_f32 v106, v106
    v_exp_f32 v107, v107
    v_mfma_f32_32x32x16_bf16 v[56:71], v[28:31], v[16:19], v[56:71]
    v_exp_f32 v108, v108
    v_exp_f32 v109, v109
    v_exp_f32 v110, v110
    v_exp_f32 v111, v111
    v_mfma_f32_32x32x16_bf16 v[72:87], v[28:31], v[20:23], v[72:87]
    v_exp_f32 v112, v112
    v_exp_f32 v113, v113
    v_exp_f32 v114, v114
    v_exp_f32 v115, v115
    v_smfmac_f32_32x32x32_bf16 v[136:151], v[48:51], v[104:111], v6
    v_exp_f32 v116, v116
    v_exp_f32 v117, v117
    v_exp_f32 v118, v118
    v_exp_f32 v119, v119
    s_nop 0
    s_waitcnt lgkmcnt(0)
    v_smfmac_f32_32x32x32_bf16 v[136:151], v[52:55], v[112:119], v6
    s_mov_b64 exec, s[16:17]
    ds_read_b128 v[48:51], v5 offset:10368
    ds_read_b128 v[52:55], v5 offset:10944
    s_mov_b64 exec, -1
    v_exp_f32 v56, v56
    v_exp_f32 v57, v57
    v_exp_f32 v58, v58
    v_exp_f32 v59, v59
    v_mfma_f32_32x32x4_2b_bf16 v[88:119], v[38:39], v[24:25], 0
    v_exp_f32 v60, v60
    v_exp_f32 v61, v61
    v_exp_f32 v62, v62
    v_exp_f32 v63, v63
    v_exp_f32 v64, v64
    v_exp_f32 v65, v65
    v_exp_f32 v66, v66
    v_exp_f32 v67, v67
    v_smfmac_f32_32x32x32_bf16 v[120:135], v[40:43], v[56:63], v6
    v_exp_f32 v68, v68
    v_exp_f32 v69, v69
    v_exp_f32 v70, v70
    v_exp_f32 v71, v71
    ds_read_b128 v[28:31], v2 offset:43008
    ds_read_b32 v32, v3 offset:10752
    v_smfmac_f32_32x32x32_bf16 v[120:135], v[44:47], v[64:71], v6
    v_exp_f32 v72, v72
    v_exp_f32 v73, v73
    v_exp_f32 v74, v74
    v_exp_f32 v75, v75
    v_mfma_f32_32x32x16_bf16 v[88:103], v[34:37], v[16:19], v[88:103]
    v_exp_f32 v76, v76
    v_exp_f32 v77, v77
    v_exp_f32 v78, v78
    v_exp_f32 v79, v79
    v_mfma_f32_32x32x16_bf16 v[104:119], v[34:37], v[20:23], v[104:119]
    v_exp_f32 v80, v80
    v_exp_f32 v81, v81
    v_exp_f32 v82, v82
    v_exp_f32 v83, v83
    v_smfmac_f32_32x32x32_bf16 v[136:151], v[40:43], v[72:79], v6
    v_exp_f32 v84, v84
    v_exp_f32 v85, v85
    v_exp_f32 v86, v86
    v_exp_f32 v87, v87
    s_setprio 0
    s_waitcnt lgkmcnt(0)
    v_smfmac_f32_32x32x32_bf16 v[136:151], v[44:47], v[80:87], v6
    s_mov_b64 exec, s[16:17]
    ds_read_b128 v[40:43], v5 offset:11520
    ds_read_b128 v[44:47], v5 offset:12096
    s_mov_b64 exec, -1
    v_exp_f32 v88, v88
    v_exp_f32 v89, v89
    v_exp_f32 v90, v90
    v_exp_f32 v91, v91
    v_mfma_f32_32x32x4_2b_bf16 v[56:87], v[32:33], v[24:25], 0
    v_exp_f32 v92, v92
    v_exp_f32 v93, v93
    v_exp_f32 v94, v94
    v_exp_f32 v95, v95
    v_exp_f32 v96, v96
    v_exp_f32 v97, v97
    v_exp_f32 v98, v98
    v_exp_f32 v99, v99
    v_smfmac_f32_32x32x32_bf16 v[120:135], v[48:51], v[88:95], v6
    v_exp_f32 v100, v100
    v_exp_f32 v101, v101
    v_exp_f32 v102, v102
    v_exp_f32 v103, v103
    ds_read_b128 v[34:37], v2 offset:44032
    ds_read_b32 v38, v3 offset:11008
    v_smfmac_f32_32x32x32_bf16 v[120:135], v[52:55], v[96:103], v6
    v_exp_f32 v104, v104
    v_exp_f32 v105, v105
    v_exp_f32 v106, v106
    v_exp_f32 v107, v107
    v_mfma_f32_32x32x16_bf16 v[56:71], v[28:31], v[16:19], v[56:71]
    v_exp_f32 v108, v108
    v_exp_f32 v109, v109
    v_exp_f32 v110, v110
    v_exp_f32 v111, v111
    v_mfma_f32_32x32x16_bf16 v[72:87], v[28:31], v[20:23], v[72:87]
    v_exp_f32 v112, v112
    v_exp_f32 v113, v113
    v_exp_f32 v114, v114
    v_exp_f32 v115, v115
    v_smfmac_f32_32x32x32_bf16 v[136:151], v[48:51], v[104:111], v6
    v_exp_f32 v116, v116
    v_exp_f32 v117, v117
    v_exp_f32 v118, v118
    v_exp_f32 v119, v119
    s_setprio 2
    s_waitcnt lgkmcnt(0)
    v_smfmac_f32_32x32x32_bf16 v[136:151], v[52:55], v[112:119], v6
    s_mov_b64 exec, s[16:17]
    ds_read_b128 v[48:51], v5 offset:12672
    ds_read_b128 v[52:55], v5 offset:13248
    s_mov_b64 exec, -1
    v_exp_f32 v56, v56
    v_exp_f32 v57, v57
    v_exp_f32 v58, v58
    v_exp_f32 v59, v59
    v_mfma_f32_32x32x4_2b_bf16 v[88:119], v[38:39], v[24:25], 0
    v_exp_f32 v60, v60
    v_exp_f32 v61, v61
    v_exp_f32 v62, v62
    v_exp_f32 v63, v63
    v_exp_f32 v64, v64
    v_exp_f32 v65, v65
    v_exp_f32 v66, v66
    v_exp_f32 v67, v67
    v_smfmac_f32_32x32x32_bf16 v[120:135], v[40:43], v[56:63], v6
    v_exp_f32 v68, v68
    v_exp_f32 v69, v69
    v_exp_f32 v70, v70
    v_exp_f32 v71, v71
    ds_read_b128 v[28:31], v2 offset:45056
    ds_read_b32 v32, v3 offset:11264
    v_smfmac_f32_32x32x32_bf16 v[120:135], v[44:47], v[64:71], v6
    v_exp_f32 v72, v72
    v_exp_f32 v73, v73
    v_exp_f32 v74, v74
    v_exp_f32 v75, v75
    v_mfma_f32_32x32x16_bf16 v[88:103], v[34:37], v[16:19], v[88:103]
    v_exp_f32 v76, v76
    v_exp_f32 v77, v77
    v_exp_f32 v78, v78
    v_exp_f32 v79, v79
    v_mfma_f32_32x32x16_bf16 v[104:119], v[34:37], v[20:23], v[104:119]
    v_exp_f32 v80, v80
    v_exp_f32 v81, v81
    v_exp_f32 v82, v82
    v_exp_f32 v83, v83
    v_smfmac_f32_32x32x32_bf16 v[136:151], v[40:43], v[72:79], v6
    v_exp_f32 v84, v84
    v_exp_f32 v85, v85
    v_exp_f32 v86, v86
    v_exp_f32 v87, v87
    s_nop 0
    s_waitcnt lgkmcnt(0)
    v_smfmac_f32_32x32x32_bf16 v[136:151], v[44:47], v[80:87], v6
    s_mov_b64 exec, s[16:17]
    ds_read_b128 v[40:43], v5 offset:13824
    ds_read_b128 v[44:47], v5 offset:14400
    s_mov_b64 exec, -1
    v_exp_f32 v88, v88
    v_exp_f32 v89, v89
    v_exp_f32 v90, v90
    v_exp_f32 v91, v91
    v_mfma_f32_32x32x4_2b_bf16 v[56:87], v[32:33], v[24:25], 0
    v_exp_f32 v92, v92
    v_exp_f32 v93, v93
    v_exp_f32 v94, v94
    v_exp_f32 v95, v95
    v_exp_f32 v96, v96
    v_exp_f32 v97, v97
    v_exp_f32 v98, v98
    v_exp_f32 v99, v99
    v_smfmac_f32_32x32x32_bf16 v[120:135], v[48:51], v[88:95], v6
    v_exp_f32 v100, v100
    v_exp_f32 v101, v101
    v_exp_f32 v102, v102
    v_exp_f32 v103, v103
    ds_read_b128 v[34:37], v2 offset:46080
    ds_read_b32 v38, v3 offset:11520
    v_smfmac_f32_32x32x32_bf16 v[120:135], v[52:55], v[96:103], v6
    v_exp_f32 v104, v104
    v_exp_f32 v105, v105
    v_exp_f32 v106, v106
    v_exp_f32 v107, v107
    v_mfma_f32_32x32x16_bf16 v[56:71], v[28:31], v[16:19], v[56:71]
    v_exp_f32 v108, v108
    v_exp_f32 v109, v109
    v_exp_f32 v110, v110
    v_exp_f32 v111, v111
    v_mfma_f32_32x32x16_bf16 v[72:87], v[28:31], v[20:23], v[72:87]
    v_exp_f32 v112, v112
    v_exp_f32 v113, v113
    v_exp_f32 v114, v114
    v_exp_f32 v115, v115
    v_smfmac_f32_32x32x32_bf16 v[136:151], v[48:51], v[104:111], v6
    v_exp_f32 v116, v116
    v_exp_f32 v117, v117
    v_exp_f32 v118, v118
    v_exp_f32 v119, v119
    s_nop 0
    s_waitcnt lgkmcnt(0)
    v_smfmac_f32_32x32x32_bf16 v[136:151], v[52:55], v[112:119], v6
    s_mov_b64 exec, s[16:17]
    ds_read_b128 v[48:51], v5 offset:14976
    ds_read_b128 v[52:55], v5 offset:15552
    s_mov_b64 exec, -1
    v_exp_f32 v56, v56
    v_exp_f32 v57, v57
    v_exp_f32 v58, v58
    v_exp_f32 v59, v59
    v_mfma_f32_32x32x4_2b_bf16 v[88:119], v[38:39], v[24:25], 0
    v_exp_f32 v60, v60
    v_exp_f32 v61, v61
    v_exp_f32 v62, v62
    v_exp_f32 v63, v63
    v_exp_f32 v64, v64
    v_exp_f32 v65, v65
    v_exp_f32 v66, v66
    v_exp_f32 v67, v67
    v_smfmac_f32_32x32x32_bf16 v[120:135], v[40:43], v[56:63], v6
    v_exp_f32 v68, v68
    v_exp_f32 v69, v69
    v_exp_f32 v70, v70
    v_exp_f32 v71, v71
    ds_read_b128 v[28:31], v2 offset:47104
    ds_read_b32 v32, v3 offset:11776
    v_smfmac_f32_32x32x32_bf16 v[120:135], v[44:47], v[64:71], v6
    v_exp_f32 v72, v72
    v_exp_f32 v73, v73
    v_exp_f32 v74, v74
    v_exp_f32 v75, v75
    v_mfma_f32_32x32x16_bf16 v[88:103], v[34:37], v[16:19], v[88:103]
    v_exp_f32 v76, v76
    v_exp_f32 v77, v77
    v_exp_f32 v78, v78
    v_exp_f32 v79, v79
    v_mfma_f32_32x32x16_bf16 v[104:119], v[34:37], v[20:23], v[104:119]
    v_exp_f32 v80, v80
    v_exp_f32 v81, v81
    v_exp_f32 v82, v82
    v_exp_f32 v83, v83
    v_smfmac_f32_32x32x32_bf16 v[136:151], v[40:43], v[72:79], v6
    v_exp_f32 v84, v84
    v_exp_f32 v85, v85
    v_exp_f32 v86, v86
    v_exp_f32 v87, v87
    s_nop 0
    s_waitcnt lgkmcnt(0)
    v_smfmac_f32_32x32x32_bf16 v[136:151], v[44:47], v[80:87], v6
    s_mov_b64 exec, s[16:17]
    ds_read_b128 v[40:43], v5 offset:16128
    ds_read_b128 v[44:47], v5 offset:16704
    s_mov_b64 exec, -1
    v_exp_f32 v88, v88
    v_exp_f32 v89, v89
    v_exp_f32 v90, v90
    v_exp_f32 v91, v91
    v_mfma_f32_32x32x4_2b_bf16 v[56:87], v[32:33], v[24:25], 0
    v_exp_f32 v92, v92
    v_exp_f32 v93, v93
    v_exp_f32 v94, v94
    v_exp_f32 v95, v95
    v_exp_f32 v96, v96
    v_exp_f32 v97, v97
    v_exp_f32 v98, v98
    v_exp_f32 v99, v99
    v_smfmac_f32_32x32x32_bf16 v[120:135], v[48:51], v[88:95], v6
    v_exp_f32 v100, v100
    v_exp_f32 v101, v101
    v_exp_f32 v102, v102
    v_exp_f32 v103, v103
    ds_read_b128 v[34:37], v2 offset:48128
    ds_read_b32 v38, v3 offset:12032
    v_smfmac_f32_32x32x32_bf16 v[120:135], v[52:55], v[96:103], v6
    v_exp_f32 v104, v104
    v_exp_f32 v105, v105
    v_exp_f32 v106, v106
    v_exp_f32 v107, v107
    v_mfma_f32_32x32x16_bf16 v[56:71], v[28:31], v[16:19], v[56:71]
    v_exp_f32 v108, v108
    v_exp_f32 v109, v109
    v_exp_f32 v110, v110
    v_exp_f32 v111, v111
    v_mfma_f32_32x32x16_bf16 v[72:87], v[28:31], v[20:23], v[72:87]
    v_exp_f32 v112, v112
    v_exp_f32 v113, v113
    v_exp_f32 v114, v114
    v_exp_f32 v115, v115
    v_smfmac_f32_32x32x32_bf16 v[136:151], v[48:51], v[104:111], v6
    v_exp_f32 v116, v116
    v_exp_f32 v117, v117
    v_exp_f32 v118, v118
    v_exp_f32 v119, v119
    s_nop 0
    s_waitcnt lgkmcnt(0)
    v_smfmac_f32_32x32x32_bf16 v[136:151], v[52:55], v[112:119], v6
    s_mov_b64 exec, s[16:17]
    ds_read_b128 v[48:51], v5 offset:17280
    ds_read_b128 v[52:55], v5 offset:17856
    s_mov_b64 exec, -1
    v_exp_f32 v56, v56
    v_exp_f32 v57, v57
    v_exp_f32 v58, v58
    v_exp_f32 v59, v59
    v_mfma_f32_32x32x4_2b_bf16 v[88:119], v[38:39], v[24:25], 0
    v_exp_f32 v60, v60
    v_exp_f32 v61, v61
    v_exp_f32 v62, v62
    v_exp_f32 v63, v63
    v_exp_f32 v64, v64
    v_exp_f32 v65, v65
    v_exp_f32 v66, v66
    v_exp_f32 v67, v67
    v_smfmac_f32_32x32x32_bf16 v[120:135], v[40:43], v[56:63], v6
    v_exp_f32 v68, v68
    v_exp_f32 v69, v69
    v_exp_f32 v70, v70
    v_exp_f32 v71, v71
    ds_read_b128 v[28:31], v2 offset:49152
    ds_read_b32 v32, v3 offset:12288
    v_smfmac_f32_32x32x32_bf16 v[120:135], v[44:47], v[64:71], v6
    v_exp_f32 v72, v72
    v_exp_f32 v73, v73
    v_exp_f32 v74, v74
    v_exp_f32 v75, v75
    v_mfma_f32_32x32x16_bf16 v[88:103], v[34:37], v[16:19], v[88:103]
    v_exp_f32 v76, v76
    v_exp_f32 v77, v77
    v_exp_f32 v78, v78
    v_exp_f32 v79, v79
    v_mfma_f32_32x32x16_bf16 v[104:119], v[34:37], v[20:23], v[104:119]
    v_exp_f32 v80, v80
    v_exp_f32 v81, v81
    v_exp_f32 v82, v82
    v_exp_f32 v83, v83
    v_smfmac_f32_32x32x32_bf16 v[136:151], v[40:43], v[72:79], v6
    v_exp_f32 v84, v84
    v_exp_f32 v85, v85
    v_exp_f32 v86, v86
    v_exp_f32 v87, v87
    s_nop 0
    s_waitcnt lgkmcnt(0)
    v_smfmac_f32_32x32x32_bf16 v[136:151], v[44:47], v[80:87], v6
    s_mov_b64 exec, s[16:17]
    ds_read_b128 v[40:43], v5 offset:18432
    ds_read_b128 v[44:47], v5 offset:19008
    s_mov_b64 exec, -1
    v_exp_f32 v88, v88
    v_exp_f32 v89, v89
    v_exp_f32 v90, v90
    v_exp_f32 v91, v91
    v_mfma_f32_32x32x4_2b_bf16 v[56:87], v[32:33], v[24:25], 0
    v_exp_f32 v92, v92
    v_exp_f32 v93, v93
    v_exp_f32 v94, v94
    v_exp_f32 v95, v95
    v_exp_f32 v96, v96
    v_exp_f32 v97, v97
    v_exp_f32 v98, v98
    v_exp_f32 v99, v99
    v_smfmac_f32_32x32x32_bf16 v[120:135], v[48:51], v[88:95], v6
    v_exp_f32 v100, v100
    v_exp_f32 v101, v101
    v_exp_f32 v102, v102
    v_exp_f32 v103, v103
    ds_read_b128 v[34:37], v2 offset:50176
    ds_read_b32 v38, v3 offset:12544
    v_smfmac_f32_32x32x32_bf16 v[120:135], v[52:55], v[96:103], v6
    v_exp_f32 v104, v104
    v_exp_f32 v105, v105
    v_exp_f32 v106, v106
    v_exp_f32 v107, v107
    v_mfma_f32_32x32x16_bf16 v[56:71], v[28:31], v[16:19], v[56:71]
    v_exp_f32 v108, v108
    v_exp_f32 v109, v109
    v_exp_f32 v110, v110
    v_exp_f32 v111, v111
    v_mfma_f32_32x32x16_bf16 v[72:87], v[28:31], v[20:23], v[72:87]
    v_exp_f32 v112, v112
    v_exp_f32 v113, v113
    v_exp_f32 v114, v114
    v_exp_f32 v115, v115
    v_smfmac_f32_32x32x32_bf16 v[136:151], v[48:51], v[104:111], v6
    v_exp_f32 v116, v116
    v_exp_f32 v117, v117
    v_exp_f32 v118, v118
    v_exp_f32 v119, v119
    s_setprio 0
    s_waitcnt lgkmcnt(0)
    v_smfmac_f32_32x32x32_bf16 v[136:151], v[52:55], v[112:119], v6
    s_mov_b64 exec, s[16:17]
    ds_read_b128 v[48:51], v5 offset:19584
    ds_read_b128 v[52:55], v5 offset:20160
    s_mov_b64 exec, -1
    v_exp_f32 v56, v56
    v_exp_f32 v57, v57
    v_exp_f32 v58, v58
    v_exp_f32 v59, v59
    v_mfma_f32_32x32x4_2b_bf16 v[88:119], v[38:39], v[24:25], 0
    v_exp_f32 v60, v60
    v_exp_f32 v61, v61
    v_exp_f32 v62, v62
    v_exp_f32 v63, v63
    v_exp_f32 v64, v64
    v_exp_f32 v65, v65
    v_exp_f32 v66, v66
    v_exp_f32 v67, v67
    v_smfmac_f32_32x32x32_bf16 v[120:135], v[40:43], v[56:63], v6
    v_exp_f32 v68, v68
    v_exp_f32 v69, v69
    v_exp_f32 v70, v70
    v_exp_f32 v71, v71
    ds_read_b128 v[28:31], v2 offset:51200
    ds_read_b32 v32, v3 offset:12800
    v_smfmac_f32_32x32x32_bf16 v[120:135], v[44:47], v[64:71], v6
    v_exp_f32 v72, v72
    v_exp_f32 v73, v73
    v_exp_f32 v74, v74
    v_exp_f32 v75, v75
    v_mfma_f32_32x32x16_bf16 v[88:103], v[34:37], v[16:19], v[88:103]
    v_exp_f32 v76, v76
    v_exp_f32 v77, v77
    v_exp_f32 v78, v78
    v_exp_f32 v79, v79
    v_mfma_f32_32x32x16_bf16 v[104:119], v[34:37], v[20:23], v[104:119]
    v_exp_f32 v80, v80
    v_exp_f32 v81, v81
    v_exp_f32 v82, v82
    v_exp_f32 v83, v83
    v_smfmac_f32_32x32x32_bf16 v[136:151], v[40:43], v[72:79], v6
    v_exp_f32 v84, v84
    v_exp_f32 v85, v85
    v_exp_f32 v86, v86
    v_exp_f32 v87, v87
    s_setprio 2
    s_waitcnt lgkmcnt(0)
    v_smfmac_f32_32x32x32_bf16 v[136:151], v[44:47], v[80:87], v6
    s_mov_b64 exec, s[16:17]
    ds_read_b128 v[40:43], v5 offset:20736
    ds_read_b128 v[44:47], v5 offset:21312
    s_mov_b64 exec, -1
    v_exp_f32 v88, v88
    v_exp_f32 v89, v89
    v_exp_f32 v90, v90
    v_exp_f32 v91, v91
    v_mfma_f32_32x32x4_2b_bf16 v[56:87], v[32:33], v[24:25], 0
    v_exp_f32 v92, v92
    v_exp_f32 v93, v93
    v_exp_f32 v94, v94
    v_exp_f32 v95, v95
    v_exp_f32 v96, v96
    v_exp_f32 v97, v97
    v_exp_f32 v98, v98
    v_exp_f32 v99, v99
    v_smfmac_f32_32x32x32_bf16 v[120:135], v[48:51], v[88:95], v6
    v_exp_f32 v100, v100
    v_exp_f32 v101, v101
    v_exp_f32 v102, v102
    v_exp_f32 v103, v103
    ds_read_b128 v[34:37], v2 offset:52224
    ds_read_b32 v38, v3 offset:13056
    v_smfmac_f32_32x32x32_bf16 v[120:135], v[52:55], v[96:103], v6
    v_exp_f32 v104, v104
    v_exp_f32 v105, v105
    v_exp_f32 v106, v106
    v_exp_f32 v107, v107
    v_mfma_f32_32x32x16_bf16 v[56:71], v[28:31], v[16:19], v[56:71]
    v_exp_f32 v108, v108
    v_exp_f32 v109, v109
    v_exp_f32 v110, v110
    v_exp_f32 v111, v111
    v_mfma_f32_32x32x16_bf16 v[72:87], v[28:31], v[20:23], v[72:87]
    v_exp_f32 v112, v112
    v_exp_f32 v113, v113
    v_exp_f32 v114, v114
    v_exp_f32 v115, v115
    v_smfmac_f32_32x32x32_bf16 v[136:151], v[48:51], v[104:111], v6
    v_exp_f32 v116, v116
    v_exp_f32 v117, v117
    v_exp_f32 v118, v118
    v_exp_f32 v119, v119
    s_nop 0
    s_waitcnt lgkmcnt(0)
    v_smfmac_f32_32x32x32_bf16 v[136:151], v[52:55], v[112:119], v6
    s_mov_b64 exec, s[16:17]
    ds_read_b128 v[48:51], v5 offset:21888
    ds_read_b128 v[52:55], v5 offset:22464
    s_mov_b64 exec, -1
    v_exp_f32 v56, v56
    v_exp_f32 v57, v57
    v_exp_f32 v58, v58
    v_exp_f32 v59, v59
    v_mfma_f32_32x32x4_2b_bf16 v[88:119], v[38:39], v[24:25], 0
    v_exp_f32 v60, v60
    v_exp_f32 v61, v61
    v_exp_f32 v62, v62
    v_exp_f32 v63, v63
    v_exp_f32 v64, v64
    v_exp_f32 v65, v65
    v_exp_f32 v66, v66
    v_exp_f32 v67, v67
    v_smfmac_f32_32x32x32_bf16 v[120:135], v[40:43], v[56:63], v6
    v_exp_f32 v68, v68
    v_exp_f32 v69, v69
    v_exp_f32 v70, v70
    v_exp_f32 v71, v71
    ds_read_b128 v[28:31], v2 offset:53248
    ds_read_b32 v32, v3 offset:13312
    v_smfmac_f32_32x32x32_bf16 v[120:135], v[44:47], v[64:71], v6
    v_exp_f32 v72, v72
    v_exp_f32 v73, v73
    v_exp_f32 v74, v74
    v_exp_f32 v75, v75
    v_mfma_f32_32x32x16_bf16 v[88:103], v[34:37], v[16:19], v[88:103]
    v_exp_f32 v76, v76
    v_exp_f32 v77, v77
    v_exp_f32 v78, v78
    v_exp_f32 v79, v79
    v_mfma_f32_32x32x16_bf16 v[104:119], v[34:37], v[20:23], v[104:119]
    v_exp_f32 v80, v80
    v_exp_f32 v81, v81
    v_exp_f32 v82, v82
    v_exp_f32 v83, v83
    v_smfmac_f32_32x32x32_bf16 v[136:151], v[40:43], v[72:79], v6
    v_exp_f32 v84, v84
    v_exp_f32 v85, v85
    v_exp_f32 v86, v86
    v_exp_f32 v87, v87
    s_nop 0
    s_waitcnt lgkmcnt(0)
    v_smfmac_f32_32x32x32_bf16 v[136:151], v[44:47], v[80:87], v6
    s_mov_b64 exec, s[16:17]
    ds_read_b128 v[40:43], v5 offset:23040
    ds_read_b128 v[44:47], v5 offset:23616
    s_mov_b64 exec, -1
    v_exp_f32 v88, v88
    v_exp_f32 v89, v89
    v_exp_f32 v90, v90
    v_exp_f32 v91, v91
    v_mfma_f32_32x32x4_2b_bf16 v[56:87], v[32:33], v[24:25], 0
    v_exp_f32 v92, v92
    v_exp_f32 v93, v93
    v_exp_f32 v94, v94
    v_exp_f32 v95, v95
    v_exp_f32 v96, v96
    v_exp_f32 v97, v97
    v_exp_f32 v98, v98
    v_exp_f32 v99, v99
    v_smfmac_f32_32x32x32_bf16 v[120:135], v[48:51], v[88:95], v6
    v_exp_f32 v100, v100
    v_exp_f32 v101, v101
    v_exp_f32 v102, v102
    v_exp_f32 v103, v103
    ds_read_b128 v[34:37], v2 offset:54272
    ds_read_b32 v38, v3 offset:13568
    v_smfmac_f32_32x32x32_bf16 v[120:135], v[52:55], v[96:103], v6
    v_exp_f32 v104, v104
    v_exp_f32 v105, v105
    v_exp_f32 v106, v106
    v_exp_f32 v107, v107
    v_mfma_f32_32x32x16_bf16 v[56:71], v[28:31], v[16:19], v[56:71]
    v_exp_f32 v108, v108
    v_exp_f32 v109, v109
    v_exp_f32 v110, v110
    v_exp_f32 v111, v111
    v_mfma_f32_32x32x16_bf16 v[72:87], v[28:31], v[20:23], v[72:87]
    v_exp_f32 v112, v112
    v_exp_f32 v113, v113
    v_exp_f32 v114, v114
    v_exp_f32 v115, v115
    v_smfmac_f32_32x32x32_bf16 v[136:151], v[48:51], v[104:111], v6
    v_exp_f32 v116, v116
    v_exp_f32 v117, v117
    v_exp_f32 v118, v118
    v_exp_f32 v119, v119
    s_nop 0
    s_waitcnt lgkmcnt(0)
    v_smfmac_f32_32x32x32_bf16 v[136:151], v[52:55], v[112:119], v6
    s_mov_b64 exec, s[16:17]
    ds_read_b128 v[48:51], v5 offset:24192
    ds_read_b128 v[52:55], v5 offset:24768
    s_mov_b64 exec, -1
    v_exp_f32 v56, v56
    v_exp_f32 v57, v57
    v_exp_f32 v58, v58
    v_exp_f32 v59, v59
    v_mfma_f32_32x32x4_2b_bf16 v[88:119], v[38:39], v[24:25], 0
    v_exp_f32 v60, v60
    v_exp_f32 v61, v61
    v_exp_f32 v62, v62
    v_exp_f32 v63, v63
    v_exp_f32 v64, v64
    v_exp_f32 v65, v65
    v_exp_f32 v66, v66
    v_exp_f32 v67, v67
    v_smfmac_f32_32x32x32_bf16 v[120:135], v[40:43], v[56:63], v6
    v_exp_f32 v68, v68
    v_exp_f32 v69, v69
    v_exp_f32 v70, v70
    v_exp_f32 v71, v71
    ds_read_b128 v[28:31], v2 offset:55296
    ds_read_b32 v32, v3 offset:13824
    v_smfmac_f32_32x32x32_bf16 v[120:135], v[44:47], v[64:71], v6
    v_exp_f32 v72, v72
    v_exp_f32 v73, v73
    v_exp_f32 v74, v74
    v_exp_f32 v75, v75
    v_mfma_f32_32x32x16_bf16 v[88:103], v[34:37], v[16:19], v[88:103]
    v_exp_f32 v76, v76
    v_exp_f32 v77, v77
    v_exp_f32 v78, v78
    v_exp_f32 v79, v79
    v_mfma_f32_32x32x16_bf16 v[104:119], v[34:37], v[20:23], v[104:119]
    v_exp_f32 v80, v80
    v_exp_f32 v81, v81
    v_exp_f32 v82, v82
    v_exp_f32 v83, v83
    v_smfmac_f32_32x32x32_bf16 v[136:151], v[40:43], v[72:79], v6
    v_exp_f32 v84, v84
    v_exp_f32 v85, v85
    v_exp_f32 v86, v86
    v_exp_f32 v87, v87
    s_nop 0
    s_waitcnt lgkmcnt(0)
    v_smfmac_f32_32x32x32_bf16 v[136:151], v[44:47], v[80:87], v6
    s_mov_b64 exec, s[16:17]
    ds_read_b128 v[40:43], v5 offset:25344
    ds_read_b128 v[44:47], v5 offset:25920
    s_mov_b64 exec, -1
    v_exp_f32 v88, v88
    v_exp_f32 v89, v89
    v_exp_f32 v90, v90
    v_exp_f32 v91, v91
    v_mfma_f32_32x32x4_2b_bf16 v[56:87], v[32:33], v[24:25], 0
    v_exp_f32 v92, v92
    v_exp_f32 v93, v93
    v_exp_f32 v94, v94
    v_exp_f32 v95, v95
    v_exp_f32 v96, v96
    v_exp_f32 v97, v97
    v_exp_f32 v98, v98
    v_exp_f32 v99, v99
    v_smfmac_f32_32x32x32_bf16 v[120:135], v[48:51], v[88:95], v6
    v_exp_f32 v100, v100
    v_exp_f32 v101, v101
    v_exp_f32 v102, v102
    v_exp_f32 v103, v103
    ds_read_b128 v[34:37], v2 offset:56320
    ds_read_b32 v38, v3 offset:14080
    v_smfmac_f32_32x32x32_bf16 v[120:135], v[52:55], v[96:103], v6
    v_exp_f32 v104, v104
    v_exp_f32 v105, v105
    v_exp_f32 v106, v106
    v_exp_f32 v107, v107
    v_mfma_f32_32x32x16_bf16 v[56:71], v[28:31], v[16:19], v[56:71]
    v_exp_f32 v108, v108
    v_exp_f32 v109, v109
    v_exp_f32 v110, v110
    v_exp_f32 v111, v111
    v_mfma_f32_32x32x16_bf16 v[72:87], v[28:31], v[20:23], v[72:87]
    v_exp_f32 v112, v112
    v_exp_f32 v113, v113
    v_exp_f32 v114, v114
    v_exp_f32 v115, v115
    v_smfmac_f32_32x32x32_bf16 v[136:151], v[48:51], v[104:111], v6
    v_exp_f32 v116, v116
    v_exp_f32 v117, v117
    v_exp_f32 v118, v118
    v_exp_f32 v119, v119
    s_nop 0
    s_waitcnt lgkmcnt(0)
    v_smfmac_f32_32x32x32_bf16 v[136:151], v[52:55], v[112:119], v6
    s_mov_b64 exec, s[16:17]
    ds_read_b128 v[48:51], v5 offset:26496
    ds_read_b128 v[52:55], v5 offset:27072
    s_mov_b64 exec, -1
    v_exp_f32 v56, v56
    v_exp_f32 v57, v57
    v_exp_f32 v58, v58
    v_exp_f32 v59, v59
    v_mfma_f32_32x32x4_2b_bf16 v[88:119], v[38:39], v[24:25], 0
    v_exp_f32 v60, v60
    v_exp_f32 v61, v61
    v_exp_f32 v62, v62
    v_exp_f32 v63, v63
    v_exp_f32 v64, v64
    v_exp_f32 v65, v65
    v_exp_f32 v66, v66
    v_exp_f32 v67, v67
    v_smfmac_f32_32x32x32_bf16 v[120:135], v[40:43], v[56:63], v6
    v_exp_f32 v68, v68
    v_exp_f32 v69, v69
    v_exp_f32 v70, v70
    v_exp_f32 v71, v71
    ds_read_b128 v[28:31], v2 offset:57344
    ds_read_b32 v32, v3 offset:14336
    v_smfmac_f32_32x32x32_bf16 v[120:135], v[44:47], v[64:71], v6
    v_exp_f32 v72, v72
    v_exp_f32 v73, v73
    v_exp_f32 v74, v74
    v_exp_f32 v75, v75
    v_mfma_f32_32x32x16_bf16 v[88:103], v[34:37], v[16:19], v[88:103]
    v_exp_f32 v76, v76
    v_exp_f32 v77, v77
    v_exp_f32 v78, v78
    v_exp_f32 v79, v79
    v_mfma_f32_32x32x16_bf16 v[104:119], v[34:37], v[20:23], v[104:119]
    v_exp_f32 v80, v80
    v_exp_f32 v81, v81
    v_exp_f32 v82, v82
    v_exp_f32 v83, v83
    v_smfmac_f32_32x32x32_bf16 v[136:151], v[40:43], v[72:79], v6
    v_exp_f32 v84, v84
    v_exp_f32 v85, v85
    v_exp_f32 v86, v86
    v_exp_f32 v87, v87
    s_setprio 0
    s_waitcnt lgkmcnt(0)
    v_smfmac_f32_32x32x32_bf16 v[136:151], v[44:47], v[80:87], v6
    s_mov_b64 exec, s[16:17]
    ds_read_b128 v[40:43], v5 offset:27648
    ds_read_b128 v[44:47], v5 offset:28224
    s_mov_b64 exec, -1
    v_exp_f32 v88, v88
    v_exp_f32 v89, v89
    v_exp_f32 v90, v90
    v_exp_f32 v91, v91
    v_mfma_f32_32x32x4_2b_bf16 v[56:87], v[32:33], v[24:25], 0
    v_exp_f32 v92, v92
    v_exp_f32 v93, v93
    v_exp_f32 v94, v94
    v_exp_f32 v95, v95
    v_exp_f32 v96, v96
    v_exp_f32 v97, v97
    v_exp_f32 v98, v98
    v_exp_f32 v99, v99
    v_smfmac_f32_32x32x32_bf16 v[120:135], v[48:51], v[88:95], v6
    v_exp_f32 v100, v100
    v_exp_f32 v101, v101
    v_exp_f32 v102, v102
    v_exp_f32 v103, v103
    ds_read_b128 v[34:37], v2 offset:58368
    ds_read_b32 v38, v3 offset:14592
    v_smfmac_f32_32x32x32_bf16 v[120:135], v[52:55], v[96:103], v6
    v_exp_f32 v104, v104
    v_exp_f32 v105, v105
    v_exp_f32 v106, v106
    v_exp_f32 v107, v107
    v_mfma_f32_32x32x16_bf16 v[56:71], v[28:31], v[16:19], v[56:71]
    v_exp_f32 v108, v108
    v_exp_f32 v109, v109
    v_exp_f32 v110, v110
    v_exp_f32 v111, v111
    v_mfma_f32_32x32x16_bf16 v[72:87], v[28:31], v[20:23], v[72:87]
    v_exp_f32 v112, v112
    v_exp_f32 v113, v113
    v_exp_f32 v114, v114
    v_exp_f32 v115, v115
    v_smfmac_f32_32x32x32_bf16 v[136:151], v[48:51], v[104:111], v6
    v_exp_f32 v116, v116
    v_exp_f32 v117, v117
    v_exp_f32 v118, v118
    v_exp_f32 v119, v119
    s_setprio 2
    s_waitcnt lgkmcnt(0)
    v_smfmac_f32_32x32x32_bf16 v[136:151], v[52:55], v[112:119], v6
    s_mov_b64 exec, s[16:17]
    ds_read_b128 v[48:51], v5 offset:28800
    ds_read_b128 v[52:55], v5 offset:29376
    s_mov_b64 exec, -1
    v_exp_f32 v56, v56
    v_exp_f32 v57, v57
    v_exp_f32 v58, v58
    v_exp_f32 v59, v59
    v_mfma_f32_32x32x4_2b_bf16 v[88:119], v[38:39], v[24:25], 0
    v_exp_f32 v60, v60
    v_exp_f32 v61, v61
    v_exp_f32 v62, v62
    v_exp_f32 v63, v63
    v_exp_f32 v64, v64
    v_exp_f32 v65, v65
    v_exp_f32 v66, v66
    v_exp_f32 v67, v67
    v_smfmac_f32_32x32x32_bf16 v[120:135], v[40:43], v[56:63], v6
    v_exp_f32 v68, v68
    v_exp_f32 v69, v69
    v_exp_f32 v70, v70
    v_exp_f32 v71, v71
    ds_read_b128 v[28:31], v2 offset:59392
    ds_read_b32 v32, v3 offset:14848
    v_smfmac_f32_32x32x32_bf16 v[120:135], v[44:47], v[64:71], v6
    v_exp_f32 v72, v72
    v_exp_f32 v73, v73
    v_exp_f32 v74, v74
    v_exp_f32 v75, v75
    v_mfma_f32_32x32x16_bf16 v[88:103], v[34:37], v[16:19], v[88:103]
    v_exp_f32 v76, v76
    v_exp_f32 v77, v77
    v_exp_f32 v78, v78
    v_exp_f32 v79, v79
    v_mfma_f32_32x32x16_bf16 v[104:119], v[34:37], v[20:23], v[104:119]
    v_exp_f32 v80, v80
    v_exp_f32 v81, v81
    v_exp_f32 v82, v82
    v_exp_f32 v83, v83
    v_smfmac_f32_32x32x32_bf16 v[136:151], v[40:43], v[72:79], v6
    v_exp_f32 v84, v84
    v_exp_f32 v85, v85
    v_exp_f32 v86, v86
    v_exp_f32 v87, v87
    s_nop 0
    s_waitcnt lgkmcnt(0)
    v_smfmac_f32_32x32x32_bf16 v[136:151], v[44:47], v[80:87], v6
    s_mov_b64 exec, s[16:17]
    ds_read_b128 v[40:43], v5 offset:29952
    ds_read_b128 v[44:47], v5 offset:30528
    s_mov_b64 exec, -1
    v_exp_f32 v88, v88
    v_exp_f32 v89, v89
    v_exp_f32 v90, v90
    v_exp_f32 v91, v91
    v_mfma_f32_32x32x4_2b_bf16 v[56:87], v[32:33], v[24:25], 0
    v_exp_f32 v92, v92
    v_exp_f32 v93, v93
    v_exp_f32 v94, v94
    v_exp_f32 v95, v95
    v_exp_f32 v96, v96
    v_exp_f32 v97, v97
    v_exp_f32 v98, v98
    v_exp_f32 v99, v99
    v_smfmac_f32_32x32x32_bf16 v[120:135], v[48:51], v[88:95], v6
    v_exp_f32 v100, v100
    v_exp_f32 v101, v101
    v_exp_f32 v102, v102
    v_exp_f32 v103, v103
    ds_read_b128 v[34:37], v2 offset:60416
    ds_read_b32 v38, v3 offset:15104
    v_smfmac_f32_32x32x32_bf16 v[120:135], v[52:55], v[96:103], v6
    v_exp_f32 v104, v104
    v_exp_f32 v105, v105
    v_exp_f32 v106, v106
    v_exp_f32 v107, v107
    v_mfma_f32_32x32x16_bf16 v[56:71], v[28:31], v[16:19], v[56:71]
    v_exp_f32 v108, v108
    v_exp_f32 v109, v109
    v_exp_f32 v110, v110
    v_exp_f32 v111, v111
    v_mfma_f32_32x32x16_bf16 v[72:87], v[28:31], v[20:23], v[72:87]
    v_exp_f32 v112, v112
    v_exp_f32 v113, v113
    v_exp_f32 v114, v114
    v_exp_f32 v115, v115
    v_smfmac_f32_32x32x32_bf16 v[136:151], v[48:51], v[104:111], v6
    v_exp_f32 v116, v116
    v_exp_f32 v117, v117
    v_exp_f32 v118, v118
    v_exp_f32 v119, v119
    s_nop 0
    s_waitcnt lgkmcnt(0)
    v_smfmac_f32_32x32x32_bf16 v[136:151], v[52:55], v[112:119], v6
    s_mov_b64 exec, s[16:17]
    ds_read_b128 v[48:51], v5 offset:31104
    ds_read_b128 v[52:55], v5 offset:31680
    s_mov_b64 exec, -1
    v_exp_f32 v56, v56
    v_exp_f32 v57, v57
    v_exp_f32 v58, v58
    v_exp_f32 v59, v59
    v_mfma_f32_32x32x4_2b_bf16 v[88:119], v[38:39], v[24:25], 0
    v_exp_f32 v60, v60
    v_exp_f32 v61, v61
    v_exp_f32 v62, v62
    v_exp_f32 v63, v63
    v_exp_f32 v64, v64
    v_exp_f32 v65, v65
    v_exp_f32 v66, v66
    v_exp_f32 v67, v67
    v_smfmac_f32_32x32x32_bf16 v[120:135], v[40:43], v[56:63], v6
    v_exp_f32 v68, v68
    v_exp_f32 v69, v69
    v_exp_f32 v70, v70
    v_exp_f32 v71, v71
    ds_read_b128 v[28:31], v2 offset:61440
    ds_read_b32 v32, v3 offset:15360
    v_smfmac_f32_32x32x32_bf16 v[120:135], v[44:47], v[64:71], v6
    v_exp_f32 v72, v72
    v_exp_f32 v73, v73
    v_exp_f32 v74, v74
    v_exp_f32 v75, v75
    v_mfma_f32_32x32x16_bf16 v[88:103], v[34:37], v[16:19], v[88:103]
    v_exp_f32 v76, v76
    v_exp_f32 v77, v77
    v_exp_f32 v78, v78
    v_exp_f32 v79, v79
    v_mfma_f32_32x32x16_bf16 v[104:119], v[34:37], v[20:23], v[104:119]
    v_exp_f32 v80, v80
    v_exp_f32 v81, v81
    v_exp_f32 v82, v82
    v_exp_f32 v83, v83
    v_smfmac_f32_32x32x32_bf16 v[136:151], v[40:43], v[72:79], v6
    v_exp_f32 v84, v84
    v_exp_f32 v85, v85
    v_exp_f32 v86, v86
    v_exp_f32 v87, v87
    s_nop 0
    s_waitcnt lgkmcnt(0)
    v_smfmac_f32_32x32x32_bf16 v[136:151], v[44:47], v[80:87], v6
    s_mov_b64 exec, s[16:17]
    ds_read_b128 v[40:43], v5 offset:32256
    ds_read_b128 v[44:47], v5 offset:32832
    s_mov_b64 exec, -1
    v_exp_f32 v88, v88
    v_exp_f32 v89, v89
    v_exp_f32 v90, v90
    v_exp_f32 v91, v91
    v_mfma_f32_32x32x4_2b_bf16 v[56:87], v[32:33], v[24:25], 0
    v_exp_f32 v92, v92
    v_exp_f32 v93, v93
    v_exp_f32 v94, v94
    v_exp_f32 v95, v95
    v_exp_f32 v96, v96
    v_exp_f32 v97, v97
    v_exp_f32 v98, v98
    v_exp_f32 v99, v99
    v_smfmac_f32_32x32x32_bf16 v[120:135], v[48:51], v[88:95], v6
    v_exp_f32 v100, v100
    v_exp_f32 v101, v101
    v_exp_f32 v102, v102
    v_exp_f32 v103, v103
    ds_read_b128 v[34:37], v2 offset:62464
    ds_read_b32 v38, v3 offset:15616
    v_smfmac_f32_32x32x32_bf16 v[120:135], v[52:55], v[96:103], v6
    v_exp_f32 v104, v104
    v_exp_f32 v105, v105
    v_exp_f32 v106, v106
    v_exp_f32 v107, v107
    v_mfma_f32_32x32x16_bf16 v[56:71], v[28:31], v[16:19], v[56:71]
    v_exp_f32 v108, v108
    v_exp_f32 v109, v109
    v_exp_f32 v110, v110
    v_exp_f32 v111, v111
    v_mfma_f32_32x32x16_bf16 v[72:87], v[28:31], v[20:23], v[72:87]
    v_exp_f32 v112, v112
    v_exp_f32 v113, v113
    v_exp_f32 v114, v114
    v_exp_f32 v115, v115
    v_smfmac_f32_32x32x32_bf16 v[136:151], v[48:51], v[104:111], v6
    v_exp_f32 v116, v116
    v_exp_f32 v117, v117
    v_exp_f32 v118, v118
    v_exp_f32 v119, v119
    s_nop 0
    s_waitcnt lgkmcnt(0)
    v_smfmac_f32_32x32x32_bf16 v[136:151], v[52:55], v[112:119], v6
    s_mov_b64 exec, s[16:17]
    ds_read_b128 v[48:51], v5 offset:33408
    ds_read_b128 v[52:55], v5 offset:33984
    s_mov_b64 exec, -1
    v_exp_f32 v56, v56
    v_exp_f32 v57, v57
    v_exp_f32 v58, v58
    v_exp_f32 v59, v59
    v_mfma_f32_32x32x4_2b_bf16 v[88:119], v[38:39], v[24:25], 0
    v_exp_f32 v60, v60
    v_exp_f32 v61, v61
    v_exp_f32 v62, v62
    v_exp_f32 v63, v63
    v_exp_f32 v64, v64
    v_exp_f32 v65, v65
    v_exp_f32 v66, v66
    v_exp_f32 v67, v67
    v_smfmac_f32_32x32x32_bf16 v[120:135], v[40:43], v[56:63], v6
    v_exp_f32 v68, v68
    v_exp_f32 v69, v69
    v_exp_f32 v70, v70
    v_exp_f32 v71, v71
    ds_read_b128 v[28:31], v2 offset:63488
    ds_read_b32 v32, v3 offset:15872
    v_smfmac_f32_32x32x32_bf16 v[120:135], v[44:47], v[64:71], v6
    v_exp_f32 v72, v72
    v_exp_f32 v73, v73
    v_exp_f32 v74, v74
    v_exp_f32 v75, v75
    v_mfma_f32_32x32x16_bf16 v[88:103], v[34:37], v[16:19], v[88:103]
    v_exp_f32 v76, v76
    v_exp_f32 v77, v77
    v_exp_f32 v78, v78
    v_exp_f32 v79, v79
    v_mfma_f32_32x32x16_bf16 v[104:119], v[34:37], v[20:23], v[104:119]
    v_exp_f32 v80, v80
    v_exp_f32 v81, v81
    v_exp_f32 v82, v82
    v_exp_f32 v83, v83
    v_smfmac_f32_32x32x32_bf16 v[136:151], v[40:43], v[72:79], v6
    v_exp_f32 v84, v84
    v_exp_f32 v85, v85
    v_exp_f32 v86, v86
    v_exp_f32 v87, v87
    s_nop 0
    s_waitcnt lgkmcnt(0)
    v_smfmac_f32_32x32x32_bf16 v[136:151], v[44:47], v[80:87], v6
    s_mov_b64 exec, s[16:17]
    ds_read_b128 v[40:43], v5 offset:34560
    ds_read_b128 v[44:47], v5 offset:35136
    s_mov_b64 exec, -1
    v_exp_f32 v88, v88
    v_exp_f32 v89, v89
    v_exp_f32 v90, v90
    v_exp_f32 v91, v91
    v_mfma_f32_32x32x4_2b_bf16 v[56:87], v[32:33], v[24:25], 0
    v_exp_f32 v92, v92
    v_exp_f32 v93, v93
    v_exp_f32 v94, v94
    v_exp_f32 v95, v95
    v_exp_f32 v96, v96
    v_exp_f32 v97, v97
    v_exp_f32 v98, v98
    v_exp_f32 v99, v99
    v_smfmac_f32_32x32x32_bf16 v[120:135], v[48:51], v[88:95], v6
    v_exp_f32 v100, v100
    v_exp_f32 v101, v101
    v_exp_f32 v102, v102
    v_exp_f32 v103, v103
    ds_read_b128 v[34:37], v2 offset:64512
    ds_read_b32 v38, v3 offset:16128
    v_smfmac_f32_32x32x32_bf16 v[120:135], v[52:55], v[96:103], v6
    v_exp_f32 v104, v104
    v_exp_f32 v105, v105
    v_exp_f32 v106, v106
    v_exp_f32 v107, v107
    v_mfma_f32_32x32x16_bf16 v[56:71], v[28:31], v[16:19], v[56:71]
    v_exp_f32 v108, v108
    v_exp_f32 v109, v109
    v_exp_f32 v110, v110
    v_exp_f32 v111, v111
    v_mfma_f32_32x32x16_bf16 v[72:87], v[28:31], v[20:23], v[72:87]
    v_exp_f32 v112, v112
    v_exp_f32 v113, v113
    v_exp_f32 v114, v114
    v_exp_f32 v115, v115
    v_smfmac_f32_32x32x32_bf16 v[136:151], v[48:51], v[104:111], v6
    v_exp_f32 v116, v116
    v_exp_f32 v117, v117
    v_exp_f32 v118, v118
    v_exp_f32 v119, v119
    s_setprio 0
    s_waitcnt lgkmcnt(0)
    v_smfmac_f32_32x32x32_bf16 v[136:151], v[52:55], v[112:119], v6
    s_mov_b64 exec, s[16:17]
    ds_read_b128 v[48:51], v5 offset:35712
    ds_read_b128 v[52:55], v5 offset:36288
    s_mov_b64 exec, -1
    v_exp_f32 v56, v56
    v_exp_f32 v57, v57
    v_exp_f32 v58, v58
    v_exp_f32 v59, v59
    v_mfma_f32_32x32x4_2b_bf16 v[88:119], v[38:39], v[24:25], 0
    v_exp_f32 v60, v60
    v_exp_f32 v61, v61
    v_exp_f32 v62, v62
    v_exp_f32 v63, v63
    v_exp_f32 v64, v64
    v_exp_f32 v65, v65
    v_exp_f32 v66, v66
    v_exp_f32 v67, v67
    v_smfmac_f32_32x32x32_bf16 v[120:135], v[40:43], v[56:63], v6
    v_exp_f32 v68, v68
    v_exp_f32 v69, v69
    v_exp_f32 v70, v70
    v_exp_f32 v71, v71
    s_nop 1
    v_smfmac_f32_32x32x32_bf16 v[120:135], v[44:47], v[64:71], v6
    v_exp_f32 v72, v72
    v_exp_f32 v73, v73
    v_exp_f32 v74, v74
    v_exp_f32 v75, v75
    v_mfma_f32_32x32x16_bf16 v[88:103], v[34:37], v[16:19], v[88:103]
    v_exp_f32 v76, v76
    v_exp_f32 v77, v77
    v_exp_f32 v78, v78
    v_exp_f32 v79, v79
    v_mfma_f32_32x32x16_bf16 v[104:119], v[34:37], v[20:23], v[104:119]
    v_exp_f32 v80, v80
    v_exp_f32 v81, v81
    v_exp_f32 v82, v82
    v_exp_f32 v83, v83
    v_smfmac_f32_32x32x32_bf16 v[136:151], v[40:43], v[72:79], v6
    v_exp_f32 v84, v84
    v_exp_f32 v85, v85
    v_exp_f32 v86, v86
    v_exp_f32 v87, v87
    s_setprio 2
    s_waitcnt lgkmcnt(0)
    v_smfmac_f32_32x32x32_bf16 v[136:151], v[44:47], v[80:87], v6
    v_exp_f32 v88, v88
    v_exp_f32 v89, v89
    v_exp_f32 v90, v90
    v_exp_f32 v91, v91
    v_exp_f32 v92, v92
    v_exp_f32 v93, v93
    v_exp_f32 v94, v94
    v_exp_f32 v95, v95
    v_exp_f32 v96, v96
    v_exp_f32 v97, v97
    v_exp_f32 v98, v98
    v_exp_f32 v99, v99
    v_smfmac_f32_32x32x32_bf16 v[120:135], v[48:51], v[88:95], v6
    v_exp_f32 v100, v100
    v_exp_f32 v101, v101
    v_exp_f32 v102, v102
    v_exp_f32 v103, v103
    s_nop 1
    v_smfmac_f32_32x32x32_bf16 v[120:135], v[52:55], v[96:103], v6
    v_exp_f32 v104, v104
    v_exp_f32 v105, v105
    v_exp_f32 v106, v106
    v_exp_f32 v107, v107
    v_exp_f32 v108, v108
    v_exp_f32 v109, v109
    v_exp_f32 v110, v110
    v_exp_f32 v111, v111
    v_exp_f32 v112, v112
    v_exp_f32 v113, v113
    v_exp_f32 v114, v114
    v_exp_f32 v115, v115
    v_smfmac_f32_32x32x32_bf16 v[136:151], v[48:51], v[104:111], v6
    v_exp_f32 v116, v116
    v_exp_f32 v117, v117
    v_exp_f32 v118, v118
    v_exp_f32 v119, v119
    s_nop 1
    v_smfmac_f32_32x32x32_bf16 v[136:151], v[52:55], v[112:119], v6
    s_setprio 0
L_p2_loopdone:
    s_add_u32 s45, s46, 32768
    s_add_u32 s51, s47, 4096
L_p2_store:
    v_rcp_f32 v152, v130
    s_nop 0
    v_mul_f32 v120, v120, v152
    v_mul_f32 v121, v121, v152
    v_mul_f32 v122, v122, v152
    v_mul_f32 v123, v123, v152
    v_mul_f32 v124, v124, v152
    v_mul_f32 v125, v125, v152
    v_mul_f32 v126, v126, v152
    v_mul_f32 v127, v127, v152
    v_mul_f32 v128, v128, v152
    v_mul_f32 v129, v129, v152
    v_cvt_pk_bf16_f32 v154, v120, v121
    v_cvt_pk_bf16_f32 v155, v122, v123
    v_cvt_pk_bf16_f32 v156, v124, v125
    v_cvt_pk_bf16_f32 v157, v126, v127
    v_cvt_pk_bf16_f32 v158, v128, v129
    buffer_store_dwordx4 v[154:157], v2, s[8:11], s46 offen offset:0 sc1
    s_mov_b32 exec_hi, 0
    buffer_store_dword v158, v197, s[8:11], s47 offen sc1
    s_mov_b32 exec_hi, -1
    v_rcp_f32 v152, v146
    s_nop 0
    v_mul_f32 v136, v136, v152
    v_mul_f32 v137, v137, v152
    v_mul_f32 v138, v138, v152
    v_mul_f32 v139, v139, v152
    v_mul_f32 v140, v140, v152
    v_mul_f32 v141, v141, v152
    v_mul_f32 v142, v142, v152
    v_mul_f32 v143, v143, v152
    v_mul_f32 v144, v144, v152
    v_mul_f32 v145, v145, v152
    v_cvt_pk_bf16_f32 v160, v136, v137
    v_cvt_pk_bf16_f32 v161, v138, v139
    v_cvt_pk_bf16_f32 v162, v140, v141
    v_cvt_pk_bf16_f32 v163, v142, v143
    v_cvt_pk_bf16_f32 v164, v144, v145
    buffer_store_dwordx4 v[160:163], v2, s[8:11], s45 offen sc1
    s_mov_b32 exec_hi, 0
    buffer_store_dword v164, v197, s[8:11], s51 offen sc1
    s_mov_b32 exec_hi, -1
    s_cmp_lg_u32 s15, 0
    s_cbranch_scc1 L_p2_checked
    s_mov_b64 s[20:21], 0
    s_mov_b32 s22, 0x53800000
    s_mov_b32 s23, 0x2b800000
    v_mul_f32 v152, 0, v120
    v_mul_f32 v153, 0, v136
    v_fma_f32 v152, v121, 0, v152
    v_fma_f32 v153, v137, 0, v153
    v_fma_f32 v152, v122, 0, v152
    v_fma_f32 v153, v138, 0, v153
    v_fma_f32 v152, v123, 0, v152
    v_fma_f32 v153, v139, 0, v153
    v_fma_f32 v152, v124, 0, v152
    v_fma_f32 v153, v140, 0, v153
    v_fma_f32 v152, v125, 0, v152
    v_fma_f32 v153, v141, 0, v153
    v_fma_f32 v152, v126, 0, v152
    v_fma_f32 v153, v142, 0, v153
    v_fma_f32 v152, v127, 0, v152
    v_fma_f32 v153, v143, 0, v153
    v_fma_f32 v152, v128, 0, v152
    v_fma_f32 v153, v144, 0, v153
    v_fma_f32 v152, v129, 0, v152
    v_fma_f32 v153, v145, 0, v153
    v_add_f32 v152, v152, v130
    v_add_f32 v153, v153, v146
    v_cmp_ngt_f32 vcc, s22, v152
    s_or_b64 s[20:21], s[20:21], vcc
    v_cmp_nlt_f32 vcc, s23, v152
    s_or_b64 s[20:21], s[20:21], vcc
    v_cmp_ngt_f32 vcc, s22, v153
    s_or_b64 s[20:21], s[20:21], vcc
    v_cmp_nlt_f32 vcc, s23, v153
    s_or_b64 s[20:21], s[20:21], vcc
    s_cmp_eq_u64 s[20:21], 0
    s_cbranch_scc0 L_p2_fallback
L_p2_checked:
    s_waitcnt vmcnt(0)
    s_barrier
    s_cmp_lg_u32 s3, 0
    s_cbranch_scc1 L_sig_p2
    s_lshl_b32 s48, s48, 7
    s_add_u32 s48, s48, 19922944
    v_mov_b32 v254, s48
    v_mov_b32 v255, s63
    s_mov_b64 exec, 1
    global_store_dword v254, v255, s[80:81] sc1
    s_mov_b64 exec, -1
L_sig_p2:
    s_branch L_p2_end
L_p2_fallback:
    s_mov_b32 s15, 1
    v_mov_b32 v152, 0xff800000
    v_mov_b32 v153, 0xff800000
    v_mov_b32 v25, 0
    v_mov_b32 v156, v2
    v_mov_b32 v157, v3
    s_mov_b32 s18, 64
L_p2_fb1:
    ds_read_b128 v[28:31], v156
    ds_read_b32 v32, v157
    v_add_u32 v156, 1024, v156
    v_add_u32 v157, 256, v157
    s_waitcnt lgkmcnt(0)
    v_mfma_f32_32x32x4_2b_bf16 v[56:87], v[32:33], v[24:25], 0
    s_nop 15
    s_nop 3
    v_mfma_f32_32x32x16_bf16 v[56:71], v[28:31], v[16:19], v[56:71]
    v_mfma_f32_32x32x16_bf16 v[72:87], v[28:31], v[20:23], v[72:87]
    s_nop 15
    v_max3_f32 v152, v152, v56, v57
    v_max3_f32 v152, v152, v58, v59
    v_max3_f32 v152, v152, v60, v61
    v_max3_f32 v152, v152, v62, v63
    v_max3_f32 v152, v152, v64, v65
    v_max3_f32 v152, v152, v66, v67
    v_max3_f32 v152, v152, v68, v69
    v_max3_f32 v152, v152, v70, v71
    v_max3_f32 v153, v153, v72, v73
    v_max3_f32 v153, v153, v74, v75
    v_max3_f32 v153, v153, v76, v77
    v_max3_f32 v153, v153, v78, v79
    v_max3_f32 v153, v153, v80, v81
    v_max3_f32 v153, v153, v82, v83
    v_max3_f32 v153, v153, v84, v85
    v_max3_f32 v153, v153, v86, v87
    s_sub_u32 s18, s18, 1
    s_cmp_lg_u32 s18, 0
    s_cbranch_scc1 L_p2_fb1
    v_mov_b32 v158, v152
    v_mov_b32 v159, v152
    s_nop 1
    v_permlane32_swap_b32 v158, v159
    s_nop 1
    v_max_f32 v152, v158, v159
    v_mov_b32 v158, v153
    v_mov_b32 v159, v153
    s_nop 1
    v_permlane32_swap_b32 v158, v159
    s_nop 1
    v_max_f32 v153, v158, v159
    v_cmp_gt_u32 vcc, 32, v0
    s_nop 1
    v_cndmask_b32 v158, v153, v152, vcc
    v_and_b32 v160, 0xffff0000, v158
    v_sub_f32 v158, v158, v160
    v_and_b32 v161, 0xffff0000, v158
    v_xor_b32 v160, 0x80000000, v160
    v_xor_b32 v161, 0x80000000, v161
    v_lshrrev_b32 v160, 16, v160
    v_or_b32 v25, v160, v161
    v_mov_b32 v120, 0
    v_mov_b32 v121, 0
    v_mov_b32 v122, 0
    v_mov_b32 v123, 0
    v_mov_b32 v124, 0
    v_mov_b32 v125, 0
    v_mov_b32 v126, 0
    v_mov_b32 v127, 0
    v_mov_b32 v128, 0
    v_mov_b32 v129, 0
    v_mov_b32 v130, 0
    v_mov_b32 v131, 0
    v_mov_b32 v132, 0
    v_mov_b32 v133, 0
    v_mov_b32 v134, 0
    v_mov_b32 v135, 0
    v_mov_b32 v136, 0
    v_mov_b32 v137, 0
    v_mov_b32 v138, 0
    v_mov_b32 v139, 0
    v_mov_b32 v140, 0
    v_mov_b32 v141, 0
    v_mov_b32 v142, 0
    v_mov_b32 v143, 0
    v_mov_b32 v144, 0
    v_mov_b32 v145, 0
    v_mov_b32 v146, 0
    v_mov_b32 v147, 0
    v_mov_b32 v148, 0
    v_mov_b32 v149, 0
    v_mov_b32 v150, 0
    v_mov_b32 v151, 0
    v_mov_b32 v156, v2
    v_mov_b32 v157, v3
    v_mov_b32 v158, v4
    s_mov_b32 s18, 64
L_p2_fb2:
    ds_read_b128 v[28:31], v156
    ds_read_b32 v32, v157
    s_mov_b64 exec, s[16:17]
    ds_read_b128 v[40:43], v158
    ds_read_b128 v[44:47], v158 offset:576
    s_mov_b64 exec, -1
    v_add_u32 v156, 1024, v156
    v_add_u32 v157, 256, v157
    v_add_u32 v158, 1152, v158
    s_waitcnt lgkmcnt(0)
    v_mfma_f32_32x32x4_2b_bf16 v[56:87], v[32:33], v[24:25], 0
    s_nop 15
    s_nop 3
    v_mfma_f32_32x32x16_bf16 v[56:71], v[28:31], v[16:19], v[56:71]
    v_mfma_f32_32x32x16_bf16 v[72:87], v[28:31], v[20:23], v[72:87]
    s_nop 15
    v_exp_f32 v56, v56
    v_exp_f32 v57, v57
    v_exp_f32 v58, v58
    v_exp_f32 v59, v59
    v_exp_f32 v60, v60
    v_exp_f32 v61, v61
    v_exp_f32 v62, v62
    v_exp_f32 v63, v63
    v_exp_f32 v64, v64
    v_exp_f32 v65, v65
    v_exp_f32 v66, v66
    v_exp_f32 v67, v67
    v_exp_f32 v68, v68
    v_exp_f32 v69, v69
    v_exp_f32 v70, v70
    v_exp_f32 v71, v71
    v_exp_f32 v72, v72
    v_exp_f32 v73, v73
    v_exp_f32 v74, v74
    v_exp_f32 v75, v75
    v_exp_f32 v76, v76
    v_exp_f32 v77, v77
    v_exp_f32 v78, v78
    v_exp_f32 v79, v79
    v_exp_f32 v80, v80
    v_exp_f32 v81, v81
    v_exp_f32 v82, v82
    v_exp_f32 v83, v83
    v_exp_f32 v84, v84
    v_exp_f32 v85, v85
    v_exp_f32 v86, v86
    v_exp_f32 v87, v87
    s_nop 1
    v_smfmac_f32_32x32x32_bf16 v[120:135], v[40:43], v[56:63], v6
    v_smfmac_f32_32x32x32_bf16 v[120:135], v[44:47], v[64:71], v6
    v_smfmac_f32_32x32x32_bf16 v[136:151], v[40:43], v[72:79], v6
    v_smfmac_f32_32x32x32_bf16 v[136:151], v[44:47], v[80:87], v6
    s_sub_u32 s18, s18, 1
    s_cmp_lg_u32 s18, 0
    s_cbranch_scc1 L_p2_fb2
    s_nop 7
    s_nop 7
    s_branch L_p2_store
L_p2_end:
    s_and_b32 s30, s2, 7
    s_lshr_b32 s31, s2, 3
    s_mov_b32 s32, s3
    s_lshr_b32 s33, s30, 2
    s_and_b32 s34, s30, 3
    s_lshl_b32 s34, s34, 2
    s_and_b32 s35, s31, 3
    s_add_u32 s34, s34, s35
    s_lshr_b32 s35, s31, 2
    s_lshl_b32 s36, s34, 2
    s_lshr_b32 s37, s32, 1
    s_add_u32 s36, s36, s37
    v_mul_u32_u24 v9, 26, v0
    v_lshrrev_b32 v9, 8, v9
    v_mul_u32_u24 v10, 10, v9
    v_sub_u32 v10, v0, v10
    v_mul_u32_u24 v9, 1152, v9
    v_lshl_add_u32 v5, v10, 4, v9
    s_cmp_eq_u32 s33, 0
    s_cselect_b32 s8, s68, s74
    s_cselect_b32 s9, s69, s75
    s_mov_b32 s10, 663552
    s_mov_b32 s11, 0x00020000
    s_sub_u32 s38, s32, 1
    s_mul_i32 s22, s38, 6912
    s_mul_i32 s23, s35, 144
    s_add_u32 s22, s22, s23
    s_mul_i32 s23, s38, 960
    s_cmp_eq_u32 s32, 0
    s_cbranch_scc1 L_p3_nodma
    s_mov_b32 exec_hi, 0x0fffffff
    s_mov_b32 m0, s23
    s_add_u32 s23, s23, 6720
    buffer_load_dwordx4 v5, s[8:11], s22 offen lds
    s_add_u32 s22, s22, 48384
    s_mov_b32 m0, s23
    s_add_u32 s23, s23, 6720
    buffer_load_dwordx4 v5, s[8:11], s22 offen lds
    s_add_u32 s22, s22, 48384
    s_mov_b32 m0, s23
    s_add_u32 s23, s23, 6720
    buffer_load_dwordx4 v5, s[8:11], s22 offen lds
    s_add_u32 s22, s22, 48384
    s_mov_b32 m0, s23
    s_add_u32 s23, s23, 6720
    buffer_load_dwordx4 v5, s[8:11], s22 offen lds
    s_add_u32 s22, s22, 48384
    s_mov_b32 m0, s23
    s_add_u32 s23, s23, 6720
    buffer_load_dwordx4 v5, s[8:11], s22 offen lds
    s_add_u32 s22, s22, 48384
    s_mov_b32 m0, s23
    s_add_u32 s23, s23, 6720
    buffer_load_dwordx4 v5, s[8:11], s22 offen lds
    s_add_u32 s22, s22, 48384
    s_mov_b32 m0, s23
    s_add_u32 s23, s23, 6720
    buffer_load_dwordx4 v5, s[8:11], s22 offen lds
    s_add_u32 s22, s22, 48384
    s_mov_b32 m0, s23
    s_add_u32 s23, s23, 6720
    buffer_load_dwordx4 v5, s[8:11], s22 offen lds
    s_add_u32 s22, s22, 48384
    s_mov_b32 m0, s23
    s_add_u32 s23, s23, 6720
    buffer_load_dwordx4 v5, s[8:11], s22 offen lds
    s_add_u32 s22, s22, 48384
    s_mov_b32 m0, s23
    s_add_u32 s23, s23, 6720
    buffer_load_dwordx4 v5, s[8:11], s22 offen lds
    s_add_u32 s22, s22, 48384
    s_mov_b32 m0, s23
    s_add_u32 s23, s23, 6720
    buffer_load_dwordx4 v5, s[8:11], s22 offen lds
    s_add_u32 s22, s22, 48384
    s_mov_b32 m0, s23
    s_add_u32 s23, s23, 6720
    buffer_load_dwordx4 v5, s[8:11], s22 offen lds
    s_add_u32 s22, s22, 48384
    s_mov_b32 m0, s23
    s_add_u32 s23, s23, 6720
    buffer_load_dwordx4 v5, s[8:11], s22 offen lds
    s_add_u32 s22, s22, 48384
    s_cmp_ge_u32 s38, 5
    s_cbranch_scc1 L_p3_dmadone
    s_mov_b32 m0, s23
    s_add_u32 s23, s23, 6720
    buffer_load_dwordx4 v5, s[8:11], s22 offen lds
    s_add_u32 s22, s22, 48384
L_p3_dmadone:
    s_mov_b32 exec_hi, -1
L_p3_nodma:
    s_mov_b32 exec_hi, -1
    v_and_b32 v7, 15, v0
    v_lshrrev_b32 v8, 4, v0
    v_lshlrev_b32 v9, 9, v8
    v_lshl_add_u32 v1, v7, 4, v9
    s_and_b32 s37, s32, 1
    s_lshl_b32 s38, s37, 6
    s_lshl_b32 s37, s37, 8
    v_add_u32 v1, s37, v1
    v_lshlrev_b32 v47, 2, v7
    v_lshl_add_u32 v47, v8, 9, v47
    v_add_u32 v47, s38, v47
    v_lshrrev_b32 v9, 1, v8
    v_mul_u32_u24 v9, 20, v9
    v_and_b32 v10, 1, v8
    v_lshl_add_u32 v9, v10, 2, v9
    v_lshrrev_b32 v10, 2, v7
    v_add_u32 v9, v9, v10
    v_mul_u32_u24 v9, 160, v9
    v_and_b32 v11, 3, v7
    v_lshl_add_u32 v2, v11, 3, v9
    v_add_u32 v3, 46080, v2
    v_lshlrev_b32 v9, 2, v8
    v_lshrrev_b32 v12, 1, v10
    v_add_u32 v9, v9, v12
    v_mul_u32_u24 v9, 18, v9
    v_and_b32 v13, 1, v10
    v_add_u32 v9, v9, v13
    v_xor_b32 v12, 1, v12
    v_lshl_add_u32 v9, v12, 4, v9
    v_mul_u32_u24 v9, 160, v9
    v_lshl_add_u32 v4, v11, 3, v9
    s_lshr_b32 s37, s34, 2
    s_lshl_b32 s38, s33, 2
    s_add_u32 s37, s37, s38
    s_lshl_b32 s37, s37, 5
    s_add_u32 s37, s37, 256
    v_add_u32 v6, s37, v0
    v_lshlrev_b32 v6, 7, v6
    v_add_u32 v6, 19922944, v6
    s_mov_b32 s16, s80
    s_mov_b32 s17, s81
    s_mov_b32 s18, 20971520
    s_mov_b32 s19, 0x00020000
    s_mov_b32 s12, s76
    s_mov_b32 s13, s77
    s_mov_b32 s14, 4718592
    s_mov_b32 s15, 0x00020000
    s_lshl_b32 s20, s33, 21
    s_lshl_b32 s21, s36, 15
    s_add_u32 s20, s20, s21
    s_add_u32 s20, s20, 14680064
    s_lshl_b32 s21, s33, 18
    s_lshl_b32 s22, s36, 12
    s_add_u32 s21, s21, s22
    s_add_u32 s21, s21, 18874368
    s_mul_i32 s23, s32, 2688
    s_add_u32 s23, s23, 92160
    v_mul_u32_u24 v9, 168, v7
    v_lshl_add_u32 v9, v8, 3, v9
    v_add_u32 v14, s23, v9
    s_lshl_b32 s24, s36, 5
    s_and_b32 s25, s32, 1
    s_lshl_b32 s25, s25, 4
    s_add_u32 s24, s24, s25
    s_mul_i32 s24, s24, 2304
    s_mul_i32 s25, s33, 1152
    s_add_u32 s24, s24, s25
    s_mul_i32 s25, s35, 144
    s_add_u32 s24, s24, s25
    v_add_u32 v10, 0, v0
    v_mul_u32_u24 v11, 57, v10
    v_lshrrev_b32 v11, 9, v11
    v_mul_u32_u24 v12, 9, v11
    v_sub_u32 v12, v10, v12
    v_mul_u32_u24 v13, 168, v11
    v_lshl_add_u32 v13, v12, 4, v13
    v_add_u32 v40, s23, v13
    v_mul_u32_u24 v13, 2304, v11
    v_lshl_add_u32 v44, v12, 4, v13
    v_add_u32 v10, 64, v0
    v_mul_u32_u24 v11, 57, v10
    v_lshrrev_b32 v11, 9, v11
    v_mul_u32_u24 v12, 9, v11
    v_sub_u32 v12, v10, v12
    v_mul_u32_u24 v13, 168, v11
    v_lshl_add_u32 v13, v12, 4, v13
    v_add_u32 v41, s23, v13
    v_mul_u32_u24 v13, 2304, v11
    v_lshl_add_u32 v45, v12, 4, v13
    v_add_u32 v10, 128, v0
    v_mul_u32_u24 v11, 57, v10
    v_lshrrev_b32 v11, 9, v11
    v_mul_u32_u24 v12, 9, v11
    v_sub_u32 v12, v10, v12
    v_mul_u32_u24 v13, 168, v11
    v_lshl_add_u32 v13, v12, 4, v13
    v_add_u32 v42, s23, v13
    v_mul_u32_u24 v13, 2304, v11
    v_lshl_add_u32 v46, v12, 4, v13
    s_cmp_lg_u32 s3, 0
    s_cbranch_scc1 L_polled_p2
    s_mov_b32 s40, 0
    s_mov_b32 exec_hi, 0
    s_mov_b32 exec_lo, -1
L_poll_p2:
    global_load_dword v255, v6, s[80:81] sc1
    s_waitcnt vmcnt(0)
    v_cmp_ne_u32 vcc, s63, v255
    s_cmp_eq_u64 vcc, 0
    s_cbranch_scc1 L_pollok_p2
    s_sleep 1
    s_add_u32 s40, s40, 1
    s_cmp_lt_u32 s40, 400000
    s_cbranch_scc1 L_poll_p2
L_pollok_p2:
    s_mov_b64 exec, -1
L_polled_p2:
    s_waitcnt vmcnt(0)
    s_barrier
    buffer_load_dwordx4 v[64:67], v1, s[16:19], s20 offen offset:0 sc1
    buffer_load_dwordx4 v[68:71], v1, s[16:19], s20 offen offset:2048 sc1
    s_add_u32 s20, s20, 4096
    buffer_load_dwordx4 v[72:75], v1, s[16:19], s20 offen offset:0 sc1
    buffer_load_dwordx4 v[76:79], v1, s[16:19], s20 offen offset:2048 sc1
    s_add_u32 s20, s20, 4096
    buffer_load_dwordx4 v[80:83], v1, s[16:19], s20 offen offset:0 sc1
    buffer_load_dwordx4 v[84:87], v1, s[16:19], s20 offen offset:2048 sc1
    s_add_u32 s20, s20, 4096
    buffer_load_dwordx4 v[88:91], v1, s[16:19], s20 offen offset:0 sc1
    buffer_load_dwordx4 v[92:95], v1, s[16:19], s20 offen offset:2048 sc1
    s_add_u32 s20, s20, 4096
    ds_read_b64_tr_b16 v[144:145], v2 offset:0
    ds_read_b64_tr_b16 v[146:147], v2 offset:1280
    ds_read_b64_tr_b16 v[148:149], v2 offset:32
    ds_read_b64_tr_b16 v[150:151], v2 offset:1312
    ds_read_b64_tr_b16 v[152:153], v2 offset:64
    ds_read_b64_tr_b16 v[154:155], v2 offset:1344
    ds_read_b64_tr_b16 v[156:157], v2 offset:96
    ds_read_b64_tr_b16 v[158:159], v2 offset:1376
    ds_read_b64_tr_b16 v[160:161], v2 offset:128
    ds_read_b64_tr_b16 v[162:163], v2 offset:1408
    s_waitcnt vmcnt(7) lgkmcnt(0)
    buffer_load_dwordx4 v[96:99], v1, s[16:19], s20 offen offset:0 sc1
    v_mfma_f32_16x16x32_bf16 v[16:19], v[144:147], v[64:67], 0
    ds_read_b64_tr_b16 v[164:165], v2 offset:5760
    ds_read_b64_tr_b16 v[166:167], v2 offset:7040
    v_mfma_f32_16x16x32_bf16 v[20:23], v[148:151], v[64:67], 0
    ds_read_b64_tr_b16 v[168:169], v2 offset:5792
    ds_read_b64_tr_b16 v[170:171], v2 offset:7072
    v_mfma_f32_16x16x32_bf16 v[24:27], v[152:155], v[64:67], 0
    ds_read_b64_tr_b16 v[172:173], v2 offset:5824
    ds_read_b64_tr_b16 v[174:175], v2 offset:7104
    v_mfma_f32_16x16x32_bf16 v[28:31], v[156:159], v[64:67], 0
    ds_read_b64_tr_b16 v[176:177], v2 offset:5856
    ds_read_b64_tr_b16 v[178:179], v2 offset:7136
    v_mfma_f32_16x16x32_bf16 v[32:35], v[160:163], v[64:67], 0
    ds_read_b64_tr_b16 v[180:181], v2 offset:5888
    ds_read_b64_tr_b16 v[182:183], v2 offset:7168
    s_waitcnt vmcnt(7) lgkmcnt(0)
    buffer_load_dwordx4 v[100:103], v1, s[16:19], s20 offen offset:2048 sc1
    s_add_u32 s20, s20, 4096
    v_mfma_f32_16x16x32_bf16 v[16:19], v[164:167], v[68:71], v[16:19]
    ds_read_b64_tr_b16 v[144:145], v2 offset:11520
    ds_read_b64_tr_b16 v[146:147], v2 offset:12800
    v_mfma_f32_16x16x32_bf16 v[20:23], v[168:171], v[68:71], v[20:23]
    ds_read_b64_tr_b16 v[148:149], v2 offset:11552
    ds_read_b64_tr_b16 v[150:151], v2 offset:12832
    v_mfma_f32_16x16x32_bf16 v[24:27], v[172:175], v[68:71], v[24:27]
    ds_read_b64_tr_b16 v[152:153], v2 offset:11584
    ds_read_b64_tr_b16 v[154:155], v2 offset:12864
    v_mfma_f32_16x16x32_bf16 v[28:31], v[176:179], v[68:71], v[28:31]
    ds_read_b64_tr_b16 v[156:157], v2 offset:11616
    ds_read_b64_tr_b16 v[158:159], v2 offset:12896
    v_mfma_f32_16x16x32_bf16 v[32:35], v[180:183], v[68:71], v[32:35]
    ds_read_b64_tr_b16 v[160:161], v2 offset:11648
    ds_read_b64_tr_b16 v[162:163], v2 offset:12928
    s_waitcnt vmcnt(7) lgkmcnt(0)
    buffer_load_dwordx4 v[104:107], v1, s[16:19], s20 offen offset:0 sc1
    v_mfma_f32_16x16x32_bf16 v[16:19], v[144:147], v[72:75], v[16:19]
    ds_read_b64_tr_b16 v[164:165], v2 offset:17280
    ds_read_b64_tr_b16 v[166:167], v2 offset:18560
    v_mfma_f32_16x16x32_bf16 v[20:23], v[148:151], v[72:75], v[20:23]
    ds_read_b64_tr_b16 v[168:169], v2 offset:17312
    ds_read_b64_tr_b16 v[170:171], v2 offset:18592
    v_mfma_f32_16x16x32_bf16 v[24:27], v[152:155], v[72:75], v[24:27]
    ds_read_b64_tr_b16 v[172:173], v2 offset:17344
    ds_read_b64_tr_b16 v[174:175], v2 offset:18624
    v_mfma_f32_16x16x32_bf16 v[28:31], v[156:159], v[72:75], v[28:31]
    ds_read_b64_tr_b16 v[176:177], v2 offset:17376
    ds_read_b64_tr_b16 v[178:179], v2 offset:18656
    v_mfma_f32_16x16x32_bf16 v[32:35], v[160:163], v[72:75], v[32:35]
    ds_read_b64_tr_b16 v[180:181], v2 offset:17408
    ds_read_b64_tr_b16 v[182:183], v2 offset:18688
    s_waitcnt vmcnt(7) lgkmcnt(0)
    buffer_load_dwordx4 v[108:111], v1, s[16:19], s20 offen offset:2048 sc1
    s_add_u32 s20, s20, 4096
    v_mfma_f32_16x16x32_bf16 v[16:19], v[164:167], v[76:79], v[16:19]
    ds_read_b64_tr_b16 v[144:145], v2 offset:23040
    ds_read_b64_tr_b16 v[146:147], v2 offset:24320
    v_mfma_f32_16x16x32_bf16 v[20:23], v[168:171], v[76:79], v[20:23]
    ds_read_b64_tr_b16 v[148:149], v2 offset:23072
    ds_read_b64_tr_b16 v[150:151], v2 offset:24352
    v_mfma_f32_16x16x32_bf16 v[24:27], v[172:175], v[76:79], v[24:27]
    ds_read_b64_tr_b16 v[152:153], v2 offset:23104
    ds_read_b64_tr_b16 v[154:155], v2 offset:24384
    v_mfma_f32_16x16x32_bf16 v[28:31], v[176:179], v[76:79], v[28:31]
    ds_read_b64_tr_b16 v[156:157], v2 offset:23136
    ds_read_b64_tr_b16 v[158:159], v2 offset:24416
    v_mfma_f32_16x16x32_bf16 v[32:35], v[180:183], v[76:79], v[32:35]
    ds_read_b64_tr_b16 v[160:161], v2 offset:23168
    ds_read_b64_tr_b16 v[162:163], v2 offset:24448
    s_waitcnt vmcnt(7) lgkmcnt(0)
    buffer_load_dwordx4 v[112:115], v1, s[16:19], s20 offen offset:0 sc1
    v_mfma_f32_16x16x32_bf16 v[16:19], v[144:147], v[80:83], v[16:19]
    ds_read_b64_tr_b16 v[164:165], v2 offset:28800
    ds_read_b64_tr_b16 v[166:167], v2 offset:30080
    v_mfma_f32_16x16x32_bf16 v[20:23], v[148:151], v[80:83], v[20:23]
    ds_read_b64_tr_b16 v[168:169], v2 offset:28832
    ds_read_b64_tr_b16 v[170:171], v2 offset:30112
    v_mfma_f32_16x16x32_bf16 v[24:27], v[152:155], v[80:83], v[24:27]
    ds_read_b64_tr_b16 v[172:173], v2 offset:28864
    ds_read_b64_tr_b16 v[174:175], v2 offset:30144
    v_mfma_f32_16x16x32_bf16 v[28:31], v[156:159], v[80:83], v[28:31]
    ds_read_b64_tr_b16 v[176:177], v2 offset:28896
    ds_read_b64_tr_b16 v[178:179], v2 offset:30176
    v_mfma_f32_16x16x32_bf16 v[32:35], v[160:163], v[80:83], v[32:35]
    ds_read_b64_tr_b16 v[180:181], v2 offset:28928
    ds_read_b64_tr_b16 v[182:183], v2 offset:30208
    s_waitcnt vmcnt(7) lgkmcnt(0)
    buffer_load_dwordx4 v[116:119], v1, s[16:19], s20 offen offset:2048 sc1
    s_add_u32 s20, s20, 4096
    v_mfma_f32_16x16x32_bf16 v[16:19], v[164:167], v[84:87], v[16:19]
    ds_read_b64_tr_b16 v[144:145], v2 offset:34560
    ds_read_b64_tr_b16 v[146:147], v2 offset:35840
    v_mfma_f32_16x16x32_bf16 v[20:23], v[168:171], v[84:87], v[20:23]
    ds_read_b64_tr_b16 v[148:149], v2 offset:34592
    ds_read_b64_tr_b16 v[150:151], v2 offset:35872
    v_mfma_f32_16x16x32_bf16 v[24:27], v[172:175], v[84:87], v[24:27]
    ds_read_b64_tr_b16 v[152:153], v2 offset:34624
    ds_read_b64_tr_b16 v[154:155], v2 offset:35904
    v_mfma_f32_16x16x32_bf16 v[28:31], v[176:179], v[84:87], v[28:31]
    ds_read_b64_tr_b16 v[156:157], v2 offset:34656
    ds_read_b64_tr_b16 v[158:159], v2 offset:35936
    v_mfma_f32_16x16x32_bf16 v[32:35], v[180:183], v[84:87], v[32:35]
    ds_read_b64_tr_b16 v[160:161], v2 offset:34688
    ds_read_b64_tr_b16 v[162:163], v2 offset:35968
    s_waitcnt vmcnt(7) lgkmcnt(0)
    buffer_load_dwordx4 v[120:123], v1, s[16:19], s20 offen offset:0 sc1
    v_mfma_f32_16x16x32_bf16 v[16:19], v[144:147], v[88:91], v[16:19]
    ds_read_b64_tr_b16 v[164:165], v2 offset:40320
    ds_read_b64_tr_b16 v[166:167], v2 offset:41600
    v_mfma_f32_16x16x32_bf16 v[20:23], v[148:151], v[88:91], v[20:23]
    ds_read_b64_tr_b16 v[168:169], v2 offset:40352
    ds_read_b64_tr_b16 v[170:171], v2 offset:41632
    v_mfma_f32_16x16x32_bf16 v[24:27], v[152:155], v[88:91], v[24:27]
    ds_read_b64_tr_b16 v[172:173], v2 offset:40384
    ds_read_b64_tr_b16 v[174:175], v2 offset:41664
    v_mfma_f32_16x16x32_bf16 v[28:31], v[156:159], v[88:91], v[28:31]
    ds_read_b64_tr_b16 v[176:177], v2 offset:40416
    ds_read_b64_tr_b16 v[178:179], v2 offset:41696
    v_mfma_f32_16x16x32_bf16 v[32:35], v[160:163], v[88:91], v[32:35]
    ds_read_b64_tr_b16 v[180:181], v2 offset:40448
    ds_read_b64_tr_b16 v[182:183], v2 offset:41728
    s_waitcnt vmcnt(7) lgkmcnt(0)
    buffer_load_dwordx4 v[124:127], v1, s[16:19], s20 offen offset:2048 sc1
    s_add_u32 s20, s20, 4096
    v_mfma_f32_16x16x32_bf16 v[16:19], v[164:167], v[92:95], v[16:19]
    ds_read_b64_tr_b16 v[144:145], v3 offset:0
    ds_read_b64_tr_b16 v[146:147], v3 offset:1280
    v_mfma_f32_16x16x32_bf16 v[20:23], v[168:171], v[92:95], v[20:23]
    ds_read_b64_tr_b16 v[148:149], v3 offset:32
    ds_read_b64_tr_b16 v[150:151], v3 offset:1312
    v_mfma_f32_16x16x32_bf16 v[24:27], v[172:175], v[92:95], v[24:27]
    ds_read_b64_tr_b16 v[152:153], v3 offset:64
    ds_read_b64_tr_b16 v[154:155], v3 offset:1344
    v_mfma_f32_16x16x32_bf16 v[28:31], v[176:179], v[92:95], v[28:31]
    ds_read_b64_tr_b16 v[156:157], v3 offset:96
    ds_read_b64_tr_b16 v[158:159], v3 offset:1376
    v_mfma_f32_16x16x32_bf16 v[32:35], v[180:183], v[92:95], v[32:35]
    ds_read_b64_tr_b16 v[160:161], v3 offset:128
    ds_read_b64_tr_b16 v[162:163], v3 offset:1408
    s_waitcnt vmcnt(7) lgkmcnt(0)
    buffer_load_dword v128, v47, s[16:19], s21 offen offset:0 sc1
    buffer_load_dword v129, v47, s[16:19], s21 offen offset:128 sc1
    buffer_load_dword v130, v47, s[16:19], s21 offen offset:256 sc1
    buffer_load_dword v131, v47, s[16:19], s21 offen offset:384 sc1
    v_mfma_f32_16x16x32_bf16 v[16:19], v[144:147], v[96:99], v[16:19]
    ds_read_b64_tr_b16 v[164:165], v3 offset:5760
    ds_read_b64_tr_b16 v[166:167], v3 offset:7040
    v_mfma_f32_16x16x32_bf16 v[20:23], v[148:151], v[96:99], v[20:23]
    ds_read_b64_tr_b16 v[168:169], v3 offset:5792
    ds_read_b64_tr_b16 v[170:171], v3 offset:7072
    v_mfma_f32_16x16x32_bf16 v[24:27], v[152:155], v[96:99], v[24:27]
    ds_read_b64_tr_b16 v[172:173], v3 offset:5824
    ds_read_b64_tr_b16 v[174:175], v3 offset:7104
    v_mfma_f32_16x16x32_bf16 v[28:31], v[156:159], v[96:99], v[28:31]
    ds_read_b64_tr_b16 v[176:177], v3 offset:5856
    ds_read_b64_tr_b16 v[178:179], v3 offset:7136
    v_mfma_f32_16x16x32_bf16 v[32:35], v[160:163], v[96:99], v[32:35]
    ds_read_b64_tr_b16 v[180:181], v3 offset:5888
    ds_read_b64_tr_b16 v[182:183], v3 offset:7168
    s_waitcnt vmcnt(10) lgkmcnt(0)
    buffer_load_dword v132, v47, s[16:19], s21 offen offset:2048 sc1
    buffer_load_dword v133, v47, s[16:19], s21 offen offset:2176 sc1
    buffer_load_dword v134, v47, s[16:19], s21 offen offset:2304 sc1
    buffer_load_dword v135, v47, s[16:19], s21 offen offset:2432 sc1
    v_mfma_f32_16x16x32_bf16 v[16:19], v[164:167], v[100:103], v[16:19]
    ds_read_b64_tr_b16 v[144:145], v3 offset:11520
    ds_read_b64_tr_b16 v[146:147], v3 offset:12800
    v_mfma_f32_16x16x32_bf16 v[20:23], v[168:171], v[100:103], v[20:23]
    ds_read_b64_tr_b16 v[148:149], v3 offset:11552
    ds_read_b64_tr_b16 v[150:151], v3 offset:12832
    v_mfma_f32_16x16x32_bf16 v[24:27], v[172:175], v[100:103], v[24:27]
    ds_read_b64_tr_b16 v[152:153], v3 offset:11584
    ds_read_b64_tr_b16 v[154:155], v3 offset:12864
    v_mfma_f32_16x16x32_bf16 v[28:31], v[176:179], v[100:103], v[28:31]
    ds_read_b64_tr_b16 v[156:157], v3 offset:11616
    ds_read_b64_tr_b16 v[158:159], v3 offset:12896
    v_mfma_f32_16x16x32_bf16 v[32:35], v[180:183], v[100:103], v[32:35]
    ds_read_b64_tr_b16 v[160:161], v3 offset:11648
    ds_read_b64_tr_b16 v[162:163], v3 offset:12928
    s_waitcnt vmcnt(13) lgkmcnt(0)
    v_mfma_f32_16x16x32_bf16 v[16:19], v[144:147], v[104:107], v[16:19]
    ds_read_b64_tr_b16 v[164:165], v3 offset:17280
    ds_read_b64_tr_b16 v[166:167], v3 offset:18560
    v_mfma_f32_16x16x32_bf16 v[20:23], v[148:151], v[104:107], v[20:23]
    ds_read_b64_tr_b16 v[168:169], v3 offset:17312
    ds_read_b64_tr_b16 v[170:171], v3 offset:18592
    v_mfma_f32_16x16x32_bf16 v[24:27], v[152:155], v[104:107], v[24:27]
    ds_read_b64_tr_b16 v[172:173], v3 offset:17344
    ds_read_b64_tr_b16 v[174:175], v3 offset:18624
    v_mfma_f32_16x16x32_bf16 v[28:31], v[156:159], v[104:107], v[28:31]
    ds_read_b64_tr_b16 v[176:177], v3 offset:17376
    ds_read_b64_tr_b16 v[178:179], v3 offset:18656
    v_mfma_f32_16x16x32_bf16 v[32:35], v[160:163], v[104:107], v[32:35]
    ds_read_b64_tr_b16 v[180:181], v3 offset:17408
    ds_read_b64_tr_b16 v[182:183], v3 offset:18688
    s_waitcnt vmcnt(12) lgkmcnt(0)
    v_mfma_f32_16x16x32_bf16 v[16:19], v[164:167], v[108:111], v[16:19]
    ds_read_b64_tr_b16 v[144:145], v3 offset:23040
    ds_read_b64_tr_b16 v[146:147], v3 offset:24320
    v_mfma_f32_16x16x32_bf16 v[20:23], v[168:171], v[108:111], v[20:23]
    ds_read_b64_tr_b16 v[148:149], v3 offset:23072
    ds_read_b64_tr_b16 v[150:151], v3 offset:24352
    v_mfma_f32_16x16x32_bf16 v[24:27], v[172:175], v[108:111], v[24:27]
    ds_read_b64_tr_b16 v[152:153], v3 offset:23104
    ds_read_b64_tr_b16 v[154:155], v3 offset:24384
    v_mfma_f32_16x16x32_bf16 v[28:31], v[176:179], v[108:111], v[28:31]
    ds_read_b64_tr_b16 v[156:157], v3 offset:23136
    ds_read_b64_tr_b16 v[158:159], v3 offset:24416
    v_mfma_f32_16x16x32_bf16 v[32:35], v[180:183], v[108:111], v[32:35]
    ds_read_b64_tr_b16 v[160:161], v3 offset:23168
    ds_read_b64_tr_b16 v[162:163], v3 offset:24448
    s_waitcnt vmcnt(11) lgkmcnt(0)
    v_mfma_f32_16x16x32_bf16 v[16:19], v[144:147], v[112:115], v[16:19]
    ds_read_b64_tr_b16 v[164:165], v3 offset:28800
    ds_read_b64_tr_b16 v[166:167], v3 offset:30080
    v_mfma_f32_16x16x32_bf16 v[20:23], v[148:151], v[112:115], v[20:23]
    ds_read_b64_tr_b16 v[168:169], v3 offset:28832
    ds_read_b64_tr_b16 v[170:171], v3 offset:30112
    v_mfma_f32_16x16x32_bf16 v[24:27], v[152:155], v[112:115], v[24:27]
    ds_read_b64_tr_b16 v[172:173], v3 offset:28864
    ds_read_b64_tr_b16 v[174:175], v3 offset:30144
    v_mfma_f32_16x16x32_bf16 v[28:31], v[156:159], v[112:115], v[28:31]
    ds_read_b64_tr_b16 v[176:177], v3 offset:28896
    ds_read_b64_tr_b16 v[178:179], v3 offset:30176
    v_mfma_f32_16x16x32_bf16 v[32:35], v[160:163], v[112:115], v[32:35]
    ds_read_b64_tr_b16 v[180:181], v3 offset:28928
    ds_read_b64_tr_b16 v[182:183], v3 offset:30208
    s_waitcnt vmcnt(10) lgkmcnt(0)
    v_mfma_f32_16x16x32_bf16 v[16:19], v[164:167], v[116:119], v[16:19]
    ds_read_b64_tr_b16 v[144:145], v3 offset:34560
    ds_read_b64_tr_b16 v[146:147], v3 offset:35840
    v_mfma_f32_16x16x32_bf16 v[20:23], v[168:171], v[116:119], v[20:23]
    ds_read_b64_tr_b16 v[148:149], v3 offset:34592
    ds_read_b64_tr_b16 v[150:151], v3 offset:35872
    v_mfma_f32_16x16x32_bf16 v[24:27], v[172:175], v[116:119], v[24:27]
    ds_read_b64_tr_b16 v[152:153], v3 offset:34624
    ds_read_b64_tr_b16 v[154:155], v3 offset:35904
    v_mfma_f32_16x16x32_bf16 v[28:31], v[176:179], v[116:119], v[28:31]
    ds_read_b64_tr_b16 v[156:157], v3 offset:34656
    ds_read_b64_tr_b16 v[158:159], v3 offset:35936
    v_mfma_f32_16x16x32_bf16 v[32:35], v[180:183], v[116:119], v[32:35]
    ds_read_b64_tr_b16 v[160:161], v3 offset:34688
    ds_read_b64_tr_b16 v[162:163], v3 offset:35968
    s_waitcnt vmcnt(9) lgkmcnt(0)
    v_mfma_f32_16x16x32_bf16 v[16:19], v[144:147], v[120:123], v[16:19]
    ds_read_b64_tr_b16 v[164:165], v3 offset:40320
    ds_read_b64_tr_b16 v[166:167], v3 offset:41600
    v_mfma_f32_16x16x32_bf16 v[20:23], v[148:151], v[120:123], v[20:23]
    ds_read_b64_tr_b16 v[168:169], v3 offset:40352
    ds_read_b64_tr_b16 v[170:171], v3 offset:41632
    v_mfma_f32_16x16x32_bf16 v[24:27], v[152:155], v[120:123], v[24:27]
    ds_read_b64_tr_b16 v[172:173], v3 offset:40384
    ds_read_b64_tr_b16 v[174:175], v3 offset:41664
    v_mfma_f32_16x16x32_bf16 v[28:31], v[156:159], v[120:123], v[28:31]
    ds_read_b64_tr_b16 v[176:177], v3 offset:40416
    ds_read_b64_tr_b16 v[178:179], v3 offset:41696
    v_mfma_f32_16x16x32_bf16 v[32:35], v[160:163], v[120:123], v[32:35]
    ds_read_b64_tr_b16 v[180:181], v3 offset:40448
    ds_read_b64_tr_b16 v[182:183], v3 offset:41728
    s_waitcnt vmcnt(8) lgkmcnt(0)
    v_mfma_f32_16x16x32_bf16 v[16:19], v[164:167], v[124:127], v[16:19]
    ds_read_b64_tr_b16 v[144:145], v4 offset:0
    ds_read_b64_tr_b16 v[146:147], v4 offset:5760
    v_mfma_f32_16x16x32_bf16 v[20:23], v[168:171], v[124:127], v[20:23]
    ds_read_b64_tr_b16 v[148:149], v4 offset:32
    ds_read_b64_tr_b16 v[150:151], v4 offset:5792
    v_mfma_f32_16x16x32_bf16 v[24:27], v[172:175], v[124:127], v[24:27]
    ds_read_b64_tr_b16 v[152:153], v4 offset:64
    ds_read_b64_tr_b16 v[154:155], v4 offset:5824
    v_mfma_f32_16x16x32_bf16 v[28:31], v[176:179], v[124:127], v[28:31]
    ds_read_b64_tr_b16 v[156:157], v4 offset:96
    ds_read_b64_tr_b16 v[158:159], v4 offset:5856
    v_mfma_f32_16x16x32_bf16 v[32:35], v[180:183], v[124:127], v[32:35]
    ds_read_b64_tr_b16 v[160:161], v4 offset:128
    ds_read_b64_tr_b16 v[162:163], v4 offset:5888
    s_waitcnt vmcnt(4) lgkmcnt(0)
    v_mfma_f32_16x16x32_bf16 v[16:19], v[144:147], v[128:131], v[16:19]
    ds_read_b64_tr_b16 v[164:165], v4 offset:46080
    ds_read_b64_tr_b16 v[166:167], v4 offset:51840
    v_mfma_f32_16x16x32_bf16 v[20:23], v[148:151], v[128:131], v[20:23]
    ds_read_b64_tr_b16 v[168:169], v4 offset:46112
    ds_read_b64_tr_b16 v[170:171], v4 offset:51872
    v_mfma_f32_16x16x32_bf16 v[24:27], v[152:155], v[128:131], v[24:27]
    ds_read_b64_tr_b16 v[172:173], v4 offset:46144
    ds_read_b64_tr_b16 v[174:175], v4 offset:51904
    v_mfma_f32_16x16x32_bf16 v[28:31], v[156:159], v[128:131], v[28:31]
    ds_read_b64_tr_b16 v[176:177], v4 offset:46176
    ds_read_b64_tr_b16 v[178:179], v4 offset:51936
    v_mfma_f32_16x16x32_bf16 v[32:35], v[160:163], v[128:131], v[32:35]
    ds_read_b64_tr_b16 v[180:181], v4 offset:46208
    ds_read_b64_tr_b16 v[182:183], v4 offset:51968
    s_waitcnt vmcnt(0) lgkmcnt(0)
    v_mfma_f32_16x16x32_bf16 v[16:19], v[164:167], v[132:135], v[16:19]
    v_mfma_f32_16x16x32_bf16 v[20:23], v[168:171], v[132:135], v[20:23]
    v_mfma_f32_16x16x32_bf16 v[24:27], v[172:175], v[132:135], v[24:27]
    v_mfma_f32_16x16x32_bf16 v[28:31], v[176:179], v[132:135], v[28:31]
    v_mfma_f32_16x16x32_bf16 v[32:35], v[180:183], v[132:135], v[32:35]
    s_nop 7
    v_cvt_pk_bf16_f32 v64, v16, v17
    v_cvt_pk_bf16_f32 v65, v18, v19
    ds_write_b64 v14, v[64:65] offset:0
    v_cvt_pk_bf16_f32 v66, v20, v21
    v_cvt_pk_bf16_f32 v67, v22, v23
    ds_write_b64 v14, v[66:67] offset:32
    v_cvt_pk_bf16_f32 v68, v24, v25
    v_cvt_pk_bf16_f32 v69, v26, v27
    ds_write_b64 v14, v[68:69] offset:64
    v_cvt_pk_bf16_f32 v70, v28, v29
    v_cvt_pk_bf16_f32 v71, v30, v31
    ds_write_b64 v14, v[70:71] offset:96
    v_cvt_pk_bf16_f32 v72, v32, v33
    v_cvt_pk_bf16_f32 v73, v34, v35
    ds_write_b64 v14, v[72:73] offset:128
    s_waitcnt lgkmcnt(0)
    ds_read_b64 v[120:121], v40
    ds_read_b64 v[122:123], v40 offset:8
    ds_read_b64 v[124:125], v41
    ds_read_b64 v[126:127], v41 offset:8
    ds_read_b64 v[128:129], v42
    ds_read_b64 v[130:131], v42 offset:8
    s_waitcnt lgkmcnt(4)
    buffer_store_dwordx4 v[120:123], v44, s[12:15], s24 offen
    s_waitcnt lgkmcnt(2)
    buffer_store_dwordx4 v[124:127], v45, s[12:15], s24 offen
    s_waitcnt lgkmcnt(0)
    s_mov_b32 exec_lo, 0xffff
    s_mov_b32 exec_hi, 0
    buffer_store_dwordx4 v[128:131], v46, s[12:15], s24 offen
    s_mov_b64 exec, -1
L_end:
L_exit:
    s_endpgm
.section .rodata,"a"
.p2align 6
.amdhsa_kernel concat_heads__mha_block__mha_block__prompt_kernel
  .amdhsa_next_free_vgpr 256
  .amdhsa_next_free_sgpr 102
  .amdhsa_accum_offset 256
  .amdhsa_group_segment_fixed_size 0
  .amdhsa_kernarg_size 72
  .amdhsa_user_sgpr_count 2
  .amdhsa_user_sgpr_kernarg_segment_ptr 1
  .amdhsa_system_sgpr_workgroup_id_x 1
.end_amdhsa_kernel
.text
```
